```python
import torch

def _softmax(x, axis=-1):
    return torch.softmax(x, dim=axis)

def _gelu(x):
    return torch.nn.functional.gelu(x, approximate='tanh')

def _silu(x):
    return torch.nn.functional.silu(x)

def _sigmoid(x):
    return torch.sigmoid(x)

def _layernorm(x, axis=-1, eps=1e-05):
    m = x.mean(dim=axis, keepdim=True)
    v = x.var(dim=axis, keepdim=True, unbiased=False)
    return (x - m) / torch.sqrt(v + eps)

def _scatter_add(tgt, idx, src, axis=0):
    return tgt.clone().index_add_(axis, idx, src)

def _segment_sum(src, seg, n):
    out = torch.zeros((n,) + src.shape[1:], dtype=src.dtype)
    return out.index_add_(0, seg, src)

def _pad(x, pw):
    flat = tuple((v for pair in reversed(pw) for v in pair))
    return torch.nn.functional.pad(x, flat)
kernel_name = 'standalone__video_timesformer__vision'

def setup_inputs():

    _w = lambda a: (lambda t: t.to(torch.bfloat16) if t.is_floating_point() else t)(torch.as_tensor(a))
    T = 7
    p = 14
    HW = 384 // p * p
    N = (HW // p) ** 2
    C = 384
    return {'x': _w((lambda *s: torch.randn(*s, dtype=torch.bfloat16) * 0.1)(1, T, N, C)), 'wqkv_t': _w((lambda *s: torch.randn(*s, dtype=torch.bfloat16) * 0.1)(C, 3 * C)), 'wo_t': _w((lambda *s: torch.randn(*s, dtype=torch.bfloat16) * 0.1)(C, C)), 'wqkv_s': _w((lambda *s: torch.randn(*s, dtype=torch.bfloat16) * 0.1)(C, 3 * C)), 'wo_s': _w((lambda *s: torch.randn(*s, dtype=torch.bfloat16) * 0.1)(C, C))}

def reference(x, wqkv_t, wo_t, wqkv_s, wo_s):
    B, T, N, C = x.shape
    scale = C ** (-0.5)
    xt = (lambda x, *d: x.permute(*d))(x, 0, 2, 1, 3).reshape(B * N, T, C)
    h = _layernorm(xt, axis=-1)
    qkv = h @ wqkv_t
    q, k, v = (qkv[..., :C].clone(), qkv[..., C:2 * C].clone(), qkv[..., 2 * C:].clone())
    a = _softmax(torch.einsum('btc,bsc->bts', q, k) * scale, axis=-1)
    xt = xt + torch.einsum('bts,bsc->btc', a, v) @ wo_t
    x1 = (lambda x, *d: x.permute(*d))(xt.reshape(B, N, T, C), 0, 2, 1, 3)
    xs = x1.reshape(B * T, N, C)
    h = _layernorm(xs, axis=-1)
    qkv = h @ wqkv_s
    q, k, v = (qkv[..., :C].clone(), qkv[..., C:2 * C].clone(), qkv[..., 2 * C:].clone())
    a = _softmax(torch.einsum('bnc,bmc->bnm', q, k) * scale, axis=-1)
    xs = xs + torch.einsum('bnm,bmc->bnc', a, v) @ wo_s
    return xs.reshape(B, T, N, C)
```

```asm
; @launch grid=(255,1,1) block=(256,1,1) lds=148480
.amdgcn_target "amdgcn-amd-amdhsa--gfx950"
.text
.globl standalone__video_timesformer__vision_kernel
.p2align 8
.type standalone__video_timesformer__vision_kernel,@function
standalone__video_timesformer__vision_kernel:
    s_cmp_ge_u32 s2, 255
    s_cbranch_scc1 standalone__video_timesformer__vision_kernel_end
    s_load_dwordx16 s[16:31], s[0:1], 0
    v_and_b32 v1, 63, v0
    v_lshrrev_b32 v4, 6, v0
    v_and_b32 v2, 31, v1
    v_readfirstlane_b32 s3, v4
    v_lshrrev_b32 v3, 5, v1
    s_waitcnt lgkmcnt(0)
    s_mov_b32 s64, s28
    s_mov_b32 s65, s29
    s_mov_b32 s66, 256
    s_mov_b32 s67, 0x00020000
    s_add_u32 s80, s30, 25165824
    s_addc_u32 s81, s31, 0
    s_mov_b32 s82, 24576
    s_mov_b32 s83, 0x00020000
    s_mov_b32 s53, 0
    s_cmp_lg_u32 s2, 72
    s_cbranch_scc1 L_noz
    s_cmp_lg_u32 s3, 0
    s_cbranch_scc1 L_noz
    v_mov_b32 v244, 0
    v_lshlrev_b32 v245, 7, v1
    s_mov_b32 s63, 0
    buffer_store_dword v244, v245, s[80:83], s63 offen sc1
    s_mov_b32 s63, 8192
    buffer_store_dword v244, v245, s[80:83], s63 offen sc1
    s_mov_b32 s63, 16384
    buffer_store_dword v244, v245, s[80:83], s63 offen sc1
    s_waitcnt vmcnt(0)
    v_mov_b32 v244, 1
    v_mov_b32 v245, 0
    buffer_store_dword v244, v245, s[64:67], 0 offen sc1
    s_mov_b32 s53, 1
L_noz:
    s_cmp_ge_u32 s2, 72
    s_cbranch_scc1 L_cons
    s_mul_hi_u32 s54, s2, 119304648
    s_mul_i32 s55, s54, 36
    s_sub_u32 s55, s2, s55
    s_mov_b32 s56, 0
LF_loop:
    s_mov_b32 s4, s54
    s_mov_b32 s5, s55
    s_mul_hi_u32 s6, s5, 0x2AAAAAAB
    s_mul_i32 s7, s6, 6
    s_sub_u32 s7, s5, s7
    s_cmp_ge_u32 s4, 2
    s_cselect_b32 s8, s22, s18
    s_cselect_b32 s9, s23, s19
    s_cselect_b32 s10, s24, s20
    s_cselect_b32 s11, s25, s21
    s_mov_b32 s32, s8
    s_mov_b32 s33, s9
    s_mov_b32 s34, 884736
    s_mov_b32 s35, 0x00020000
    s_mov_b32 s36, s10
    s_mov_b32 s37, s11
    s_mov_b32 s38, 294912
    s_mov_b32 s39, 0x00020000
    s_lshl_b32 s8, s4, 20
    s_add_u32 s40, s30, s8
    s_addc_u32 s41, s31, 0
    s_mov_b32 s42, 294912
    s_mov_b32 s43, 0x00020000
    s_and_b32 s12, s4, 1
    v_lshlrev_b32 v5, 4, v1
    s_lshl_b32 s13, s6, 6
    s_lshl_b32 s14, s3, 4
    s_add_u32 s13, s13, s14
    s_mul_i32 s13, s13, 2304
    s_mul_i32 s15, s12, 1536
    s_add_u32 s13, s13, s15
    s_mul_i32 s14, s14, 784
    v_cmp_gt_u32 vcc, 48, v1
    s_and_saveexec_b64 s[44:45], vcc
    s_add_u32 m0, s14, 0
    s_add_u32 s15, s13, 0
    s_nop 0
    buffer_load_dwordx4 v5, s[32:35], s15 offen lds
    s_add_u32 m0, s14, 784
    s_add_u32 s15, s13, 2304
    s_nop 0
    buffer_load_dwordx4 v5, s[32:35], s15 offen lds
    s_add_u32 m0, s14, 1568
    s_add_u32 s15, s13, 4608
    s_nop 0
    buffer_load_dwordx4 v5, s[32:35], s15 offen lds
    s_add_u32 m0, s14, 2352
    s_add_u32 s15, s13, 6912
    s_nop 0
    buffer_load_dwordx4 v5, s[32:35], s15 offen lds
    s_add_u32 m0, s14, 3136
    s_add_u32 s15, s13, 9216
    s_nop 0
    buffer_load_dwordx4 v5, s[32:35], s15 offen lds
    s_add_u32 m0, s14, 3920
    s_add_u32 s15, s13, 11520
    s_nop 0
    buffer_load_dwordx4 v5, s[32:35], s15 offen lds
    s_add_u32 m0, s14, 4704
    s_add_u32 s15, s13, 13824
    s_nop 0
    buffer_load_dwordx4 v5, s[32:35], s15 offen lds
    s_add_u32 m0, s14, 5488
    s_add_u32 s15, s13, 16128
    s_nop 0
    buffer_load_dwordx4 v5, s[32:35], s15 offen lds
    s_add_u32 m0, s14, 6272
    s_add_u32 s15, s13, 18432
    s_nop 0
    buffer_load_dwordx4 v5, s[32:35], s15 offen lds
    s_add_u32 m0, s14, 7056
    s_add_u32 s15, s13, 20736
    s_nop 0
    buffer_load_dwordx4 v5, s[32:35], s15 offen lds
    s_add_u32 m0, s14, 7840
    s_add_u32 s15, s13, 23040
    s_nop 0
    buffer_load_dwordx4 v5, s[32:35], s15 offen lds
    s_add_u32 m0, s14, 8624
    s_add_u32 s15, s13, 25344
    s_nop 0
    buffer_load_dwordx4 v5, s[32:35], s15 offen lds
    s_add_u32 m0, s14, 9408
    s_add_u32 s15, s13, 27648
    s_nop 0
    buffer_load_dwordx4 v5, s[32:35], s15 offen lds
    s_add_u32 m0, s14, 10192
    s_add_u32 s15, s13, 29952
    s_nop 0
    buffer_load_dwordx4 v5, s[32:35], s15 offen lds
    s_add_u32 m0, s14, 10976
    s_add_u32 s15, s13, 32256
    s_nop 0
    buffer_load_dwordx4 v5, s[32:35], s15 offen lds
    s_add_u32 m0, s14, 11760
    s_add_u32 s15, s13, 34560
    s_nop 0
    buffer_load_dwordx4 v5, s[32:35], s15 offen lds
    s_mov_b64 exec, s[44:45]
    v_mul_u32_u24 v6, 784, v2
    v_lshl_add_u32 v6, v3, 4, v6
    s_lshr_b32 s46, s3, 1
    s_and_b32 s47, s3, 1
    s_mul_i32 s15, s46, 25088
    v_add_u32 v7, s15, v6
    s_cmp_eq_u32 s12, 1
    s_cbranch_scc1 LF0_vo
    s_lshl_b32 s13, s7, 6
    s_lshl_b32 s14, s3, 4
    s_add_u32 s13, s13, s14
    s_mul_i32 s13, s13, 2304
    s_add_u32 s13, s13, 768
    s_mul_i32 s14, s14, 784
    s_and_saveexec_b64 s[44:45], vcc
    s_add_u32 m0, s14, 50176
    s_add_u32 s15, s13, 0
    s_nop 0
    buffer_load_dwordx4 v5, s[32:35], s15 offen lds
    s_add_u32 m0, s14, 50960
    s_add_u32 s15, s13, 2304
    s_nop 0
    buffer_load_dwordx4 v5, s[32:35], s15 offen lds
    s_add_u32 m0, s14, 51744
    s_add_u32 s15, s13, 4608
    s_nop 0
    buffer_load_dwordx4 v5, s[32:35], s15 offen lds
    s_add_u32 m0, s14, 52528
    s_add_u32 s15, s13, 6912
    s_nop 0
    buffer_load_dwordx4 v5, s[32:35], s15 offen lds
    s_add_u32 m0, s14, 53312
    s_add_u32 s15, s13, 9216
    s_nop 0
    buffer_load_dwordx4 v5, s[32:35], s15 offen lds
    s_add_u32 m0, s14, 54096
    s_add_u32 s15, s13, 11520
    s_nop 0
    buffer_load_dwordx4 v5, s[32:35], s15 offen lds
    s_add_u32 m0, s14, 54880
    s_add_u32 s15, s13, 13824
    s_nop 0
    buffer_load_dwordx4 v5, s[32:35], s15 offen lds
    s_add_u32 m0, s14, 55664
    s_add_u32 s15, s13, 16128
    s_nop 0
    buffer_load_dwordx4 v5, s[32:35], s15 offen lds
    s_add_u32 m0, s14, 56448
    s_add_u32 s15, s13, 18432
    s_nop 0
    buffer_load_dwordx4 v5, s[32:35], s15 offen lds
    s_add_u32 m0, s14, 57232
    s_add_u32 s15, s13, 20736
    s_nop 0
    buffer_load_dwordx4 v5, s[32:35], s15 offen lds
    s_add_u32 m0, s14, 58016
    s_add_u32 s15, s13, 23040
    s_nop 0
    buffer_load_dwordx4 v5, s[32:35], s15 offen lds
    s_add_u32 m0, s14, 58800
    s_add_u32 s15, s13, 25344
    s_nop 0
    buffer_load_dwordx4 v5, s[32:35], s15 offen lds
    s_add_u32 m0, s14, 59584
    s_add_u32 s15, s13, 27648
    s_nop 0
    buffer_load_dwordx4 v5, s[32:35], s15 offen lds
    s_add_u32 m0, s14, 60368
    s_add_u32 s15, s13, 29952
    s_nop 0
    buffer_load_dwordx4 v5, s[32:35], s15 offen lds
    s_add_u32 m0, s14, 61152
    s_add_u32 s15, s13, 32256
    s_nop 0
    buffer_load_dwordx4 v5, s[32:35], s15 offen lds
    s_add_u32 m0, s14, 61936
    s_add_u32 s15, s13, 34560
    s_nop 0
    buffer_load_dwordx4 v5, s[32:35], s15 offen lds
    s_mov_b64 exec, s[44:45]
    s_mul_i32 s15, s47, 25088
    s_add_u32 s15, s15, 50176
    v_add_u32 v8, s15, v6
    s_cmp_lg_u32 s3, 0
    s_cbranch_scc1 LF0_nz0
    s_cmp_lg_u32 s53, 0
    s_cbranch_scc1 LF0_zc0_skip
    v_mov_b32 v245, 0
    s_mov_b32 s61, 0
LF0_zc0:
    buffer_load_dword v244, v245, s[64:67], 0 offen sc1
    s_waitcnt vmcnt(0)
    v_readfirstlane_b32 s63, v244
    s_nop 3
    s_cmp_ge_u32 s63, 1
    s_cbranch_scc1 LF0_zc0_done
    s_sleep 4
    s_add_u32 s61, s61, 1
    s_cmp_lt_u32 s61, 0x200000
    s_cbranch_scc1 LF0_zc0
LF0_zc0_done:
    s_mov_b32 s53, 1
LF0_zc0_skip:
LF0_nz0:
    s_waitcnt vmcnt(0)
    s_barrier
    ds_read_b128 v[32:35], v7 offset:0
    ds_read_b128 v[36:39], v8 offset:0
    ds_read_b128 v[40:43], v7 offset:32
    ds_read_b128 v[44:47], v8 offset:32
    ds_read_b128 v[48:51], v7 offset:64
    ds_read_b128 v[52:55], v8 offset:64
    ds_read_b128 v[56:59], v7 offset:96
    ds_read_b128 v[60:63], v8 offset:96
    ds_read_b128 v[64:67], v7 offset:128
    ds_read_b128 v[68:71], v8 offset:128
    ds_read_b128 v[72:75], v7 offset:160
    ds_read_b128 v[76:79], v8 offset:160
    ds_read_b128 v[80:83], v7 offset:192
    ds_read_b128 v[84:87], v8 offset:192
    s_waitcnt lgkmcnt(12)
    v_mfma_f32_32x32x16_bf16 v[16:31], v[32:35], v[36:39], 0
    ds_read_b128 v[88:91], v7 offset:224
    ds_read_b128 v[92:95], v8 offset:224
    s_waitcnt lgkmcnt(12)
    v_mfma_f32_32x32x16_bf16 v[16:31], v[40:43], v[44:47], v[16:31]
    ds_read_b128 v[32:35], v7 offset:256
    ds_read_b128 v[36:39], v8 offset:256
    s_waitcnt lgkmcnt(12)
    v_mfma_f32_32x32x16_bf16 v[16:31], v[48:51], v[52:55], v[16:31]
    ds_read_b128 v[40:43], v7 offset:288
    ds_read_b128 v[44:47], v8 offset:288
    s_waitcnt lgkmcnt(12)
    v_mfma_f32_32x32x16_bf16 v[16:31], v[56:59], v[60:63], v[16:31]
    ds_read_b128 v[48:51], v7 offset:320
    ds_read_b128 v[52:55], v8 offset:320
    s_waitcnt lgkmcnt(12)
    v_mfma_f32_32x32x16_bf16 v[16:31], v[64:67], v[68:71], v[16:31]
    ds_read_b128 v[56:59], v7 offset:352
    ds_read_b128 v[60:63], v8 offset:352
    s_waitcnt lgkmcnt(12)
    v_mfma_f32_32x32x16_bf16 v[16:31], v[72:75], v[76:79], v[16:31]
    ds_read_b128 v[64:67], v7 offset:384
    ds_read_b128 v[68:71], v8 offset:384
    s_waitcnt lgkmcnt(12)
    v_mfma_f32_32x32x16_bf16 v[16:31], v[80:83], v[84:87], v[16:31]
    ds_read_b128 v[72:75], v7 offset:416
    ds_read_b128 v[76:79], v8 offset:416
    s_waitcnt lgkmcnt(12)
    v_mfma_f32_32x32x16_bf16 v[16:31], v[88:91], v[92:95], v[16:31]
    ds_read_b128 v[80:83], v7 offset:448
    ds_read_b128 v[84:87], v8 offset:448
    s_waitcnt lgkmcnt(12)
    v_mfma_f32_32x32x16_bf16 v[16:31], v[32:35], v[36:39], v[16:31]
    ds_read_b128 v[88:91], v7 offset:480
    ds_read_b128 v[92:95], v8 offset:480
    s_waitcnt lgkmcnt(12)
    v_mfma_f32_32x32x16_bf16 v[16:31], v[40:43], v[44:47], v[16:31]
    ds_read_b128 v[32:35], v7 offset:512
    ds_read_b128 v[36:39], v8 offset:512
    s_waitcnt lgkmcnt(12)
    v_mfma_f32_32x32x16_bf16 v[16:31], v[48:51], v[52:55], v[16:31]
    ds_read_b128 v[40:43], v7 offset:544
    ds_read_b128 v[44:47], v8 offset:544
    s_waitcnt lgkmcnt(12)
    v_mfma_f32_32x32x16_bf16 v[16:31], v[56:59], v[60:63], v[16:31]
    ds_read_b128 v[48:51], v7 offset:576
    ds_read_b128 v[52:55], v8 offset:576
    s_waitcnt lgkmcnt(12)
    v_mfma_f32_32x32x16_bf16 v[16:31], v[64:67], v[68:71], v[16:31]
    ds_read_b128 v[56:59], v7 offset:608
    ds_read_b128 v[60:63], v8 offset:608
    s_waitcnt lgkmcnt(12)
    v_mfma_f32_32x32x16_bf16 v[16:31], v[72:75], v[76:79], v[16:31]
    ds_read_b128 v[64:67], v7 offset:640
    ds_read_b128 v[68:71], v8 offset:640
    s_waitcnt lgkmcnt(12)
    v_mfma_f32_32x32x16_bf16 v[16:31], v[80:83], v[84:87], v[16:31]
    ds_read_b128 v[72:75], v7 offset:672
    ds_read_b128 v[76:79], v8 offset:672
    s_waitcnt lgkmcnt(12)
    v_mfma_f32_32x32x16_bf16 v[16:31], v[88:91], v[92:95], v[16:31]
    ds_read_b128 v[80:83], v7 offset:704
    ds_read_b128 v[84:87], v8 offset:704
    s_waitcnt lgkmcnt(12)
    v_mfma_f32_32x32x16_bf16 v[16:31], v[32:35], v[36:39], v[16:31]
    ds_read_b128 v[88:91], v7 offset:736
    ds_read_b128 v[92:95], v8 offset:736
    s_waitcnt lgkmcnt(12)
    v_mfma_f32_32x32x16_bf16 v[16:31], v[40:43], v[44:47], v[16:31]
    s_waitcnt lgkmcnt(10)
    v_mfma_f32_32x32x16_bf16 v[16:31], v[48:51], v[52:55], v[16:31]
    s_waitcnt lgkmcnt(8)
    v_mfma_f32_32x32x16_bf16 v[16:31], v[56:59], v[60:63], v[16:31]
    s_waitcnt lgkmcnt(6)
    v_mfma_f32_32x32x16_bf16 v[16:31], v[64:67], v[68:71], v[16:31]
    s_waitcnt lgkmcnt(4)
    v_mfma_f32_32x32x16_bf16 v[16:31], v[72:75], v[76:79], v[16:31]
    s_waitcnt lgkmcnt(2)
    v_mfma_f32_32x32x16_bf16 v[16:31], v[80:83], v[84:87], v[16:31]
    s_waitcnt lgkmcnt(0)
    v_mfma_f32_32x32x16_bf16 v[16:31], v[88:91], v[92:95], v[16:31]
    s_nop 15
    v_mul_f32 v16, 0x3d96c740, v16
    v_mul_f32 v17, 0x3d96c740, v17
    v_mul_f32 v18, 0x3d96c740, v18
    v_mul_f32 v19, 0x3d96c740, v19
    v_mul_f32 v20, 0x3d96c740, v20
    v_mul_f32 v21, 0x3d96c740, v21
    v_mul_f32 v22, 0x3d96c740, v22
    v_mul_f32 v23, 0x3d96c740, v23
    v_mul_f32 v24, 0x3d96c740, v24
    v_mul_f32 v25, 0x3d96c740, v25
    v_mul_f32 v26, 0x3d96c740, v26
    v_mul_f32 v27, 0x3d96c740, v27
    v_mul_f32 v28, 0x3d96c740, v28
    v_mul_f32 v29, 0x3d96c740, v29
    v_mul_f32 v30, 0x3d96c740, v30
    v_mul_f32 v31, 0x3d96c740, v31
    v_cvt_pk_bf16_f32 v32, v16, v17
    v_cvt_pk_bf16_f32 v33, v18, v19
    v_cvt_pk_bf16_f32 v34, v20, v21
    v_cvt_pk_bf16_f32 v35, v22, v23
    v_cvt_pk_bf16_f32 v36, v24, v25
    v_cvt_pk_bf16_f32 v37, v26, v27
    v_cvt_pk_bf16_f32 v38, v28, v29
    v_cvt_pk_bf16_f32 v39, v30, v31
    s_nop 1
    v_permlane32_swap_b32 v32, v34
    v_permlane32_swap_b32 v33, v35
    v_permlane32_swap_b32 v36, v38
    v_permlane32_swap_b32 v37, v39
    s_branch LF0_store
LF0_vo:
    v_lshrrev_b32 v8, 3, v1
    v_and_b32 v9, 7, v1
    v_mul_u32_u24 v8, 768, v8
    v_lshl_add_u32 v8, v9, 4, v8
    s_lshl_b32 s13, s7, 7
    s_mul_i32 s14, s3, 96*768
    s_add_u32 s13, s13, s14
    s_mul_i32 s14, s3, 96*128
    s_add_u32 m0, s14, 50176
    s_add_u32 s15, s13, 0
    s_nop 0
    buffer_load_dwordx4 v8, s[36:39], s15 offen lds
    s_add_u32 m0, s14, 51200
    s_add_u32 s15, s13, 6144
    s_nop 0
    buffer_load_dwordx4 v8, s[36:39], s15 offen lds
    s_add_u32 m0, s14, 52224
    s_add_u32 s15, s13, 12288
    s_nop 0
    buffer_load_dwordx4 v8, s[36:39], s15 offen lds
    s_add_u32 m0, s14, 53248
    s_add_u32 s15, s13, 18432
    s_nop 0
    buffer_load_dwordx4 v8, s[36:39], s15 offen lds
    s_add_u32 m0, s14, 54272
    s_add_u32 s15, s13, 24576
    s_nop 0
    buffer_load_dwordx4 v8, s[36:39], s15 offen lds
    s_add_u32 m0, s14, 55296
    s_add_u32 s15, s13, 30720
    s_nop 0
    buffer_load_dwordx4 v8, s[36:39], s15 offen lds
    s_add_u32 m0, s14, 56320
    s_add_u32 s15, s13, 36864
    s_nop 0
    buffer_load_dwordx4 v8, s[36:39], s15 offen lds
    s_add_u32 m0, s14, 57344
    s_add_u32 s15, s13, 43008
    s_nop 0
    buffer_load_dwordx4 v8, s[36:39], s15 offen lds
    s_add_u32 m0, s14, 58368
    s_add_u32 s15, s13, 49152
    s_nop 0
    buffer_load_dwordx4 v8, s[36:39], s15 offen lds
    s_add_u32 m0, s14, 59392
    s_add_u32 s15, s13, 55296
    s_nop 0
    buffer_load_dwordx4 v8, s[36:39], s15 offen lds
    s_add_u32 m0, s14, 60416
    s_add_u32 s15, s13, 61440
    s_nop 0
    buffer_load_dwordx4 v8, s[36:39], s15 offen lds
    s_add_u32 m0, s14, 61440
    s_add_u32 s15, s13, 67584
    s_nop 0
    buffer_load_dwordx4 v8, s[36:39], s15 offen lds
    v_and_b32 v4, 15, v1
    v_lshrrev_b32 v9, 2, v4
    v_and_b32 v4, 3, v4
    v_lshl_add_u32 v9, v3, 3, v9
    v_lshlrev_b32 v9, 7, v9
    v_lshl_add_u32 v9, v4, 3, v9
    v_bfe_u32 v4, v1, 4, 1
    v_lshl_add_u32 v9, v4, 5, v9
    s_lshl_b32 s15, s47, 6
    s_add_u32 s15, s15, 50176
    v_add_u32 v9, s15, v9
    s_cmp_lg_u32 s3, 0
    s_cbranch_scc1 LF0_nz1
    s_cmp_lg_u32 s53, 0
    s_cbranch_scc1 LF0_zc1_skip
    v_mov_b32 v245, 0
    s_mov_b32 s61, 0
LF0_zc1:
    buffer_load_dword v244, v245, s[64:67], 0 offen sc1
    s_waitcnt vmcnt(0)
    v_readfirstlane_b32 s63, v244
    s_nop 3
    s_cmp_ge_u32 s63, 1
    s_cbranch_scc1 LF0_zc1_done
    s_sleep 4
    s_add_u32 s61, s61, 1
    s_cmp_lt_u32 s61, 0x200000
    s_cbranch_scc1 LF0_zc1
LF0_zc1_done:
    s_mov_b32 s53, 1
LF0_zc1_skip:
LF0_nz1:
    s_waitcnt vmcnt(0)
    s_barrier
    ds_read_b128 v[32:35], v7 offset:0
    ds_read_b64_tr_b16 v[36:37], v9 offset:0
    ds_read_b64_tr_b16 v[38:39], v9 offset:512
    ds_read_b128 v[40:43], v7 offset:32
    ds_read_b64_tr_b16 v[44:45], v9 offset:2048
    ds_read_b64_tr_b16 v[46:47], v9 offset:2560
    ds_read_b128 v[48:51], v7 offset:64
    ds_read_b64_tr_b16 v[52:53], v9 offset:4096
    ds_read_b64_tr_b16 v[54:55], v9 offset:4608
    ds_read_b128 v[56:59], v7 offset:96
    ds_read_b64_tr_b16 v[60:61], v9 offset:6144
    ds_read_b64_tr_b16 v[62:63], v9 offset:6656
    ds_read_b128 v[64:67], v7 offset:128
    ds_read_b64_tr_b16 v[68:69], v9 offset:8192
    ds_read_b64_tr_b16 v[70:71], v9 offset:8704
    s_waitcnt lgkmcnt(12)
    v_mfma_f32_32x32x16_bf16 v[16:31], v[32:35], v[36:39], 0
    ds_read_b128 v[72:75], v7 offset:160
    ds_read_b64_tr_b16 v[76:77], v9 offset:10240
    ds_read_b64_tr_b16 v[78:79], v9 offset:10752
    s_waitcnt lgkmcnt(12)
    v_mfma_f32_32x32x16_bf16 v[16:31], v[40:43], v[44:47], v[16:31]
    ds_read_b128 v[80:83], v7 offset:192
    ds_read_b64_tr_b16 v[84:85], v9 offset:12288
    ds_read_b64_tr_b16 v[86:87], v9 offset:12800
    s_waitcnt lgkmcnt(12)
    v_mfma_f32_32x32x16_bf16 v[16:31], v[48:51], v[52:55], v[16:31]
    ds_read_b128 v[88:91], v7 offset:224
    ds_read_b64_tr_b16 v[92:93], v9 offset:14336
    ds_read_b64_tr_b16 v[94:95], v9 offset:14848
    s_waitcnt lgkmcnt(12)
    v_mfma_f32_32x32x16_bf16 v[16:31], v[56:59], v[60:63], v[16:31]
    ds_read_b128 v[32:35], v7 offset:256
    ds_read_b64_tr_b16 v[36:37], v9 offset:16384
    ds_read_b64_tr_b16 v[38:39], v9 offset:16896
    s_waitcnt lgkmcnt(12)
    v_mfma_f32_32x32x16_bf16 v[16:31], v[64:67], v[68:71], v[16:31]
    ds_read_b128 v[40:43], v7 offset:288
    ds_read_b64_tr_b16 v[44:45], v9 offset:18432
    ds_read_b64_tr_b16 v[46:47], v9 offset:18944
    s_waitcnt lgkmcnt(12)
    v_mfma_f32_32x32x16_bf16 v[16:31], v[72:75], v[76:79], v[16:31]
    ds_read_b128 v[48:51], v7 offset:320
    ds_read_b64_tr_b16 v[52:53], v9 offset:20480
    ds_read_b64_tr_b16 v[54:55], v9 offset:20992
    s_waitcnt lgkmcnt(12)
    v_mfma_f32_32x32x16_bf16 v[16:31], v[80:83], v[84:87], v[16:31]
    ds_read_b128 v[56:59], v7 offset:352
    ds_read_b64_tr_b16 v[60:61], v9 offset:22528
    ds_read_b64_tr_b16 v[62:63], v9 offset:23040
    s_waitcnt lgkmcnt(12)
    v_mfma_f32_32x32x16_bf16 v[16:31], v[88:91], v[92:95], v[16:31]
    ds_read_b128 v[64:67], v7 offset:384
    ds_read_b64_tr_b16 v[68:69], v9 offset:24576
    ds_read_b64_tr_b16 v[70:71], v9 offset:25088
    s_waitcnt lgkmcnt(12)
    v_mfma_f32_32x32x16_bf16 v[16:31], v[32:35], v[36:39], v[16:31]
    ds_read_b128 v[72:75], v7 offset:416
    ds_read_b64_tr_b16 v[76:77], v9 offset:26624
    ds_read_b64_tr_b16 v[78:79], v9 offset:27136
    s_waitcnt lgkmcnt(12)
    v_mfma_f32_32x32x16_bf16 v[16:31], v[40:43], v[44:47], v[16:31]
    ds_read_b128 v[80:83], v7 offset:448
    ds_read_b64_tr_b16 v[84:85], v9 offset:28672
    ds_read_b64_tr_b16 v[86:87], v9 offset:29184
    s_waitcnt lgkmcnt(12)
    v_mfma_f32_32x32x16_bf16 v[16:31], v[48:51], v[52:55], v[16:31]
    ds_read_b128 v[88:91], v7 offset:480
    ds_read_b64_tr_b16 v[92:93], v9 offset:30720
    ds_read_b64_tr_b16 v[94:95], v9 offset:31232
    s_waitcnt lgkmcnt(12)
    v_mfma_f32_32x32x16_bf16 v[16:31], v[56:59], v[60:63], v[16:31]
    ds_read_b128 v[32:35], v7 offset:512
    ds_read_b64_tr_b16 v[36:37], v9 offset:32768
    ds_read_b64_tr_b16 v[38:39], v9 offset:33280
    s_waitcnt lgkmcnt(12)
    v_mfma_f32_32x32x16_bf16 v[16:31], v[64:67], v[68:71], v[16:31]
    ds_read_b128 v[40:43], v7 offset:544
    ds_read_b64_tr_b16 v[44:45], v9 offset:34816
    ds_read_b64_tr_b16 v[46:47], v9 offset:35328
    s_waitcnt lgkmcnt(12)
    v_mfma_f32_32x32x16_bf16 v[16:31], v[72:75], v[76:79], v[16:31]
    ds_read_b128 v[48:51], v7 offset:576
    ds_read_b64_tr_b16 v[52:53], v9 offset:36864
    ds_read_b64_tr_b16 v[54:55], v9 offset:37376
    s_waitcnt lgkmcnt(12)
    v_mfma_f32_32x32x16_bf16 v[16:31], v[80:83], v[84:87], v[16:31]
    ds_read_b128 v[56:59], v7 offset:608
    ds_read_b64_tr_b16 v[60:61], v9 offset:38912
    ds_read_b64_tr_b16 v[62:63], v9 offset:39424
    s_waitcnt lgkmcnt(12)
    v_mfma_f32_32x32x16_bf16 v[16:31], v[88:91], v[92:95], v[16:31]
    ds_read_b128 v[64:67], v7 offset:640
    ds_read_b64_tr_b16 v[68:69], v9 offset:40960
    ds_read_b64_tr_b16 v[70:71], v9 offset:41472
    s_waitcnt lgkmcnt(12)
    v_mfma_f32_32x32x16_bf16 v[16:31], v[32:35], v[36:39], v[16:31]
    ds_read_b128 v[72:75], v7 offset:672
    ds_read_b64_tr_b16 v[76:77], v9 offset:43008
    ds_read_b64_tr_b16 v[78:79], v9 offset:43520
    s_waitcnt lgkmcnt(12)
    v_mfma_f32_32x32x16_bf16 v[16:31], v[40:43], v[44:47], v[16:31]
    ds_read_b128 v[80:83], v7 offset:704
    ds_read_b64_tr_b16 v[84:85], v9 offset:45056
    ds_read_b64_tr_b16 v[86:87], v9 offset:45568
    s_waitcnt lgkmcnt(12)
    v_mfma_f32_32x32x16_bf16 v[16:31], v[48:51], v[52:55], v[16:31]
    ds_read_b128 v[88:91], v7 offset:736
    ds_read_b64_tr_b16 v[92:93], v9 offset:47104
    ds_read_b64_tr_b16 v[94:95], v9 offset:47616
    s_waitcnt lgkmcnt(12)
    v_mfma_f32_32x32x16_bf16 v[16:31], v[56:59], v[60:63], v[16:31]
    s_waitcnt lgkmcnt(9)
    v_mfma_f32_32x32x16_bf16 v[16:31], v[64:67], v[68:71], v[16:31]
    s_waitcnt lgkmcnt(6)
    v_mfma_f32_32x32x16_bf16 v[16:31], v[72:75], v[76:79], v[16:31]
    s_waitcnt lgkmcnt(3)
    v_mfma_f32_32x32x16_bf16 v[16:31], v[80:83], v[84:87], v[16:31]
    s_waitcnt lgkmcnt(0)
    v_mfma_f32_32x32x16_bf16 v[16:31], v[88:91], v[92:95], v[16:31]
    s_nop 15
    v_cvt_pk_bf16_f32 v32, v16, v17
    v_cvt_pk_bf16_f32 v33, v18, v19
    v_cvt_pk_bf16_f32 v34, v20, v21
    v_cvt_pk_bf16_f32 v35, v22, v23
    v_cvt_pk_bf16_f32 v36, v24, v25
    v_cvt_pk_bf16_f32 v37, v26, v27
    v_cvt_pk_bf16_f32 v38, v28, v29
    v_cvt_pk_bf16_f32 v39, v30, v31
LF0_store:
    s_lshl_b32 s13, s7, 1
    s_add_u32 s13, s13, s47
    s_mul_i32 s13, s13, 24
    s_lshl_b32 s14, s6, 1
    s_add_u32 s14, s14, s46
    s_lshl_b32 s14, s14, 1
    s_add_u32 s13, s13, s14
    s_lshl_b32 s13, s13, 10
    s_nop 1
    buffer_store_dwordx4 v[32:35], v5, s[40:43], s13 offen sc1
    buffer_store_dwordx4 v[36:39], v5, s[40:43], s13 offen offset:1024 sc1
    s_waitcnt vmcnt(0)
    s_barrier
    s_cmp_lg_u32 s3, 0
    s_cbranch_scc1 LF0_sig
    s_cmp_lg_u32 s53, 0
    s_cbranch_scc1 LF0_sigz_skip
    v_mov_b32 v245, 0
    s_mov_b32 s61, 0
LF0_sigz:
    buffer_load_dword v244, v245, s[64:67], 0 offen sc1
    s_waitcnt vmcnt(0)
    v_readfirstlane_b32 s63, v244
    s_nop 3
    s_cmp_ge_u32 s63, 1
    s_cbranch_scc1 LF0_sigz_done
    s_sleep 4
    s_add_u32 s61, s61, 1
    s_cmp_lt_u32 s61, 0x200000
    s_cbranch_scc1 LF0_sigz
LF0_sigz_done:
    s_mov_b32 s53, 1
LF0_sigz_skip:
    v_mov_b32 v244, 1
    s_lshr_b32 s63, s2, 3
    s_and_b32 s63, s63, 7
    s_lshl_b32 s63, s63, 7
    s_mul_i32 s52, s56, 8192
    s_add_u32 s63, s63, s52
    v_mul_u32_u24 v245, 1024, v1
    v_add_u32 v245, s63, v245
    s_mov_b64 s[68:69], exec
    s_mov_b64 exec, 255
    buffer_atomic_add v244, v245, s[80:83], 0 offen sc1
    s_mov_b64 exec, s[68:69]
LF0_sig:
    s_add_u32 s54, s54, 2
    s_add_u32 s56, s56, 1
    s_cmp_lt_u32 s56, 2
    s_cbranch_scc1 LF_loop
    s_cmp_lg_u32 s3, 0
    s_cbranch_scc1 LF_np1
    s_cmp_lg_u32 s53, 0
    s_cbranch_scc1 LF_p1z_skip
    v_mov_b32 v245, 0
    s_mov_b32 s61, 0
LF_p1z:
    buffer_load_dword v244, v245, s[64:67], 0 offen sc1
    s_waitcnt vmcnt(0)
    v_readfirstlane_b32 s63, v244
    s_nop 3
    s_cmp_ge_u32 s63, 1
    s_cbranch_scc1 LF_p1z_done
    s_sleep 4
    s_add_u32 s61, s61, 1
    s_cmp_lt_u32 s61, 0x200000
    s_cbranch_scc1 LF_p1z
LF_p1z_done:
    s_mov_b32 s53, 1
LF_p1z_skip:
    s_and_b32 s63, s2, 7
    s_mul_i32 s63, s63, 1024
    s_add_u32 s63, s63, 8192
    v_and_b32 v245, 7, v1
    v_lshlrev_b32 v245, 7, v245
    v_add_u32 v245, s63, v245
    s_mov_b32 s61, 0
LF_p1:
    buffer_load_dword v244, v245, s[80:83], 0 offen sc1
    s_waitcnt vmcnt(0)
    v_readlane_b32 s63, v244, 0
    v_readlane_b32 s52, v244, 1
    s_nop 3
    s_add_u32 s63, s63, s52
    v_readlane_b32 s52, v244, 2
    s_nop 3
    s_add_u32 s63, s63, s52
    v_readlane_b32 s52, v244, 3
    s_nop 3
    s_add_u32 s63, s63, s52
    v_readlane_b32 s52, v244, 4
    s_nop 3
    s_add_u32 s63, s63, s52
    v_readlane_b32 s52, v244, 5
    s_nop 3
    s_add_u32 s63, s63, s52
    v_readlane_b32 s52, v244, 6
    s_nop 3
    s_add_u32 s63, s63, s52
    v_readlane_b32 s52, v244, 7
    s_nop 3
    s_add_u32 s63, s63, s52
    s_cmp_ge_u32 s63, 72
    s_cbranch_scc1 LF_p1_done
    s_sleep 4
    s_add_u32 s61, s61, 1
    s_cmp_lt_u32 s61, 0x200000
    s_cbranch_scc1 LF_p1
LF_p1_done:
LF_np1:
    s_barrier
    s_branch L_ph2
L_cons:
    s_sub_u32 s62, s2, 72
    s_mov_b32 s32, s16
    s_mov_b32 s33, s17
    s_mov_b32 s34, 3919104
    s_mov_b32 s35, 0x00020000
    s_mov_b32 s36, s30
    s_mov_b32 s37, s31
    s_mov_b32 s38, 4194304
    s_mov_b32 s39, 0x00020000
    s_add_u32 s40, s30, 4194304
    s_addc_u32 s41, s31, 0
    s_mov_b32 s42, 3919104
    s_mov_b32 s43, 0x00020000
    s_add_u32 s44, s30, 9437184
    s_addc_u32 s45, s31, 0
    s_mov_b32 s46, 3919104
    s_mov_b32 s47, 0x00020000
    s_add_u32 s48, s30, 14680064
    s_addc_u32 s49, s31, 0
    s_mov_b32 s50, 3919104
    s_mov_b32 s51, 0x00020000
    v_lshrrev_b32 v4, 3, v1
    s_lshl_b32 s4, s3, 3
    v_add_u32 v4, s4, v4
    v_and_b32 v5, 7, v1
    v_mul_u32_u24 v6, 9363, v4
    v_lshrrev_b32 v6, 16, v6
    v_mul_u32_u24 v7, 7, v6
    v_sub_u32 v7, v4, v7
    s_lshl_b32 s5, s62, 2
    v_add_u32 v6, s5, v6
    v_mul_u32_u24 v7, 729, v7
    v_add_u32 v7, v7, v6
    v_mul_u32_u24 v7, 768, v7
    v_lshl_add_u32 v7, v5, 4, v7
    v_cmp_gt_u32 vcc, 729, v6
    s_mov_b64 s[12:13], vcc
    v_cmp_gt_u32 vcc, 28, v4
    v_mov_b32 v8, 0x7f000000
    s_nop 1
    s_and_b64 vcc, vcc, s[12:13]
    s_nop 1
    v_cndmask_b32 v8, v8, v7, vcc
    buffer_load_dwordx4 v[16:19], v8, s[32:35], 0 offen offset:0
    buffer_load_dwordx4 v[20:23], v8, s[32:35], 0 offen offset:128
    buffer_load_dwordx4 v[24:27], v8, s[32:35], 0 offen offset:256
    buffer_load_dwordx4 v[28:31], v8, s[32:35], 0 offen offset:384
    buffer_load_dwordx4 v[32:35], v8, s[32:35], 0 offen offset:512
    buffer_load_dwordx4 v[36:39], v8, s[32:35], 0 offen offset:640
    v_mul_u32_u24 v9, 784, v4
    v_lshl_add_u32 v9, v5, 4, v9
    v_lshlrev_b32 v10, 4, v1
    s_mul_i32 s6, s3, 73728
    s_mov_b32 s10, 0x3f803f80
    s_mov_b32 s11, 0xffff0000
    v_mov_b32 v64, 0
    v_mov_b32 v65, 0
    v_mov_b32 v66, 0
    v_mov_b32 v67, 0
    s_waitcnt vmcnt(0)
    v_dot2_f32_bf16 v64, v16, s10, v64
    v_dot2_f32_bf16 v66, v16, v16, v66
    v_dot2_f32_bf16 v65, v17, s10, v65
    v_dot2_f32_bf16 v67, v17, v17, v67
    v_dot2_f32_bf16 v64, v18, s10, v64
    v_dot2_f32_bf16 v66, v18, v18, v66
    v_dot2_f32_bf16 v65, v19, s10, v65
    v_dot2_f32_bf16 v67, v19, v19, v67
    v_dot2_f32_bf16 v64, v20, s10, v64
    v_dot2_f32_bf16 v66, v20, v20, v66
    v_dot2_f32_bf16 v65, v21, s10, v65
    v_dot2_f32_bf16 v67, v21, v21, v67
    v_dot2_f32_bf16 v64, v22, s10, v64
    v_dot2_f32_bf16 v66, v22, v22, v66
    v_dot2_f32_bf16 v65, v23, s10, v65
    v_dot2_f32_bf16 v67, v23, v23, v67
    v_dot2_f32_bf16 v64, v24, s10, v64
    v_dot2_f32_bf16 v66, v24, v24, v66
    v_dot2_f32_bf16 v65, v25, s10, v65
    v_dot2_f32_bf16 v67, v25, v25, v67
    v_dot2_f32_bf16 v64, v26, s10, v64
    v_dot2_f32_bf16 v66, v26, v26, v66
    v_dot2_f32_bf16 v65, v27, s10, v65
    v_dot2_f32_bf16 v67, v27, v27, v67
    v_dot2_f32_bf16 v64, v28, s10, v64
    v_dot2_f32_bf16 v66, v28, v28, v66
    v_dot2_f32_bf16 v65, v29, s10, v65
    v_dot2_f32_bf16 v67, v29, v29, v67
    v_dot2_f32_bf16 v64, v30, s10, v64
    v_dot2_f32_bf16 v66, v30, v30, v66
    v_dot2_f32_bf16 v65, v31, s10, v65
    v_dot2_f32_bf16 v67, v31, v31, v67
    v_dot2_f32_bf16 v64, v32, s10, v64
    v_dot2_f32_bf16 v66, v32, v32, v66
    v_dot2_f32_bf16 v65, v33, s10, v65
    v_dot2_f32_bf16 v67, v33, v33, v67
    v_dot2_f32_bf16 v64, v34, s10, v64
    v_dot2_f32_bf16 v66, v34, v34, v66
    v_dot2_f32_bf16 v65, v35, s10, v65
    v_dot2_f32_bf16 v67, v35, v35, v67
    v_dot2_f32_bf16 v64, v36, s10, v64
    v_dot2_f32_bf16 v66, v36, v36, v66
    v_dot2_f32_bf16 v65, v37, s10, v65
    v_dot2_f32_bf16 v67, v37, v37, v67
    v_dot2_f32_bf16 v64, v38, s10, v64
    v_dot2_f32_bf16 v66, v38, v38, v66
    v_dot2_f32_bf16 v65, v39, s10, v65
    v_dot2_f32_bf16 v67, v39, v39, v67
    ds_write_b128 v9, v[16:19] offset:25088
    ds_write_b128 v9, v[20:23] offset:25216
    ds_write_b128 v9, v[24:27] offset:25344
    ds_write_b128 v9, v[28:31] offset:25472
    ds_write_b128 v9, v[32:35] offset:25600
    ds_write_b128 v9, v[36:39] offset:25728
    v_add_f32 v64, v64, v65
    v_add_f32 v66, v66, v67
    s_nop 1
    v_add_f32_dpp v64, v64, v64 quad_perm:[1,0,3,2] row_mask:0xf bank_mask:0xf
    v_add_f32_dpp v66, v66, v66 quad_perm:[1,0,3,2] row_mask:0xf bank_mask:0xf
    s_nop 1
    v_add_f32_dpp v64, v64, v64 quad_perm:[2,3,0,1] row_mask:0xf bank_mask:0xf
    v_add_f32_dpp v66, v66, v66 quad_perm:[2,3,0,1] row_mask:0xf bank_mask:0xf
    s_nop 1
    v_add_f32_dpp v64, v64, v64 row_half_mirror row_mask:0xf bank_mask:0xf
    v_add_f32_dpp v66, v66, v66 row_half_mirror row_mask:0xf bank_mask:0xf
    v_mul_f32 v64, 0x3b2aaaab, v64
    v_mul_f32 v66, 0x3b2aaaab, v66
    v_fma_f32 v66, -v64, v64, v66
    v_max_f32 v66, 0, v66
    v_cvt_pk_bf16_f32 v68, v64, v64
    v_lshlrev_b32 v68, 16, v68
    v_cvt_pk_bf16_f32 v70, v66, v66
    v_lshlrev_b32 v70, 16, v70
    v_add_f32 v70, 0x3727c5ac, v70
    v_cvt_pk_bf16_f32 v70, v70, v70
    v_lshlrev_b32 v70, 16, v70
    v_sqrt_f32 v70, v70
    s_nop 0
    v_cvt_pk_bf16_f32 v70, v70, v70
    v_lshlrev_b32 v70, 16, v70
    v_rcp_f32 v69, v70
    s_nop 0
    v_mul_f32 v68, v68, v69
    v_lshlrev_b32 v72, 16, v16
    v_and_b32 v73, s11, v16
    v_fma_f32 v72, v72, v69, -v68
    v_fma_f32 v73, v73, v69, -v68
    v_cvt_pk_bf16_f32 v40, v72, v73
    v_lshlrev_b32 v72, 16, v17
    v_and_b32 v73, s11, v17
    v_fma_f32 v72, v72, v69, -v68
    v_fma_f32 v73, v73, v69, -v68
    v_cvt_pk_bf16_f32 v41, v72, v73
    v_lshlrev_b32 v72, 16, v18
    v_and_b32 v73, s11, v18
    v_fma_f32 v72, v72, v69, -v68
    v_fma_f32 v73, v73, v69, -v68
    v_cvt_pk_bf16_f32 v42, v72, v73
    v_lshlrev_b32 v72, 16, v19
    v_and_b32 v73, s11, v19
    v_fma_f32 v72, v72, v69, -v68
    v_fma_f32 v73, v73, v69, -v68
    v_cvt_pk_bf16_f32 v43, v72, v73
    v_lshlrev_b32 v72, 16, v20
    v_and_b32 v73, s11, v20
    v_fma_f32 v72, v72, v69, -v68
    v_fma_f32 v73, v73, v69, -v68
    v_cvt_pk_bf16_f32 v44, v72, v73
    v_lshlrev_b32 v72, 16, v21
    v_and_b32 v73, s11, v21
    v_fma_f32 v72, v72, v69, -v68
    v_fma_f32 v73, v73, v69, -v68
    v_cvt_pk_bf16_f32 v45, v72, v73
    v_lshlrev_b32 v72, 16, v22
    v_and_b32 v73, s11, v22
    v_fma_f32 v72, v72, v69, -v68
    v_fma_f32 v73, v73, v69, -v68
    v_cvt_pk_bf16_f32 v46, v72, v73
    v_lshlrev_b32 v72, 16, v23
    v_and_b32 v73, s11, v23
    v_fma_f32 v72, v72, v69, -v68
    v_fma_f32 v73, v73, v69, -v68
    v_cvt_pk_bf16_f32 v47, v72, v73
    v_lshlrev_b32 v72, 16, v24
    v_and_b32 v73, s11, v24
    v_fma_f32 v72, v72, v69, -v68
    v_fma_f32 v73, v73, v69, -v68
    v_cvt_pk_bf16_f32 v48, v72, v73
    v_lshlrev_b32 v72, 16, v25
    v_and_b32 v73, s11, v25
    v_fma_f32 v72, v72, v69, -v68
    v_fma_f32 v73, v73, v69, -v68
    v_cvt_pk_bf16_f32 v49, v72, v73
    v_lshlrev_b32 v72, 16, v26
    v_and_b32 v73, s11, v26
    v_fma_f32 v72, v72, v69, -v68
    v_fma_f32 v73, v73, v69, -v68
    v_cvt_pk_bf16_f32 v50, v72, v73
    v_lshlrev_b32 v72, 16, v27
    v_and_b32 v73, s11, v27
    v_fma_f32 v72, v72, v69, -v68
    v_fma_f32 v73, v73, v69, -v68
    v_cvt_pk_bf16_f32 v51, v72, v73
    v_lshlrev_b32 v72, 16, v28
    v_and_b32 v73, s11, v28
    v_fma_f32 v72, v72, v69, -v68
    v_fma_f32 v73, v73, v69, -v68
    v_cvt_pk_bf16_f32 v52, v72, v73
    v_lshlrev_b32 v72, 16, v29
    v_and_b32 v73, s11, v29
    v_fma_f32 v72, v72, v69, -v68
    v_fma_f32 v73, v73, v69, -v68
    v_cvt_pk_bf16_f32 v53, v72, v73
    v_lshlrev_b32 v72, 16, v30
    v_and_b32 v73, s11, v30
    v_fma_f32 v72, v72, v69, -v68
    v_fma_f32 v73, v73, v69, -v68
    v_cvt_pk_bf16_f32 v54, v72, v73
    v_lshlrev_b32 v72, 16, v31
    v_and_b32 v73, s11, v31
    v_fma_f32 v72, v72, v69, -v68
    v_fma_f32 v73, v73, v69, -v68
    v_cvt_pk_bf16_f32 v55, v72, v73
    v_lshlrev_b32 v72, 16, v32
    v_and_b32 v73, s11, v32
    v_fma_f32 v72, v72, v69, -v68
    v_fma_f32 v73, v73, v69, -v68
    v_cvt_pk_bf16_f32 v56, v72, v73
    v_lshlrev_b32 v72, 16, v33
    v_and_b32 v73, s11, v33
    v_fma_f32 v72, v72, v69, -v68
    v_fma_f32 v73, v73, v69, -v68
    v_cvt_pk_bf16_f32 v57, v72, v73
    v_lshlrev_b32 v72, 16, v34
    v_and_b32 v73, s11, v34
    v_fma_f32 v72, v72, v69, -v68
    v_fma_f32 v73, v73, v69, -v68
    v_cvt_pk_bf16_f32 v58, v72, v73
    v_lshlrev_b32 v72, 16, v35
    v_and_b32 v73, s11, v35
    v_fma_f32 v72, v72, v69, -v68
    v_fma_f32 v73, v73, v69, -v68
    v_cvt_pk_bf16_f32 v59, v72, v73
    v_lshlrev_b32 v72, 16, v36
    v_and_b32 v73, s11, v36
    v_fma_f32 v72, v72, v69, -v68
    v_fma_f32 v73, v73, v69, -v68
    v_cvt_pk_bf16_f32 v60, v72, v73
    v_lshlrev_b32 v72, 16, v37
    v_and_b32 v73, s11, v37
    v_fma_f32 v72, v72, v69, -v68
    v_fma_f32 v73, v73, v69, -v68
    v_cvt_pk_bf16_f32 v61, v72, v73
    v_lshlrev_b32 v72, 16, v38
    v_and_b32 v73, s11, v38
    v_fma_f32 v72, v72, v69, -v68
    v_fma_f32 v73, v73, v69, -v68
    v_cvt_pk_bf16_f32 v62, v72, v73
    v_lshlrev_b32 v72, 16, v39
    v_and_b32 v73, s11, v39
    v_fma_f32 v72, v72, v69, -v68
    v_fma_f32 v73, v73, v69, -v68
    v_cvt_pk_bf16_f32 v63, v72, v73
    ds_write_b128 v9, v[40:43] offset:0
    ds_write_b128 v9, v[44:47] offset:128
    ds_write_b128 v9, v[48:51] offset:256
    ds_write_b128 v9, v[52:55] offset:384
    ds_write_b128 v9, v[56:59] offset:512
    ds_write_b128 v9, v[60:63] offset:640
    v_mul_u32_u24 v11, 784, v2
    v_lshl_add_u32 v12, v3, 4, v11
    s_mul_i32 s8, s3, 192
    v_lshl_add_u32 v13, v3, 3, v11
    v_add_u32 v13, s8, v13
    s_waitcnt lgkmcnt(0)
    s_cmp_lg_u32 s3, 0
    s_cbranch_scc1 L1_np0
    s_cmp_lg_u32 s53, 0
    s_cbranch_scc1 L1_p0z_skip
    v_mov_b32 v245, 0
    s_mov_b32 s61, 0
L1_p0z:
    buffer_load_dword v244, v245, s[64:67], 0 offen sc1
    s_waitcnt vmcnt(0)
    v_readfirstlane_b32 s63, v244
    s_nop 3
    s_cmp_ge_u32 s63, 1
    s_cbranch_scc1 L1_p0z_done
    s_sleep 4
    s_add_u32 s61, s61, 1
    s_cmp_lt_u32 s61, 0x200000
    s_cbranch_scc1 L1_p0z
L1_p0z_done:
    s_mov_b32 s53, 1
L1_p0z_skip:
    s_and_b32 s63, s2, 7
    s_mul_i32 s63, s63, 1024
    s_add_u32 s63, s63, 0
    v_and_b32 v245, 7, v1
    v_lshlrev_b32 v245, 7, v245
    v_add_u32 v245, s63, v245
    s_mov_b32 s61, 0
L1_p0:
    buffer_load_dword v244, v245, s[80:83], 0 offen sc1
    s_waitcnt vmcnt(0)
    v_readlane_b32 s63, v244, 0
    v_readlane_b32 s52, v244, 1
    s_nop 3
    s_add_u32 s63, s63, s52
    v_readlane_b32 s52, v244, 2
    s_nop 3
    s_add_u32 s63, s63, s52
    v_readlane_b32 s52, v244, 3
    s_nop 3
    s_add_u32 s63, s63, s52
    v_readlane_b32 s52, v244, 4
    s_nop 3
    s_add_u32 s63, s63, s52
    v_readlane_b32 s52, v244, 5
    s_nop 3
    s_add_u32 s63, s63, s52
    v_readlane_b32 s52, v244, 6
    s_nop 3
    s_add_u32 s63, s63, s52
    v_readlane_b32 s52, v244, 7
    s_nop 3
    s_add_u32 s63, s63, s52
    s_cmp_ge_u32 s63, 72
    s_cbranch_scc1 L1_p0_done
    s_sleep 4
    s_add_u32 s61, s61, 1
    s_cmp_lt_u32 s61, 0x200000
    s_cbranch_scc1 L1_p0
L1_p0_done:
L1_np0:
    s_barrier
    s_add_u32 s7, s6, 0
    buffer_load_dwordx4 a[0:3], v10, s[36:39], s7 offen offset:0 sc1
    s_add_u32 s7, s6, 24576
    buffer_load_dwordx4 a[4:7], v10, s[36:39], s7 offen offset:0 sc1
    s_add_u32 s7, s6, 49152
    buffer_load_dwordx4 a[8:11], v10, s[36:39], s7 offen offset:0 sc1
    s_add_u32 s7, s6, 0
    buffer_load_dwordx4 a[12:15], v10, s[36:39], s7 offen offset:1024 sc1
    s_add_u32 s7, s6, 24576
    buffer_load_dwordx4 a[16:19], v10, s[36:39], s7 offen offset:1024 sc1
    s_add_u32 s7, s6, 49152
    buffer_load_dwordx4 a[20:23], v10, s[36:39], s7 offen offset:1024 sc1
    s_add_u32 s7, s6, 0
    buffer_load_dwordx4 a[24:27], v10, s[36:39], s7 offen offset:2048 sc1
    s_add_u32 s7, s6, 24576
    buffer_load_dwordx4 a[28:31], v10, s[36:39], s7 offen offset:2048 sc1
    s_lshr_b32 s9, s62, 3
    s_lshl_b32 s9, s9, 2
    s_add_u32 s9, s9, s3
    s_lshl_b32 s52, s9, 10
    s_add_u32 s9, s52, 0
    s_cmp_ge_u32 s9, 294912
    s_cselect_b32 s7, 753664, 0
    s_add_u32 s9, s9, s7
    buffer_load_dwordx4 a[240:243], v10, s[36:39], s9 offen sc1
    s_add_u32 s9, s52, 94208
    s_cmp_ge_u32 s9, 294912
    s_cselect_b32 s7, 753664, 0
    s_add_u32 s9, s9, s7
    buffer_load_dwordx4 a[244:247], v10, s[36:39], s9 offen sc1
    s_add_u32 s9, s52, 188416
    s_cmp_ge_u32 s9, 294912
    s_cselect_b32 s7, 753664, 0
    s_add_u32 s9, s9, s7
    buffer_load_dwordx4 a[248:251], v10, s[36:39], s9 offen sc1
    s_add_u32 s9, s52, 282624
    s_cmp_ge_u32 s9, 294912
    s_cselect_b32 s7, 753664, 0
    s_add_u32 s9, s9, s7
    buffer_load_dwordx4 a[252:255], v10, s[36:39], s9 offen sc1
    s_add_u32 s9, s52, 376832
    s_cmp_ge_u32 s9, 294912
    s_cselect_b32 s7, 753664, 0
    s_add_u32 s9, s9, s7
    buffer_load_dwordx4 a[240:243], v10, s[36:39], s9 offen sc1
    s_add_u32 s9, s52, 471040
    s_cmp_ge_u32 s9, 294912
    s_cselect_b32 s7, 753664, 0
    s_add_u32 s9, s9, s7
    buffer_load_dwordx4 a[244:247], v10, s[36:39], s9 offen sc1
    s_add_u32 s9, s52, 565248
    s_cmp_ge_u32 s9, 294912
    s_cselect_b32 s7, 753664, 0
    s_add_u32 s9, s9, s7
    buffer_load_dwordx4 a[248:251], v10, s[36:39], s9 offen sc1
    s_add_u32 s7, s6, 49152
    buffer_load_dwordx4 a[32:35], v10, s[36:39], s7 offen offset:2048 sc1
    s_add_u32 s7, s6, 0
    buffer_load_dwordx4 a[36:39], v10, s[36:39], s7 offen offset:3072 sc1
    s_add_u32 s7, s6, 24576
    buffer_load_dwordx4 a[40:43], v10, s[36:39], s7 offen offset:3072 sc1
    s_add_u32 s7, s6, 49152
    buffer_load_dwordx4 a[44:47], v10, s[36:39], s7 offen offset:3072 sc1
    s_add_u32 s7, s6, 4096
    buffer_load_dwordx4 a[48:51], v10, s[36:39], s7 offen offset:0 sc1
    s_add_u32 s7, s6, 28672
    buffer_load_dwordx4 a[52:55], v10, s[36:39], s7 offen offset:0 sc1
    s_add_u32 s7, s6, 53248
    buffer_load_dwordx4 a[56:59], v10, s[36:39], s7 offen offset:0 sc1
    s_add_u32 s7, s6, 4096
    buffer_load_dwordx4 a[60:63], v10, s[36:39], s7 offen offset:1024 sc1
    s_add_u32 s7, s6, 28672
    buffer_load_dwordx4 a[64:67], v10, s[36:39], s7 offen offset:1024 sc1
    s_add_u32 s7, s6, 53248
    buffer_load_dwordx4 a[68:71], v10, s[36:39], s7 offen offset:1024 sc1
    s_add_u32 s7, s6, 4096
    buffer_load_dwordx4 a[72:75], v10, s[36:39], s7 offen offset:2048 sc1
    s_add_u32 s7, s6, 28672
    buffer_load_dwordx4 a[76:79], v10, s[36:39], s7 offen offset:2048 sc1
    ds_read_b128 v[64:67], v12 offset:0
    ds_read_b128 v[68:71], v12 offset:32
    ds_read_b128 v[72:75], v12 offset:64
    ds_read_b128 v[76:79], v12 offset:96
    ds_read_b128 v[80:83], v12 offset:128
    ds_read_b128 v[84:87], v12 offset:160
    ds_read_b128 v[88:91], v12 offset:192
    ds_read_b128 v[92:95], v12 offset:224
    s_waitcnt lgkmcnt(7)
    s_waitcnt vmcnt(26)
    v_mfma_f32_32x32x16_bf16 v[96:111], a[0:3], v[64:67], 0
    s_add_u32 s7, s6, 53248
    buffer_load_dwordx4 a[80:83], v10, s[36:39], s7 offen offset:2048 sc1
    s_waitcnt vmcnt(26)
    v_mfma_f32_32x32x16_bf16 v[112:127], a[4:7], v[64:67], 0
    s_add_u32 s7, s6, 4096
    buffer_load_dwordx4 a[84:87], v10, s[36:39], s7 offen offset:3072 sc1
    s_waitcnt vmcnt(26)
    v_mfma_f32_32x32x16_bf16 v[128:143], a[8:11], v[64:67], 0
    s_add_u32 s7, s6, 28672
    buffer_load_dwordx4 a[88:91], v10, s[36:39], s7 offen offset:3072 sc1
    ds_read_b128 v[64:67], v12 offset:256
    s_waitcnt lgkmcnt(7)
    s_waitcnt vmcnt(26)
    v_mfma_f32_32x32x16_bf16 v[96:111], a[12:15], v[68:71], v[96:111]
    s_add_u32 s7, s6, 53248
    buffer_load_dwordx4 a[92:95], v10, s[36:39], s7 offen offset:3072 sc1
    s_waitcnt vmcnt(26)
    v_mfma_f32_32x32x16_bf16 v[112:127], a[16:19], v[68:71], v[112:127]
    s_add_u32 s7, s6, 8192
    buffer_load_dwordx4 a[96:99], v10, s[36:39], s7 offen offset:0 sc1
    s_waitcnt vmcnt(26)
    v_mfma_f32_32x32x16_bf16 v[128:143], a[20:23], v[68:71], v[128:143]
    s_add_u32 s7, s6, 32768
    buffer_load_dwordx4 a[100:103], v10, s[36:39], s7 offen offset:0 sc1
    ds_read_b128 v[68:71], v12 offset:288
    s_waitcnt lgkmcnt(7)
    s_waitcnt vmcnt(26)
    v_mfma_f32_32x32x16_bf16 v[96:111], a[24:27], v[72:75], v[96:111]
    s_add_u32 s7, s6, 57344
    buffer_load_dwordx4 a[104:107], v10, s[36:39], s7 offen offset:0 sc1
    s_waitcnt vmcnt(26)
    v_mfma_f32_32x32x16_bf16 v[112:127], a[28:31], v[72:75], v[112:127]
    s_add_u32 s7, s6, 8192
    buffer_load_dwordx4 a[108:111], v10, s[36:39], s7 offen offset:1024 sc1
    s_waitcnt vmcnt(19)
    v_mfma_f32_32x32x16_bf16 v[128:143], a[32:35], v[72:75], v[128:143]
    s_add_u32 s7, s6, 32768
    buffer_load_dwordx4 a[112:115], v10, s[36:39], s7 offen offset:1024 sc1
    ds_read_b128 v[72:75], v12 offset:320
    s_waitcnt lgkmcnt(7)
    s_waitcnt vmcnt(19)
    v_mfma_f32_32x32x16_bf16 v[96:111], a[36:39], v[76:79], v[96:111]
    s_add_u32 s7, s6, 57344
    buffer_load_dwordx4 a[116:119], v10, s[36:39], s7 offen offset:1024 sc1
    s_waitcnt vmcnt(19)
    v_mfma_f32_32x32x16_bf16 v[112:127], a[40:43], v[76:79], v[112:127]
    s_add_u32 s7, s6, 8192
    buffer_load_dwordx4 a[120:123], v10, s[36:39], s7 offen offset:2048 sc1
    s_waitcnt vmcnt(19)
    v_mfma_f32_32x32x16_bf16 v[128:143], a[44:47], v[76:79], v[128:143]
    s_add_u32 s7, s6, 32768
    buffer_load_dwordx4 a[124:127], v10, s[36:39], s7 offen offset:2048 sc1
    ds_read_b128 v[76:79], v12 offset:352
    s_waitcnt lgkmcnt(7)
    s_waitcnt vmcnt(19)
    v_mfma_f32_32x32x16_bf16 v[96:111], a[48:51], v[80:83], v[96:111]
    s_add_u32 s7, s6, 57344
    buffer_load_dwordx4 a[128:131], v10, s[36:39], s7 offen offset:2048 sc1
    s_waitcnt vmcnt(19)
    v_mfma_f32_32x32x16_bf16 v[112:127], a[52:55], v[80:83], v[112:127]
    s_add_u32 s7, s6, 8192
    buffer_load_dwordx4 a[132:135], v10, s[36:39], s7 offen offset:3072 sc1
    s_waitcnt vmcnt(19)
    v_mfma_f32_32x32x16_bf16 v[128:143], a[56:59], v[80:83], v[128:143]
    s_add_u32 s7, s6, 32768
    buffer_load_dwordx4 a[136:139], v10, s[36:39], s7 offen offset:3072 sc1
    ds_read_b128 v[80:83], v12 offset:384
    s_waitcnt lgkmcnt(7)
    s_waitcnt vmcnt(19)
    v_mfma_f32_32x32x16_bf16 v[96:111], a[60:63], v[84:87], v[96:111]
    s_add_u32 s7, s6, 57344
    buffer_load_dwordx4 a[140:143], v10, s[36:39], s7 offen offset:3072 sc1
    s_waitcnt vmcnt(19)
    v_mfma_f32_32x32x16_bf16 v[112:127], a[64:67], v[84:87], v[112:127]
    s_add_u32 s7, s6, 12288
    buffer_load_dwordx4 a[144:147], v10, s[36:39], s7 offen offset:0 sc1
    s_waitcnt vmcnt(19)
    v_mfma_f32_32x32x16_bf16 v[128:143], a[68:71], v[84:87], v[128:143]
    s_add_u32 s7, s6, 36864
    buffer_load_dwordx4 a[148:151], v10, s[36:39], s7 offen offset:0 sc1
    ds_read_b128 v[84:87], v12 offset:416
    s_waitcnt lgkmcnt(7)
    s_waitcnt vmcnt(19)
    v_mfma_f32_32x32x16_bf16 v[96:111], a[72:75], v[88:91], v[96:111]
    s_add_u32 s7, s6, 61440
    buffer_load_dwordx4 a[152:155], v10, s[36:39], s7 offen offset:0 sc1
    s_waitcnt vmcnt(19)
    v_mfma_f32_32x32x16_bf16 v[112:127], a[76:79], v[88:91], v[112:127]
    s_add_u32 s7, s6, 12288
    buffer_load_dwordx4 a[156:159], v10, s[36:39], s7 offen offset:1024 sc1
    s_waitcnt vmcnt(19)
    v_mfma_f32_32x32x16_bf16 v[128:143], a[80:83], v[88:91], v[128:143]
    s_add_u32 s7, s6, 36864
    buffer_load_dwordx4 a[160:163], v10, s[36:39], s7 offen offset:1024 sc1
    ds_read_b128 v[88:91], v12 offset:448
    s_waitcnt lgkmcnt(7)
    s_waitcnt vmcnt(19)
    v_mfma_f32_32x32x16_bf16 v[96:111], a[84:87], v[92:95], v[96:111]
    s_add_u32 s7, s6, 61440
    buffer_load_dwordx4 a[164:167], v10, s[36:39], s7 offen offset:1024 sc1
    s_waitcnt vmcnt(19)
    v_mfma_f32_32x32x16_bf16 v[112:127], a[88:91], v[92:95], v[112:127]
    s_add_u32 s7, s6, 12288
    buffer_load_dwordx4 a[168:171], v10, s[36:39], s7 offen offset:2048 sc1
    s_waitcnt vmcnt(19)
    v_mfma_f32_32x32x16_bf16 v[128:143], a[92:95], v[92:95], v[128:143]
    s_add_u32 s7, s6, 36864
    buffer_load_dwordx4 a[172:175], v10, s[36:39], s7 offen offset:2048 sc1
    ds_read_b128 v[92:95], v12 offset:480
    s_waitcnt lgkmcnt(7)
    s_waitcnt vmcnt(19)
    v_mfma_f32_32x32x16_bf16 v[96:111], a[96:99], v[64:67], v[96:111]
    s_add_u32 s7, s6, 61440
    buffer_load_dwordx4 a[176:179], v10, s[36:39], s7 offen offset:2048 sc1
    s_waitcnt vmcnt(19)
    v_mfma_f32_32x32x16_bf16 v[112:127], a[100:103], v[64:67], v[112:127]
    s_add_u32 s7, s6, 12288
    buffer_load_dwordx4 a[180:183], v10, s[36:39], s7 offen offset:3072 sc1
    s_waitcnt vmcnt(19)
    v_mfma_f32_32x32x16_bf16 v[128:143], a[104:107], v[64:67], v[128:143]
    s_add_u32 s7, s6, 36864
    buffer_load_dwordx4 a[184:187], v10, s[36:39], s7 offen offset:3072 sc1
    ds_read_b128 v[64:67], v12 offset:512
    s_waitcnt lgkmcnt(7)
    s_waitcnt vmcnt(19)
    v_mfma_f32_32x32x16_bf16 v[96:111], a[108:111], v[68:71], v[96:111]
    s_add_u32 s7, s6, 61440
    buffer_load_dwordx4 a[188:191], v10, s[36:39], s7 offen offset:3072 sc1
    s_waitcnt vmcnt(19)
    v_mfma_f32_32x32x16_bf16 v[112:127], a[112:115], v[68:71], v[112:127]
    s_add_u32 s7, s6, 16384
    buffer_load_dwordx4 a[192:195], v10, s[36:39], s7 offen offset:0 sc1
    s_waitcnt vmcnt(19)
    v_mfma_f32_32x32x16_bf16 v[128:143], a[116:119], v[68:71], v[128:143]
    s_add_u32 s7, s6, 40960
    buffer_load_dwordx4 a[196:199], v10, s[36:39], s7 offen offset:0 sc1
    ds_read_b128 v[68:71], v12 offset:544
    s_waitcnt lgkmcnt(7)
    s_waitcnt vmcnt(19)
    v_mfma_f32_32x32x16_bf16 v[96:111], a[120:123], v[72:75], v[96:111]
    s_add_u32 s7, s6, 65536
    buffer_load_dwordx4 a[200:203], v10, s[36:39], s7 offen offset:0 sc1
    s_waitcnt vmcnt(19)
    v_mfma_f32_32x32x16_bf16 v[112:127], a[124:127], v[72:75], v[112:127]
    s_add_u32 s7, s6, 16384
    buffer_load_dwordx4 a[204:207], v10, s[36:39], s7 offen offset:1024 sc1
    s_waitcnt vmcnt(19)
    v_mfma_f32_32x32x16_bf16 v[128:143], a[128:131], v[72:75], v[128:143]
    s_add_u32 s7, s6, 40960
    buffer_load_dwordx4 a[208:211], v10, s[36:39], s7 offen offset:1024 sc1
    ds_read_b128 v[72:75], v12 offset:576
    s_waitcnt lgkmcnt(7)
    s_waitcnt vmcnt(19)
    v_mfma_f32_32x32x16_bf16 v[96:111], a[132:135], v[76:79], v[96:111]
    s_add_u32 s7, s6, 65536
    buffer_load_dwordx4 a[212:215], v10, s[36:39], s7 offen offset:1024 sc1
    s_waitcnt vmcnt(19)
    v_mfma_f32_32x32x16_bf16 v[112:127], a[136:139], v[76:79], v[112:127]
    s_add_u32 s7, s6, 16384
    buffer_load_dwordx4 a[216:219], v10, s[36:39], s7 offen offset:2048 sc1
    s_waitcnt vmcnt(19)
    v_mfma_f32_32x32x16_bf16 v[128:143], a[140:143], v[76:79], v[128:143]
    s_add_u32 s7, s6, 40960
    buffer_load_dwordx4 a[220:223], v10, s[36:39], s7 offen offset:2048 sc1
    ds_read_b128 v[76:79], v12 offset:608
    s_waitcnt lgkmcnt(7)
    s_waitcnt vmcnt(19)
    v_mfma_f32_32x32x16_bf16 v[96:111], a[144:147], v[80:83], v[96:111]
    s_add_u32 s7, s6, 65536
    buffer_load_dwordx4 a[224:227], v10, s[36:39], s7 offen offset:2048 sc1
    s_waitcnt vmcnt(19)
    v_mfma_f32_32x32x16_bf16 v[112:127], a[148:151], v[80:83], v[112:127]
    s_add_u32 s7, s6, 16384
    buffer_load_dwordx4 a[228:231], v10, s[36:39], s7 offen offset:3072 sc1
    s_waitcnt vmcnt(19)
    v_mfma_f32_32x32x16_bf16 v[128:143], a[152:155], v[80:83], v[128:143]
    s_add_u32 s7, s6, 40960
    buffer_load_dwordx4 a[232:235], v10, s[36:39], s7 offen offset:3072 sc1
    ds_read_b128 v[80:83], v12 offset:640
    s_waitcnt lgkmcnt(7)
    s_waitcnt vmcnt(19)
    v_mfma_f32_32x32x16_bf16 v[96:111], a[156:159], v[84:87], v[96:111]
    s_add_u32 s7, s6, 65536
    buffer_load_dwordx4 a[236:239], v10, s[36:39], s7 offen offset:3072 sc1
    s_waitcnt vmcnt(19)
    v_mfma_f32_32x32x16_bf16 v[112:127], a[160:163], v[84:87], v[112:127]
    s_add_u32 s7, s6, 20480
    buffer_load_dwordx4 a[0:3], v10, s[36:39], s7 offen offset:0 sc1
    s_waitcnt vmcnt(19)
    v_mfma_f32_32x32x16_bf16 v[128:143], a[164:167], v[84:87], v[128:143]
    s_add_u32 s7, s6, 45056
    buffer_load_dwordx4 a[4:7], v10, s[36:39], s7 offen offset:0 sc1
    ds_read_b128 v[84:87], v12 offset:672
    s_waitcnt lgkmcnt(7)
    s_waitcnt vmcnt(19)
    v_mfma_f32_32x32x16_bf16 v[96:111], a[168:171], v[88:91], v[96:111]
    s_add_u32 s7, s6, 69632
    buffer_load_dwordx4 a[8:11], v10, s[36:39], s7 offen offset:0 sc1
    s_waitcnt vmcnt(19)
    v_mfma_f32_32x32x16_bf16 v[112:127], a[172:175], v[88:91], v[112:127]
    s_add_u32 s7, s6, 20480
    buffer_load_dwordx4 a[12:15], v10, s[36:39], s7 offen offset:1024 sc1
    s_waitcnt vmcnt(19)
    v_mfma_f32_32x32x16_bf16 v[128:143], a[176:179], v[88:91], v[128:143]
    s_add_u32 s7, s6, 45056
    buffer_load_dwordx4 a[16:19], v10, s[36:39], s7 offen offset:1024 sc1
    ds_read_b128 v[88:91], v12 offset:704
    s_waitcnt lgkmcnt(7)
    s_waitcnt vmcnt(19)
    v_mfma_f32_32x32x16_bf16 v[96:111], a[180:183], v[92:95], v[96:111]
    s_add_u32 s7, s6, 69632
    buffer_load_dwordx4 a[20:23], v10, s[36:39], s7 offen offset:1024 sc1
    s_waitcnt vmcnt(19)
    v_mfma_f32_32x32x16_bf16 v[112:127], a[184:187], v[92:95], v[112:127]
    s_add_u32 s7, s6, 20480
    buffer_load_dwordx4 a[24:27], v10, s[36:39], s7 offen offset:2048 sc1
    s_waitcnt vmcnt(19)
    v_mfma_f32_32x32x16_bf16 v[128:143], a[188:191], v[92:95], v[128:143]
    s_add_u32 s7, s6, 45056
    buffer_load_dwordx4 a[28:31], v10, s[36:39], s7 offen offset:2048 sc1
    ds_read_b128 v[92:95], v12 offset:736
    s_waitcnt lgkmcnt(7)
    s_waitcnt vmcnt(19)
    v_mfma_f32_32x32x16_bf16 v[96:111], a[192:195], v[64:67], v[96:111]
    s_add_u32 s7, s6, 69632
    buffer_load_dwordx4 a[32:35], v10, s[36:39], s7 offen offset:2048 sc1
    s_waitcnt vmcnt(19)
    v_mfma_f32_32x32x16_bf16 v[112:127], a[196:199], v[64:67], v[112:127]
    s_add_u32 s7, s6, 20480
    buffer_load_dwordx4 a[36:39], v10, s[36:39], s7 offen offset:3072 sc1
    s_waitcnt vmcnt(19)
    v_mfma_f32_32x32x16_bf16 v[128:143], a[200:203], v[64:67], v[128:143]
    s_add_u32 s7, s6, 45056
    buffer_load_dwordx4 a[40:43], v10, s[36:39], s7 offen offset:3072 sc1
    s_waitcnt lgkmcnt(6)
    s_waitcnt vmcnt(19)
    v_mfma_f32_32x32x16_bf16 v[96:111], a[204:207], v[68:71], v[96:111]
    s_add_u32 s7, s6, 69632
    buffer_load_dwordx4 a[44:47], v10, s[36:39], s7 offen offset:3072 sc1
    s_waitcnt vmcnt(19)
    v_mfma_f32_32x32x16_bf16 v[112:127], a[208:211], v[68:71], v[112:127]
    s_add_u32 s7, s6, 1048576
    buffer_load_dwordx4 a[48:51], v10, s[36:39], s7 offen offset:0 sc1
    s_waitcnt vmcnt(19)
    v_mfma_f32_32x32x16_bf16 v[128:143], a[212:215], v[68:71], v[128:143]
    s_add_u32 s7, s6, 1073152
    buffer_load_dwordx4 a[52:55], v10, s[36:39], s7 offen offset:0 sc1
    s_waitcnt lgkmcnt(5)
    s_waitcnt vmcnt(19)
    v_mfma_f32_32x32x16_bf16 v[96:111], a[216:219], v[72:75], v[96:111]
    s_add_u32 s7, s6, 1097728
    buffer_load_dwordx4 a[56:59], v10, s[36:39], s7 offen offset:0 sc1
    s_waitcnt vmcnt(19)
    v_mfma_f32_32x32x16_bf16 v[112:127], a[220:223], v[72:75], v[112:127]
    s_add_u32 s7, s6, 1048576
    buffer_load_dwordx4 a[60:63], v10, s[36:39], s7 offen offset:1024 sc1
    s_waitcnt vmcnt(19)
    v_mfma_f32_32x32x16_bf16 v[128:143], a[224:227], v[72:75], v[128:143]
    s_add_u32 s7, s6, 1073152
    buffer_load_dwordx4 a[64:67], v10, s[36:39], s7 offen offset:1024 sc1
    s_waitcnt lgkmcnt(4)
    s_waitcnt vmcnt(19)
    v_mfma_f32_32x32x16_bf16 v[96:111], a[228:231], v[76:79], v[96:111]
    s_add_u32 s7, s6, 1097728
    buffer_load_dwordx4 a[68:71], v10, s[36:39], s7 offen offset:1024 sc1
    s_waitcnt vmcnt(19)
    v_mfma_f32_32x32x16_bf16 v[112:127], a[232:235], v[76:79], v[112:127]
    s_add_u32 s7, s6, 1048576
    buffer_load_dwordx4 a[72:75], v10, s[36:39], s7 offen offset:2048 sc1
    s_waitcnt vmcnt(19)
    v_mfma_f32_32x32x16_bf16 v[128:143], a[236:239], v[76:79], v[128:143]
    s_add_u32 s7, s6, 1073152
    buffer_load_dwordx4 a[76:79], v10, s[36:39], s7 offen offset:2048 sc1
    s_waitcnt lgkmcnt(3)
    s_waitcnt vmcnt(19)
    v_mfma_f32_32x32x16_bf16 v[96:111], a[0:3], v[80:83], v[96:111]
    s_add_u32 s7, s6, 1097728
    buffer_load_dwordx4 a[80:83], v10, s[36:39], s7 offen offset:2048 sc1
    s_waitcnt vmcnt(19)
    v_mfma_f32_32x32x16_bf16 v[112:127], a[4:7], v[80:83], v[112:127]
    s_add_u32 s7, s6, 1048576
    buffer_load_dwordx4 a[84:87], v10, s[36:39], s7 offen offset:3072 sc1
    s_waitcnt vmcnt(19)
    v_mfma_f32_32x32x16_bf16 v[128:143], a[8:11], v[80:83], v[128:143]
    s_add_u32 s7, s6, 1073152
    buffer_load_dwordx4 a[88:91], v10, s[36:39], s7 offen offset:3072 sc1
    s_waitcnt lgkmcnt(2)
    s_waitcnt vmcnt(19)
    v_mfma_f32_32x32x16_bf16 v[96:111], a[12:15], v[84:87], v[96:111]
    s_add_u32 s7, s6, 1097728
    buffer_load_dwordx4 a[92:95], v10, s[36:39], s7 offen offset:3072 sc1
    s_waitcnt vmcnt(19)
    v_mfma_f32_32x32x16_bf16 v[112:127], a[16:19], v[84:87], v[112:127]
    s_add_u32 s7, s6, 1052672
    buffer_load_dwordx4 a[96:99], v10, s[36:39], s7 offen offset:0 sc1
    s_waitcnt vmcnt(19)
    v_mfma_f32_32x32x16_bf16 v[128:143], a[20:23], v[84:87], v[128:143]
    s_add_u32 s7, s6, 1077248
    buffer_load_dwordx4 a[100:103], v10, s[36:39], s7 offen offset:0 sc1
    s_waitcnt lgkmcnt(1)
    s_waitcnt vmcnt(19)
    v_mfma_f32_32x32x16_bf16 v[96:111], a[24:27], v[88:91], v[96:111]
    s_add_u32 s7, s6, 1101824
    buffer_load_dwordx4 a[104:107], v10, s[36:39], s7 offen offset:0 sc1
    s_waitcnt vmcnt(19)
    v_mfma_f32_32x32x16_bf16 v[112:127], a[28:31], v[88:91], v[112:127]
    s_add_u32 s7, s6, 1052672
    buffer_load_dwordx4 a[108:111], v10, s[36:39], s7 offen offset:1024 sc1
    s_waitcnt vmcnt(19)
    v_mfma_f32_32x32x16_bf16 v[128:143], a[32:35], v[88:91], v[128:143]
    s_add_u32 s7, s6, 1077248
    buffer_load_dwordx4 a[112:115], v10, s[36:39], s7 offen offset:1024 sc1
    s_waitcnt lgkmcnt(0)
    s_waitcnt vmcnt(19)
    v_mfma_f32_32x32x16_bf16 v[96:111], a[36:39], v[92:95], v[96:111]
    s_add_u32 s7, s6, 1101824
    buffer_load_dwordx4 a[116:119], v10, s[36:39], s7 offen offset:1024 sc1
    s_waitcnt vmcnt(19)
    v_mfma_f32_32x32x16_bf16 v[112:127], a[40:43], v[92:95], v[112:127]
    s_add_u32 s7, s6, 1052672
    buffer_load_dwordx4 a[120:123], v10, s[36:39], s7 offen offset:2048 sc1
    s_waitcnt vmcnt(19)
    v_mfma_f32_32x32x16_bf16 v[128:143], a[44:47], v[92:95], v[128:143]
    s_add_u32 s7, s6, 1077248
    buffer_load_dwordx4 a[124:127], v10, s[36:39], s7 offen offset:2048 sc1
    s_nop 15
    s_and_b32 s9, s2, 7
    s_mul_i32 s9, s9, 1024
    s_add_u32 s9, s9, 8192
    v_and_b32 v63, 7, v1
    v_lshlrev_b32 v63, 7, v63
    v_add_u32 v63, s9, v63
    buffer_load_dword v62, v63, s[80:83], 0 offen sc1
    ds_read2_b64 v[64:67], v13 offset0:0 offset1:2
    ds_read2_b64 v[68:71], v13 offset0:4 offset1:6
    ds_read2_b64 v[72:75], v13 offset0:8 offset1:10
    ds_read2_b64 v[76:79], v13 offset0:12 offset1:14
    ds_read2_b64 v[80:83], v13 offset0:16 offset1:18
    ds_read2_b64 v[84:87], v13 offset0:20 offset1:22
    v_cvt_pk_bf16_f32 v144, v96, v97
    v_cvt_pk_bf16_f32 v145, v98, v99
    v_cvt_pk_bf16_f32 v146, v100, v101
    v_cvt_pk_bf16_f32 v147, v102, v103
    v_cvt_pk_bf16_f32 v148, v104, v105
    v_cvt_pk_bf16_f32 v149, v106, v107
    v_cvt_pk_bf16_f32 v150, v108, v109
    v_cvt_pk_bf16_f32 v151, v110, v111
    s_add_u32 s7, s6, 1101824
    buffer_load_dwordx4 a[128:131], v10, s[36:39], s7 offen offset:2048 sc1
    v_cvt_pk_bf16_f32 v152, v112, v113
    v_cvt_pk_bf16_f32 v153, v114, v115
    v_cvt_pk_bf16_f32 v154, v116, v117
    v_cvt_pk_bf16_f32 v155, v118, v119
    v_cvt_pk_bf16_f32 v156, v120, v121
    v_cvt_pk_bf16_f32 v157, v122, v123
    v_cvt_pk_bf16_f32 v158, v124, v125
    v_cvt_pk_bf16_f32 v159, v126, v127
    s_add_u32 s7, s6, 1052672
    buffer_load_dwordx4 a[132:135], v10, s[36:39], s7 offen offset:3072 sc1
    v_cvt_pk_bf16_f32 v160, v128, v129
    v_cvt_pk_bf16_f32 v161, v130, v131
    v_cvt_pk_bf16_f32 v162, v132, v133
    v_cvt_pk_bf16_f32 v163, v134, v135
    v_cvt_pk_bf16_f32 v164, v136, v137
    v_cvt_pk_bf16_f32 v165, v138, v139
    v_cvt_pk_bf16_f32 v166, v140, v141
    v_cvt_pk_bf16_f32 v167, v142, v143
    s_add_u32 s7, s6, 1077248
    buffer_load_dwordx4 a[136:139], v10, s[36:39], s7 offen offset:3072 sc1
    s_waitcnt lgkmcnt(0)
    s_nop 1
    v_mfma_f32_32x32x16_bf16 v[168:183], v[64:67], v[144:147], 0
    v_mfma_f32_32x32x16_bf16 v[168:183], v[68:71], v[148:151], v[168:183]
    v_mfma_f32_32x32x16_bf16 v[168:183], v[72:75], v[152:155], v[168:183]
    v_mfma_f32_32x32x16_bf16 v[168:183], v[76:79], v[156:159], v[168:183]
    v_mfma_f32_32x32x16_bf16 v[168:183], v[80:83], v[160:163], v[168:183]
    v_mfma_f32_32x32x16_bf16 v[168:183], v[84:87], v[164:167], v[168:183]
    s_lshl_b32 s9, s3, 12
    s_add_u32 s9, s9, 50176
    v_add_u32 v14, s9, v10
    v_add_u32 v15, 50176, v10
    s_nop 15
    ds_write_b128 v14, v[168:171] offset:0
    ds_write_b128 v14, v[172:175] offset:1024
    ds_write_b128 v14, v[176:179] offset:2048
    ds_write_b128 v14, v[180:183] offset:3072
    s_waitcnt lgkmcnt(0)
    s_barrier
    ds_read_b128 v[184:187], v15 offset:0
    ds_read_b128 v[188:191], v15 offset:1024
    ds_read_b128 v[192:195], v15 offset:2048
    ds_read_b128 v[196:199], v15 offset:3072
    ds_read_b128 v[200:203], v15 offset:4096
    ds_read_b128 v[204:207], v15 offset:5120
    ds_read_b128 v[208:211], v15 offset:6144
    ds_read_b128 v[212:215], v15 offset:7168
    ds_read_b128 v[216:219], v15 offset:8192
    ds_read_b128 v[220:223], v15 offset:9216
    ds_read_b128 v[224:227], v15 offset:10240
    ds_read_b128 v[228:231], v15 offset:11264
    ds_read_b128 v[232:235], v15 offset:12288
    ds_read_b128 v[236:239], v15 offset:13312
    ds_read_b128 v[240:243], v15 offset:14336
    ds_read_b128 v[244:247], v15 offset:15360
    v_mul_u32_u24 v4, 9363, v2
    v_lshrrev_b32 v4, 16, v4
    v_mul_u32_u24 v4, 7, v4
    v_lshlrev_b32 v5, 2, v3
    v_sub_u32 v4, v4, v5
    v_mov_b32 v5, 0xff800000
    s_waitcnt lgkmcnt(0)
    v_add_f32 v184, v184, v200
    v_add_f32 v216, v216, v232
    v_add_f32 v185, v185, v201
    v_add_f32 v217, v217, v233
    v_add_f32 v186, v186, v202
    v_add_f32 v218, v218, v234
    v_add_f32 v187, v187, v203
    v_add_f32 v219, v219, v235
    s_add_u32 s7, s6, 1101824
    buffer_load_dwordx4 a[140:143], v10, s[36:39], s7 offen offset:3072 sc1
    v_add_f32 v188, v188, v204
    v_add_f32 v220, v220, v236
    v_add_f32 v189, v189, v205
    v_add_f32 v221, v221, v237
    v_add_f32 v190, v190, v206
    v_add_f32 v222, v222, v238
    v_add_f32 v191, v191, v207
    v_add_f32 v223, v223, v239
    s_add_u32 s7, s6, 1056768
    buffer_load_dwordx4 a[144:147], v10, s[36:39], s7 offen offset:0 sc1
    v_add_f32 v192, v192, v208
    v_add_f32 v224, v224, v240
    v_add_f32 v193, v193, v209
    v_add_f32 v225, v225, v241
    v_add_f32 v194, v194, v210
    v_add_f32 v226, v226, v242
    v_add_f32 v195, v195, v211
    v_add_f32 v227, v227, v243
    s_add_u32 s7, s6, 1081344
    buffer_load_dwordx4 a[148:151], v10, s[36:39], s7 offen offset:0 sc1
    v_add_f32 v196, v196, v212
    v_add_f32 v228, v228, v244
    v_add_f32 v197, v197, v213
    v_add_f32 v229, v229, v245
    v_add_f32 v198, v198, v214
    v_add_f32 v230, v230, v246
    v_add_f32 v199, v199, v215
    v_add_f32 v231, v231, v247
    s_add_u32 s7, s6, 1105920
    buffer_load_dwordx4 a[152:155], v10, s[36:39], s7 offen offset:0 sc1
    v_add_f32 v168, v184, v216
    v_add_f32 v169, v185, v217
    v_add_f32 v170, v186, v218
    v_add_f32 v171, v187, v219
    v_add_f32 v172, v188, v220
    v_add_f32 v173, v189, v221
    v_add_f32 v174, v190, v222
    v_add_f32 v175, v191, v223
    s_add_u32 s7, s6, 1056768
    buffer_load_dwordx4 a[156:159], v10, s[36:39], s7 offen offset:1024 sc1
    v_add_f32 v176, v192, v224
    v_add_f32 v177, v193, v225
    v_add_f32 v178, v194, v226
    v_add_f32 v179, v195, v227
    v_add_f32 v180, v196, v228
    v_add_f32 v181, v197, v229
    v_add_f32 v182, v198, v230
    v_add_f32 v183, v199, v231
    s_add_u32 s7, s6, 1081344
    buffer_load_dwordx4 a[160:163], v10, s[36:39], s7 offen offset:1024 sc1
    v_sub_u32 v6, 0, v4
    v_cmp_gt_u32 vcc, 7, v6
    s_nop 1
    v_cndmask_b32 v168, v5, v168, vcc
    v_sub_u32 v6, 1, v4
    v_cmp_gt_u32 vcc, 7, v6
    s_nop 1
    v_cndmask_b32 v169, v5, v169, vcc
    s_add_u32 s7, s6, 1105920
    buffer_load_dwordx4 a[164:167], v10, s[36:39], s7 offen offset:1024 sc1
    v_sub_u32 v6, 2, v4
    v_cmp_gt_u32 vcc, 7, v6
    s_nop 1
    v_cndmask_b32 v170, v5, v170, vcc
    v_sub_u32 v6, 3, v4
    v_cmp_gt_u32 vcc, 7, v6
    s_nop 1
    v_cndmask_b32 v171, v5, v171, vcc
    s_add_u32 s7, s6, 1056768
    buffer_load_dwordx4 a[168:171], v10, s[36:39], s7 offen offset:2048 sc1
    v_sub_u32 v6, 8, v4
    v_cmp_gt_u32 vcc, 7, v6
    s_nop 1
    v_cndmask_b32 v172, v5, v172, vcc
    v_sub_u32 v6, 9, v4
    v_cmp_gt_u32 vcc, 7, v6
    s_nop 1
    v_cndmask_b32 v173, v5, v173, vcc
    s_add_u32 s7, s6, 1081344
    buffer_load_dwordx4 a[172:175], v10, s[36:39], s7 offen offset:2048 sc1
    v_sub_u32 v6, 10, v4
    v_cmp_gt_u32 vcc, 7, v6
    s_nop 1
    v_cndmask_b32 v174, v5, v174, vcc
    v_sub_u32 v6, 11, v4
    v_cmp_gt_u32 vcc, 7, v6
    s_nop 1
    v_cndmask_b32 v175, v5, v175, vcc
    s_add_u32 s7, s6, 1105920
    buffer_load_dwordx4 a[176:179], v10, s[36:39], s7 offen offset:2048 sc1
    v_sub_u32 v6, 16, v4
    v_cmp_gt_u32 vcc, 7, v6
    s_nop 1
    v_cndmask_b32 v176, v5, v176, vcc
    v_sub_u32 v6, 17, v4
    v_cmp_gt_u32 vcc, 7, v6
    s_nop 1
    v_cndmask_b32 v177, v5, v177, vcc
    s_add_u32 s7, s6, 1056768
    buffer_load_dwordx4 a[180:183], v10, s[36:39], s7 offen offset:3072 sc1
    v_sub_u32 v6, 18, v4
    v_cmp_gt_u32 vcc, 7, v6
    s_nop 1
    v_cndmask_b32 v178, v5, v178, vcc
    v_sub_u32 v6, 19, v4
    v_cmp_gt_u32 vcc, 7, v6
    s_nop 1
    v_cndmask_b32 v179, v5, v179, vcc
    s_add_u32 s7, s6, 1081344
    buffer_load_dwordx4 a[184:187], v10, s[36:39], s7 offen offset:3072 sc1
    v_sub_u32 v6, 24, v4
    v_cmp_gt_u32 vcc, 7, v6
    s_nop 1
    v_cndmask_b32 v180, v5, v180, vcc
    v_sub_u32 v6, 25, v4
    v_cmp_gt_u32 vcc, 7, v6
    s_nop 1
    v_cndmask_b32 v181, v5, v181, vcc
    s_add_u32 s7, s6, 1105920
    buffer_load_dwordx4 a[188:191], v10, s[36:39], s7 offen offset:3072 sc1
    v_sub_u32 v6, 26, v4
    v_cmp_gt_u32 vcc, 7, v6
    s_nop 1
    v_cndmask_b32 v182, v5, v182, vcc
    v_sub_u32 v6, 27, v4
    v_cmp_gt_u32 vcc, 7, v6
    s_nop 1
    v_cndmask_b32 v183, v5, v183, vcc
    s_add_u32 s7, s6, 1060864
    buffer_load_dwordx4 a[192:195], v10, s[36:39], s7 offen offset:0 sc1
    v_max3_f32 v6, v168, v169, v170
    v_max3_f32 v6, v6, v171, v172
    v_max3_f32 v6, v6, v173, v174
    v_max3_f32 v6, v6, v175, v176
    v_max3_f32 v6, v6, v177, v178
    v_max3_f32 v6, v6, v179, v180
    v_max3_f32 v6, v6, v181, v182
    v_max_f32 v6, v6, v183
    v_mov_b32 v7, v6
    s_nop 1
    v_permlane32_swap_b32 v6, v7
    s_nop 1
    v_max_f32 v6, v6, v7
    v_max_f32 v6, 0xff7fffff, v6
    v_sub_f32 v168, v168, v6
    v_sub_f32 v169, v169, v6
    v_sub_f32 v170, v170, v6
    v_sub_f32 v171, v171, v6
    v_sub_f32 v172, v172, v6
    v_sub_f32 v173, v173, v6
    v_sub_f32 v174, v174, v6
    v_sub_f32 v175, v175, v6
    s_add_u32 s7, s6, 1085440
    buffer_load_dwordx4 a[196:199], v10, s[36:39], s7 offen offset:0 sc1
    v_sub_f32 v176, v176, v6
    v_sub_f32 v177, v177, v6
    v_sub_f32 v178, v178, v6
    v_sub_f32 v179, v179, v6
    v_sub_f32 v180, v180, v6
    v_sub_f32 v181, v181, v6
    v_sub_f32 v182, v182, v6
    v_sub_f32 v183, v183, v6
    s_add_u32 s7, s6, 1110016
    buffer_load_dwordx4 a[200:203], v10, s[36:39], s7 offen offset:0 sc1
    v_exp_f32 v168, v168
    v_exp_f32 v169, v169
    v_exp_f32 v170, v170
    v_exp_f32 v171, v171
    s_add_u32 s7, s6, 1060864
    buffer_load_dwordx4 a[204:207], v10, s[36:39], s7 offen offset:1024 sc1
    v_exp_f32 v172, v172
    v_exp_f32 v173, v173
    v_exp_f32 v174, v174
    v_exp_f32 v175, v175
    s_add_u32 s7, s6, 1085440
    buffer_load_dwordx4 a[208:211], v10, s[36:39], s7 offen offset:1024 sc1
    v_exp_f32 v176, v176
    v_exp_f32 v177, v177
    v_exp_f32 v178, v178
    v_exp_f32 v179, v179
    s_add_u32 s7, s6, 1110016
    buffer_load_dwordx4 a[212:215], v10, s[36:39], s7 offen offset:1024 sc1
    v_exp_f32 v180, v180
    v_exp_f32 v181, v181
    v_exp_f32 v182, v182
    v_exp_f32 v183, v183
    s_add_u32 s7, s6, 1060864
    buffer_load_dwordx4 a[216:219], v10, s[36:39], s7 offen offset:2048 sc1
    s_nop 0
    v_add_f32 v6, v168, v169
    v_add_f32 v6, v6, v170
    v_add_f32 v6, v6, v171
    v_add_f32 v6, v6, v172
    v_add_f32 v6, v6, v173
    v_add_f32 v6, v6, v174
    v_add_f32 v6, v6, v175
    s_add_u32 s7, s6, 1085440
    buffer_load_dwordx4 a[220:223], v10, s[36:39], s7 offen offset:2048 sc1
    v_add_f32 v6, v6, v176
    v_add_f32 v6, v6, v177
    v_add_f32 v6, v6, v178
    v_add_f32 v6, v6, v179
    v_add_f32 v6, v6, v180
    v_add_f32 v6, v6, v181
    v_add_f32 v6, v6, v182
    v_add_f32 v6, v6, v183
    s_add_u32 s7, s6, 1110016
    buffer_load_dwordx4 a[224:227], v10, s[36:39], s7 offen offset:2048 sc1
    v_mov_b32 v7, v6
    s_nop 1
    v_permlane32_swap_b32 v6, v7
    s_nop 1
    v_add_f32 v6, v6, v7
    v_rcp_f32 v6, v6
    s_nop 0
    v_mul_f32 v168, v168, v6
    v_mul_f32 v169, v169, v6
    v_mul_f32 v170, v170, v6
    v_mul_f32 v171, v171, v6
    v_mul_f32 v172, v172, v6
    v_mul_f32 v173, v173, v6
    v_mul_f32 v174, v174, v6
    v_mul_f32 v175, v175, v6
    s_add_u32 s7, s6, 1060864
    buffer_load_dwordx4 a[228:231], v10, s[36:39], s7 offen offset:3072 sc1
    v_mul_f32 v176, v176, v6
    v_mul_f32 v177, v177, v6
    v_mul_f32 v178, v178, v6
    v_mul_f32 v179, v179, v6
    v_mul_f32 v180, v180, v6
    v_mul_f32 v181, v181, v6
    v_mul_f32 v182, v182, v6
    v_mul_f32 v183, v183, v6
    s_add_u32 s7, s6, 1085440
    buffer_load_dwordx4 a[232:235], v10, s[36:39], s7 offen offset:3072 sc1
    v_cvt_pk_bf16_f32 v248, v168, v169
    v_cvt_pk_bf16_f32 v249, v170, v171
    v_cvt_pk_bf16_f32 v250, v172, v173
    v_cvt_pk_bf16_f32 v251, v174, v175
    v_cvt_pk_bf16_f32 v252, v176, v177
    v_cvt_pk_bf16_f32 v253, v178, v179
    v_cvt_pk_bf16_f32 v254, v180, v181
    v_cvt_pk_bf16_f32 v255, v182, v183
    s_add_u32 s7, s6, 1110016
    buffer_load_dwordx4 a[236:239], v10, s[36:39], s7 offen offset:3072 sc1
    s_add_u32 s7, s6, 1064960
    buffer_load_dwordx4 a[0:3], v10, s[36:39], s7 offen offset:0 sc1
    v_and_b32 v4, 15, v1
    v_lshrrev_b32 v5, 2, v4
    v_and_b32 v4, 3, v4
    v_lshl_add_u32 v5, v3, 2, v5
    v_mul_u32_u24 v5, 784, v5
    v_lshl_add_u32 v5, v4, 3, v5
    v_bfe_u32 v4, v1, 4, 1
    v_lshl_add_u32 v5, v4, 5, v5
    v_add_u32 v5, s8, v5
    ds_read_b64_tr_b16 v[64:65], v5 offset:0
    ds_read_b64_tr_b16 v[66:67], v5 offset:6272
    ds_read_b64_tr_b16 v[68:69], v5 offset:12544
    ds_read_b64_tr_b16 v[70:71], v5 offset:18816
    ds_read_b64_tr_b16 v[72:73], v5 offset:64
    ds_read_b64_tr_b16 v[74:75], v5 offset:6336
    ds_read_b64_tr_b16 v[76:77], v5 offset:12608
    ds_read_b64_tr_b16 v[78:79], v5 offset:18880
    ds_read_b64_tr_b16 v[80:81], v5 offset:128
    ds_read_b64_tr_b16 v[82:83], v5 offset:6400
    ds_read_b64_tr_b16 v[84:85], v5 offset:12672
    ds_read_b64_tr_b16 v[86:87], v5 offset:18944
    s_waitcnt lgkmcnt(0)
    v_mfma_f32_32x32x16_bf16 v[96:111], v[64:67], v[248:251], 0
    v_mfma_f32_32x32x16_bf16 v[96:111], v[68:71], v[252:255], v[96:111]
    v_mfma_f32_32x32x16_bf16 v[112:127], v[72:75], v[248:251], 0
    v_mfma_f32_32x32x16_bf16 v[112:127], v[76:79], v[252:255], v[112:127]
    v_mfma_f32_32x32x16_bf16 v[128:143], v[80:83], v[248:251], 0
    v_mfma_f32_32x32x16_bf16 v[128:143], v[84:87], v[252:255], v[128:143]
    s_mul_i32 s9, s3, 6144
    s_add_u32 s9, s9, 66560
    v_add_u32 v14, s9, v10
    v_add_u32 v15, 66560, v10
    s_nop 15
    v_cvt_pk_bf16_f32 v144, v96, v97
    v_cvt_pk_bf16_f32 v145, v98, v99
    v_cvt_pk_bf16_f32 v146, v100, v101
    v_cvt_pk_bf16_f32 v147, v102, v103
    v_cvt_pk_bf16_f32 v148, v104, v105
    v_cvt_pk_bf16_f32 v149, v106, v107
    s_add_u32 s7, s6, 1089536
    buffer_load_dwordx4 a[4:7], v10, s[36:39], s7 offen offset:0 sc1
    v_cvt_pk_bf16_f32 v150, v108, v109
    v_cvt_pk_bf16_f32 v151, v110, v111
    v_cvt_pk_bf16_f32 v152, v112, v113
    v_cvt_pk_bf16_f32 v153, v114, v115
    v_cvt_pk_bf16_f32 v154, v116, v117
    v_cvt_pk_bf16_f32 v155, v118, v119
    s_add_u32 s7, s6, 1114112
    buffer_load_dwordx4 a[8:11], v10, s[36:39], s7 offen offset:0 sc1
    v_cvt_pk_bf16_f32 v156, v120, v121
    v_cvt_pk_bf16_f32 v157, v122, v123
    v_cvt_pk_bf16_f32 v158, v124, v125
    v_cvt_pk_bf16_f32 v159, v126, v127
    v_cvt_pk_bf16_f32 v160, v128, v129
    v_cvt_pk_bf16_f32 v161, v130, v131
    s_add_u32 s7, s6, 1064960
    buffer_load_dwordx4 a[12:15], v10, s[36:39], s7 offen offset:1024 sc1
    v_cvt_pk_bf16_f32 v162, v132, v133
    v_cvt_pk_bf16_f32 v163, v134, v135
    v_cvt_pk_bf16_f32 v164, v136, v137
    v_cvt_pk_bf16_f32 v165, v138, v139
    v_cvt_pk_bf16_f32 v166, v140, v141
    v_cvt_pk_bf16_f32 v167, v142, v143
    s_add_u32 s7, s6, 1089536
    buffer_load_dwordx4 a[16:19], v10, s[36:39], s7 offen offset:1024 sc1
    ds_write_b128 v14, v[144:147] offset:0
    ds_write_b128 v14, v[148:151] offset:1024
    ds_write_b128 v14, v[152:155] offset:2048
    ds_write_b128 v14, v[156:159] offset:3072
    ds_write_b128 v14, v[160:163] offset:4096
    ds_write_b128 v14, v[164:167] offset:5120
    s_add_u32 s7, s6, 1114112
    buffer_load_dwordx4 a[20:23], v10, s[36:39], s7 offen offset:1024 sc1
    s_add_u32 s7, s6, 1064960
    buffer_load_dwordx4 a[24:27], v10, s[36:39], s7 offen offset:2048 sc1
    s_add_u32 s7, s6, 1089536
    buffer_load_dwordx4 a[28:31], v10, s[36:39], s7 offen offset:2048 sc1
    s_add_u32 s7, s6, 1114112
    buffer_load_dwordx4 a[32:35], v10, s[36:39], s7 offen offset:2048 sc1
    s_add_u32 s7, s6, 1064960
    buffer_load_dwordx4 a[36:39], v10, s[36:39], s7 offen offset:3072 sc1
    s_add_u32 s7, s6, 1089536
    buffer_load_dwordx4 a[40:43], v10, s[36:39], s7 offen offset:3072 sc1
    s_waitcnt lgkmcnt(0)
    s_barrier
    s_waitcnt vmcnt(39)
    v_readlane_b32 s9, v62, 0
    v_readlane_b32 s7, v62, 1
    s_nop 3
    s_add_u32 s9, s9, s7
    v_readlane_b32 s7, v62, 2
    s_nop 3
    s_add_u32 s9, s9, s7
    v_readlane_b32 s7, v62, 3
    s_nop 3
    s_add_u32 s9, s9, s7
    v_readlane_b32 s7, v62, 4
    s_nop 3
    s_add_u32 s9, s9, s7
    v_readlane_b32 s7, v62, 5
    s_nop 3
    s_add_u32 s9, s9, s7
    v_readlane_b32 s7, v62, 6
    s_nop 3
    s_add_u32 s9, s9, s7
    v_readlane_b32 s7, v62, 7
    s_nop 3
    s_add_u32 s9, s9, s7
    s_cmp_ge_u32 s9, 72
    s_cbranch_scc1 L1_c1ok
    s_cmp_lg_u32 s53, 0
    s_cbranch_scc1 L1_p1z_skip
    v_mov_b32 v245, 0
    s_mov_b32 s61, 0
L1_p1z:
    buffer_load_dword v244, v245, s[64:67], 0 offen sc1
    s_waitcnt vmcnt(0)
    v_readfirstlane_b32 s63, v244
    s_nop 3
    s_cmp_ge_u32 s63, 1
    s_cbranch_scc1 L1_p1z_done
    s_sleep 4
    s_add_u32 s61, s61, 1
    s_cmp_lt_u32 s61, 0x200000
    s_cbranch_scc1 L1_p1z
L1_p1z_done:
    s_mov_b32 s53, 1
L1_p1z_skip:
    s_and_b32 s63, s2, 7
    s_mul_i32 s63, s63, 1024
    s_add_u32 s63, s63, 8192
    v_and_b32 v245, 7, v1
    v_lshlrev_b32 v245, 7, v245
    v_add_u32 v245, s63, v245
    s_mov_b32 s61, 0
L1_p1:
    buffer_load_dword v244, v245, s[80:83], 0 offen sc1
    s_waitcnt vmcnt(0)
    v_readlane_b32 s63, v244, 0
    v_readlane_b32 s52, v244, 1
    s_nop 3
    s_add_u32 s63, s63, s52
    v_readlane_b32 s52, v244, 2
    s_nop 3
    s_add_u32 s63, s63, s52
    v_readlane_b32 s52, v244, 3
    s_nop 3
    s_add_u32 s63, s63, s52
    v_readlane_b32 s52, v244, 4
    s_nop 3
    s_add_u32 s63, s63, s52
    v_readlane_b32 s52, v244, 5
    s_nop 3
    s_add_u32 s63, s63, s52
    v_readlane_b32 s52, v244, 6
    s_nop 3
    s_add_u32 s63, s63, s52
    v_readlane_b32 s52, v244, 7
    s_nop 3
    s_add_u32 s63, s63, s52
    s_cmp_ge_u32 s63, 72
    s_cbranch_scc1 L1_p1_done
    s_sleep 4
    s_add_u32 s61, s61, 1
    s_cmp_lt_u32 s61, 0x200000
    s_cbranch_scc1 L1_p1
L1_p1_done:
L1_c1ok:
    ds_read_b128 v[64:67], v15 offset:0
    ds_read_b128 v[68:71], v15 offset:1024
    ds_read_b128 v[72:75], v15 offset:2048
    ds_read_b128 v[76:79], v15 offset:3072
    ds_read_b128 v[80:83], v15 offset:4096
    ds_read_b128 v[84:87], v15 offset:5120
    ds_read_b128 v[88:91], v15 offset:6144
    ds_read_b128 v[92:95], v15 offset:7168
    s_waitcnt lgkmcnt(7)
    s_waitcnt vmcnt(59)
    v_mfma_f32_32x32x16_bf16 v[96:111], a[48:51], v[64:67], 0
    s_waitcnt vmcnt(58)
    v_mfma_f32_32x32x16_bf16 v[112:127], a[52:55], v[64:67], 0
    s_add_u32 s7, s6, 1114112
    buffer_load_dwordx4 a[44:47], v10, s[36:39], s7 offen offset:3072 sc1
    s_waitcnt vmcnt(58)
    v_mfma_f32_32x32x16_bf16 v[128:143], a[56:59], v[64:67], 0
    ds_read_b128 v[64:67], v15 offset:8192
    s_waitcnt lgkmcnt(7)
    s_waitcnt vmcnt(57)
    v_mfma_f32_32x32x16_bf16 v[96:111], a[60:63], v[68:71], v[96:111]
    s_add_u32 s7, s6, 1069056
    buffer_load_dwordx4 a[48:51], v10, s[36:39], s7 offen offset:0 sc1
    s_waitcnt vmcnt(57)
    v_mfma_f32_32x32x16_bf16 v[112:127], a[64:67], v[68:71], v[112:127]
    s_waitcnt vmcnt(56)
    v_mfma_f32_32x32x16_bf16 v[128:143], a[68:71], v[68:71], v[128:143]
    s_add_u32 s7, s6, 1093632
    buffer_load_dwordx4 a[52:55], v10, s[36:39], s7 offen offset:0 sc1
    ds_read_b128 v[68:71], v15 offset:9216
    s_waitcnt lgkmcnt(7)
    s_waitcnt vmcnt(56)
    v_mfma_f32_32x32x16_bf16 v[96:111], a[72:75], v[72:75], v[96:111]
    s_waitcnt vmcnt(55)
    v_mfma_f32_32x32x16_bf16 v[112:127], a[76:79], v[72:75], v[112:127]
    s_add_u32 s7, s6, 1118208
    buffer_load_dwordx4 a[56:59], v10, s[36:39], s7 offen offset:0 sc1
    s_waitcnt vmcnt(55)
    v_mfma_f32_32x32x16_bf16 v[128:143], a[80:83], v[72:75], v[128:143]
    ds_read_b128 v[72:75], v15 offset:10240
    s_waitcnt lgkmcnt(7)
    s_waitcnt vmcnt(54)
    v_mfma_f32_32x32x16_bf16 v[96:111], a[84:87], v[76:79], v[96:111]
    s_add_u32 s7, s6, 1069056
    buffer_load_dwordx4 a[60:63], v10, s[36:39], s7 offen offset:1024 sc1
    s_waitcnt vmcnt(54)
    v_mfma_f32_32x32x16_bf16 v[112:127], a[88:91], v[76:79], v[112:127]
    s_waitcnt vmcnt(53)
    v_mfma_f32_32x32x16_bf16 v[128:143], a[92:95], v[76:79], v[128:143]
    s_add_u32 s7, s6, 1093632
    buffer_load_dwordx4 a[64:67], v10, s[36:39], s7 offen offset:1024 sc1
    ds_read_b128 v[76:79], v15 offset:11264
    s_waitcnt lgkmcnt(7)
    s_waitcnt vmcnt(53)
    v_mfma_f32_32x32x16_bf16 v[96:111], a[96:99], v[80:83], v[96:111]
    s_waitcnt vmcnt(52)
    v_mfma_f32_32x32x16_bf16 v[112:127], a[100:103], v[80:83], v[112:127]
    s_add_u32 s7, s6, 1118208
    buffer_load_dwordx4 a[68:71], v10, s[36:39], s7 offen offset:1024 sc1
    s_waitcnt vmcnt(52)
    v_mfma_f32_32x32x16_bf16 v[128:143], a[104:107], v[80:83], v[128:143]
    ds_read_b128 v[80:83], v15 offset:12288
    s_waitcnt lgkmcnt(7)
    s_waitcnt vmcnt(51)
    v_mfma_f32_32x32x16_bf16 v[96:111], a[108:111], v[84:87], v[96:111]
    s_add_u32 s7, s6, 1069056
    buffer_load_dwordx4 a[72:75], v10, s[36:39], s7 offen offset:2048 sc1
    s_waitcnt vmcnt(51)
    v_mfma_f32_32x32x16_bf16 v[112:127], a[112:115], v[84:87], v[112:127]
    s_waitcnt vmcnt(50)
    v_mfma_f32_32x32x16_bf16 v[128:143], a[116:119], v[84:87], v[128:143]
    s_add_u32 s7, s6, 1093632
    buffer_load_dwordx4 a[76:79], v10, s[36:39], s7 offen offset:2048 sc1
    ds_read_b128 v[84:87], v15 offset:13312
    s_waitcnt lgkmcnt(7)
    s_waitcnt vmcnt(50)
    v_mfma_f32_32x32x16_bf16 v[96:111], a[120:123], v[88:91], v[96:111]
    s_waitcnt vmcnt(49)
    v_mfma_f32_32x32x16_bf16 v[112:127], a[124:127], v[88:91], v[112:127]
    s_add_u32 s7, s6, 1118208
    buffer_load_dwordx4 a[80:83], v10, s[36:39], s7 offen offset:2048 sc1
    s_waitcnt vmcnt(48)
    v_mfma_f32_32x32x16_bf16 v[128:143], a[128:131], v[88:91], v[128:143]
    ds_read_b128 v[88:91], v15 offset:14336
    s_waitcnt lgkmcnt(7)
    s_waitcnt vmcnt(47)
    v_mfma_f32_32x32x16_bf16 v[96:111], a[132:135], v[92:95], v[96:111]
    s_add_u32 s7, s6, 1069056
    buffer_load_dwordx4 a[84:87], v10, s[36:39], s7 offen offset:3072 sc1
    s_waitcnt vmcnt(47)
    v_mfma_f32_32x32x16_bf16 v[112:127], a[136:139], v[92:95], v[112:127]
    s_waitcnt vmcnt(46)
    v_mfma_f32_32x32x16_bf16 v[128:143], a[140:143], v[92:95], v[128:143]
    s_add_u32 s7, s6, 1093632
    buffer_load_dwordx4 a[88:91], v10, s[36:39], s7 offen offset:3072 sc1
    ds_read_b128 v[92:95], v15 offset:15360
    s_waitcnt lgkmcnt(7)
    s_waitcnt vmcnt(46)
    v_mfma_f32_32x32x16_bf16 v[96:111], a[144:147], v[64:67], v[96:111]
    s_waitcnt vmcnt(45)
    v_mfma_f32_32x32x16_bf16 v[112:127], a[148:151], v[64:67], v[112:127]
    s_add_u32 s7, s6, 1118208
    buffer_load_dwordx4 a[92:95], v10, s[36:39], s7 offen offset:3072 sc1
    s_waitcnt vmcnt(45)
    v_mfma_f32_32x32x16_bf16 v[128:143], a[152:155], v[64:67], v[128:143]
    ds_read_b128 v[64:67], v15 offset:16384
    s_waitcnt lgkmcnt(7)
    s_waitcnt vmcnt(44)
    v_mfma_f32_32x32x16_bf16 v[96:111], a[156:159], v[68:71], v[96:111]
    s_waitcnt vmcnt(43)
    v_mfma_f32_32x32x16_bf16 v[112:127], a[160:163], v[68:71], v[112:127]
    s_waitcnt vmcnt(42)
    v_mfma_f32_32x32x16_bf16 v[128:143], a[164:167], v[68:71], v[128:143]
    ds_read_b128 v[68:71], v15 offset:17408
    s_waitcnt lgkmcnt(7)
    s_waitcnt vmcnt(41)
    v_mfma_f32_32x32x16_bf16 v[96:111], a[168:171], v[72:75], v[96:111]
    s_waitcnt vmcnt(40)
    v_mfma_f32_32x32x16_bf16 v[112:127], a[172:175], v[72:75], v[112:127]
    s_waitcnt vmcnt(39)
    v_mfma_f32_32x32x16_bf16 v[128:143], a[176:179], v[72:75], v[128:143]
    ds_read_b128 v[72:75], v15 offset:18432
    s_waitcnt lgkmcnt(7)
    s_waitcnt vmcnt(38)
    v_mfma_f32_32x32x16_bf16 v[96:111], a[180:183], v[76:79], v[96:111]
    s_waitcnt vmcnt(37)
    v_mfma_f32_32x32x16_bf16 v[112:127], a[184:187], v[76:79], v[112:127]
    s_waitcnt vmcnt(36)
    v_mfma_f32_32x32x16_bf16 v[128:143], a[188:191], v[76:79], v[128:143]
    ds_read_b128 v[76:79], v15 offset:19456
    s_waitcnt lgkmcnt(7)
    s_waitcnt vmcnt(35)
    v_mfma_f32_32x32x16_bf16 v[96:111], a[192:195], v[80:83], v[96:111]
    s_waitcnt vmcnt(34)
    v_mfma_f32_32x32x16_bf16 v[112:127], a[196:199], v[80:83], v[112:127]
    s_waitcnt vmcnt(33)
    v_mfma_f32_32x32x16_bf16 v[128:143], a[200:203], v[80:83], v[128:143]
    ds_read_b128 v[80:83], v15 offset:20480
    s_waitcnt lgkmcnt(7)
    s_waitcnt vmcnt(32)
    v_mfma_f32_32x32x16_bf16 v[96:111], a[204:207], v[84:87], v[96:111]
    s_waitcnt vmcnt(31)
    v_mfma_f32_32x32x16_bf16 v[112:127], a[208:211], v[84:87], v[112:127]
    s_waitcnt vmcnt(30)
    v_mfma_f32_32x32x16_bf16 v[128:143], a[212:215], v[84:87], v[128:143]
    ds_read_b128 v[84:87], v15 offset:21504
    s_waitcnt lgkmcnt(7)
    s_waitcnt vmcnt(29)
    v_mfma_f32_32x32x16_bf16 v[96:111], a[216:219], v[88:91], v[96:111]
    s_waitcnt vmcnt(28)
    v_mfma_f32_32x32x16_bf16 v[112:127], a[220:223], v[88:91], v[112:127]
    s_waitcnt vmcnt(27)
    v_mfma_f32_32x32x16_bf16 v[128:143], a[224:227], v[88:91], v[128:143]
    ds_read_b128 v[88:91], v15 offset:22528
    s_waitcnt lgkmcnt(7)
    s_waitcnt vmcnt(26)
    v_mfma_f32_32x32x16_bf16 v[96:111], a[228:231], v[92:95], v[96:111]
    s_waitcnt vmcnt(25)
    v_mfma_f32_32x32x16_bf16 v[112:127], a[232:235], v[92:95], v[112:127]
    s_waitcnt vmcnt(24)
    v_mfma_f32_32x32x16_bf16 v[128:143], a[236:239], v[92:95], v[128:143]
    ds_read_b128 v[92:95], v15 offset:23552
    s_waitcnt lgkmcnt(7)
    s_waitcnt vmcnt(23)
    v_mfma_f32_32x32x16_bf16 v[96:111], a[0:3], v[64:67], v[96:111]
    s_waitcnt vmcnt(22)
    v_mfma_f32_32x32x16_bf16 v[112:127], a[4:7], v[64:67], v[112:127]
    s_waitcnt vmcnt(21)
    v_mfma_f32_32x32x16_bf16 v[128:143], a[8:11], v[64:67], v[128:143]
    s_waitcnt lgkmcnt(6)
    s_waitcnt vmcnt(20)
    v_mfma_f32_32x32x16_bf16 v[96:111], a[12:15], v[68:71], v[96:111]
    s_waitcnt vmcnt(19)
    v_mfma_f32_32x32x16_bf16 v[112:127], a[16:19], v[68:71], v[112:127]
    s_waitcnt vmcnt(18)
    v_mfma_f32_32x32x16_bf16 v[128:143], a[20:23], v[68:71], v[128:143]
    s_waitcnt lgkmcnt(5)
    s_waitcnt vmcnt(17)
    v_mfma_f32_32x32x16_bf16 v[96:111], a[24:27], v[72:75], v[96:111]
    s_waitcnt vmcnt(16)
    v_mfma_f32_32x32x16_bf16 v[112:127], a[28:31], v[72:75], v[112:127]
    s_waitcnt vmcnt(15)
    v_mfma_f32_32x32x16_bf16 v[128:143], a[32:35], v[72:75], v[128:143]
    s_waitcnt lgkmcnt(4)
    s_waitcnt vmcnt(14)
    v_mfma_f32_32x32x16_bf16 v[96:111], a[36:39], v[76:79], v[96:111]
    s_waitcnt vmcnt(13)
    v_mfma_f32_32x32x16_bf16 v[112:127], a[40:43], v[76:79], v[112:127]
    s_waitcnt vmcnt(12)
    v_mfma_f32_32x32x16_bf16 v[128:143], a[44:47], v[76:79], v[128:143]
    s_waitcnt lgkmcnt(3)
    s_waitcnt vmcnt(11)
    v_mfma_f32_32x32x16_bf16 v[96:111], a[48:51], v[80:83], v[96:111]
    s_waitcnt vmcnt(10)
    v_mfma_f32_32x32x16_bf16 v[112:127], a[52:55], v[80:83], v[112:127]
    s_waitcnt vmcnt(9)
    v_mfma_f32_32x32x16_bf16 v[128:143], a[56:59], v[80:83], v[128:143]
    s_waitcnt lgkmcnt(2)
    s_waitcnt vmcnt(8)
    v_mfma_f32_32x32x16_bf16 v[96:111], a[60:63], v[84:87], v[96:111]
    s_waitcnt vmcnt(7)
    v_mfma_f32_32x32x16_bf16 v[112:127], a[64:67], v[84:87], v[112:127]
    s_waitcnt vmcnt(6)
    v_mfma_f32_32x32x16_bf16 v[128:143], a[68:71], v[84:87], v[128:143]
    s_waitcnt lgkmcnt(1)
    s_waitcnt vmcnt(5)
    v_mfma_f32_32x32x16_bf16 v[96:111], a[72:75], v[88:91], v[96:111]
    s_waitcnt vmcnt(4)
    v_mfma_f32_32x32x16_bf16 v[112:127], a[76:79], v[88:91], v[112:127]
    s_waitcnt vmcnt(3)
    v_mfma_f32_32x32x16_bf16 v[128:143], a[80:83], v[88:91], v[128:143]
    s_waitcnt lgkmcnt(0)
    s_waitcnt vmcnt(2)
    v_mfma_f32_32x32x16_bf16 v[96:111], a[84:87], v[92:95], v[96:111]
    s_waitcnt vmcnt(1)
    v_mfma_f32_32x32x16_bf16 v[112:127], a[88:91], v[92:95], v[112:127]
    s_waitcnt vmcnt(0)
    v_mfma_f32_32x32x16_bf16 v[128:143], a[92:95], v[92:95], v[128:143]
    s_nop 15
    ds_read_b64 v[184:185], v13 offset:25088
    ds_read_b64 v[186:187], v13 offset:25104
    ds_read_b64 v[188:189], v13 offset:25120
    ds_read_b64 v[190:191], v13 offset:25136
    ds_read_b64 v[192:193], v13 offset:25152
    ds_read_b64 v[194:195], v13 offset:25168
    ds_read_b64 v[196:197], v13 offset:25184
    ds_read_b64 v[198:199], v13 offset:25200
    ds_read_b64 v[200:201], v13 offset:25216
    ds_read_b64 v[202:203], v13 offset:25232
    ds_read_b64 v[204:205], v13 offset:25248
    ds_read_b64 v[206:207], v13 offset:25264
    v_mov_b32 v6, 0
    v_mov_b32 v7, 0
    s_waitcnt lgkmcnt(0)
    v_lshlrev_b32 v65, 16, v184
    v_and_b32 v66, s11, v184
    v_add_f32 v96, v96, v65
    v_add_f32 v97, v97, v66
    v_cvt_pk_bf16_f32 v184, v96, v97
    v_dot2_f32_bf16 v6, v184, s10, v6
    v_dot2_f32_bf16 v7, v184, v184, v7
    v_lshlrev_b32 v65, 16, v185
    v_and_b32 v66, s11, v185
    v_add_f32 v98, v98, v65
    v_add_f32 v99, v99, v66
    v_cvt_pk_bf16_f32 v185, v98, v99
    v_dot2_f32_bf16 v6, v185, s10, v6
    v_dot2_f32_bf16 v7, v185, v185, v7
    v_lshlrev_b32 v65, 16, v186
    v_and_b32 v66, s11, v186
    v_add_f32 v100, v100, v65
    v_add_f32 v101, v101, v66
    v_cvt_pk_bf16_f32 v186, v100, v101
    v_dot2_f32_bf16 v6, v186, s10, v6
    v_dot2_f32_bf16 v7, v186, v186, v7
    v_lshlrev_b32 v65, 16, v187
    v_and_b32 v66, s11, v187
    v_add_f32 v102, v102, v65
    v_add_f32 v103, v103, v66
    v_cvt_pk_bf16_f32 v187, v102, v103
    v_dot2_f32_bf16 v6, v187, s10, v6
    v_dot2_f32_bf16 v7, v187, v187, v7
    v_lshlrev_b32 v65, 16, v188
    v_and_b32 v66, s11, v188
    v_add_f32 v104, v104, v65
    v_add_f32 v105, v105, v66
    v_cvt_pk_bf16_f32 v188, v104, v105
    v_dot2_f32_bf16 v6, v188, s10, v6
    v_dot2_f32_bf16 v7, v188, v188, v7
    v_lshlrev_b32 v65, 16, v189
    v_and_b32 v66, s11, v189
    v_add_f32 v106, v106, v65
    v_add_f32 v107, v107, v66
    v_cvt_pk_bf16_f32 v189, v106, v107
    v_dot2_f32_bf16 v6, v189, s10, v6
    v_dot2_f32_bf16 v7, v189, v189, v7
    v_lshlrev_b32 v65, 16, v190
    v_and_b32 v66, s11, v190
    v_add_f32 v108, v108, v65
    v_add_f32 v109, v109, v66
    v_cvt_pk_bf16_f32 v190, v108, v109
    v_dot2_f32_bf16 v6, v190, s10, v6
    v_dot2_f32_bf16 v7, v190, v190, v7
    v_lshlrev_b32 v65, 16, v191
    v_and_b32 v66, s11, v191
    v_add_f32 v110, v110, v65
    v_add_f32 v111, v111, v66
    v_cvt_pk_bf16_f32 v191, v110, v111
    v_dot2_f32_bf16 v6, v191, s10, v6
    v_dot2_f32_bf16 v7, v191, v191, v7
    v_lshlrev_b32 v65, 16, v192
    v_and_b32 v66, s11, v192
    v_add_f32 v112, v112, v65
    v_add_f32 v113, v113, v66
    v_cvt_pk_bf16_f32 v192, v112, v113
    v_dot2_f32_bf16 v6, v192, s10, v6
    v_dot2_f32_bf16 v7, v192, v192, v7
    v_lshlrev_b32 v65, 16, v193
    v_and_b32 v66, s11, v193
    v_add_f32 v114, v114, v65
    v_add_f32 v115, v115, v66
    v_cvt_pk_bf16_f32 v193, v114, v115
    v_dot2_f32_bf16 v6, v193, s10, v6
    v_dot2_f32_bf16 v7, v193, v193, v7
    v_lshlrev_b32 v65, 16, v194
    v_and_b32 v66, s11, v194
    v_add_f32 v116, v116, v65
    v_add_f32 v117, v117, v66
    v_cvt_pk_bf16_f32 v194, v116, v117
    v_dot2_f32_bf16 v6, v194, s10, v6
    v_dot2_f32_bf16 v7, v194, v194, v7
    v_lshlrev_b32 v65, 16, v195
    v_and_b32 v66, s11, v195
    v_add_f32 v118, v118, v65
    v_add_f32 v119, v119, v66
    v_cvt_pk_bf16_f32 v195, v118, v119
    v_dot2_f32_bf16 v6, v195, s10, v6
    v_dot2_f32_bf16 v7, v195, v195, v7
    v_lshlrev_b32 v65, 16, v196
    v_and_b32 v66, s11, v196
    v_add_f32 v120, v120, v65
    v_add_f32 v121, v121, v66
    v_cvt_pk_bf16_f32 v196, v120, v121
    v_dot2_f32_bf16 v6, v196, s10, v6
    v_dot2_f32_bf16 v7, v196, v196, v7
    v_lshlrev_b32 v65, 16, v197
    v_and_b32 v66, s11, v197
    v_add_f32 v122, v122, v65
    v_add_f32 v123, v123, v66
    v_cvt_pk_bf16_f32 v197, v122, v123
    v_dot2_f32_bf16 v6, v197, s10, v6
    v_dot2_f32_bf16 v7, v197, v197, v7
    v_lshlrev_b32 v65, 16, v198
    v_and_b32 v66, s11, v198
    v_add_f32 v124, v124, v65
    v_add_f32 v125, v125, v66
    v_cvt_pk_bf16_f32 v198, v124, v125
    v_dot2_f32_bf16 v6, v198, s10, v6
    v_dot2_f32_bf16 v7, v198, v198, v7
    v_lshlrev_b32 v65, 16, v199
    v_and_b32 v66, s11, v199
    v_add_f32 v126, v126, v65
    v_add_f32 v127, v127, v66
    v_cvt_pk_bf16_f32 v199, v126, v127
    v_dot2_f32_bf16 v6, v199, s10, v6
    v_dot2_f32_bf16 v7, v199, v199, v7
    v_lshlrev_b32 v65, 16, v200
    v_and_b32 v66, s11, v200
    v_add_f32 v128, v128, v65
    v_add_f32 v129, v129, v66
    v_cvt_pk_bf16_f32 v200, v128, v129
    v_dot2_f32_bf16 v6, v200, s10, v6
    v_dot2_f32_bf16 v7, v200, v200, v7
    v_lshlrev_b32 v65, 16, v201
    v_and_b32 v66, s11, v201
    v_add_f32 v130, v130, v65
    v_add_f32 v131, v131, v66
    v_cvt_pk_bf16_f32 v201, v130, v131
    v_dot2_f32_bf16 v6, v201, s10, v6
    v_dot2_f32_bf16 v7, v201, v201, v7
    v_lshlrev_b32 v65, 16, v202
    v_and_b32 v66, s11, v202
    v_add_f32 v132, v132, v65
    v_add_f32 v133, v133, v66
    v_cvt_pk_bf16_f32 v202, v132, v133
    v_dot2_f32_bf16 v6, v202, s10, v6
    v_dot2_f32_bf16 v7, v202, v202, v7
    v_lshlrev_b32 v65, 16, v203
    v_and_b32 v66, s11, v203
    v_add_f32 v134, v134, v65
    v_add_f32 v135, v135, v66
    v_cvt_pk_bf16_f32 v203, v134, v135
    v_dot2_f32_bf16 v6, v203, s10, v6
    v_dot2_f32_bf16 v7, v203, v203, v7
    v_lshlrev_b32 v65, 16, v204
    v_and_b32 v66, s11, v204
    v_add_f32 v136, v136, v65
    v_add_f32 v137, v137, v66
    v_cvt_pk_bf16_f32 v204, v136, v137
    v_dot2_f32_bf16 v6, v204, s10, v6
    v_dot2_f32_bf16 v7, v204, v204, v7
    v_lshlrev_b32 v65, 16, v205
    v_and_b32 v66, s11, v205
    v_add_f32 v138, v138, v65
    v_add_f32 v139, v139, v66
    v_cvt_pk_bf16_f32 v205, v138, v139
    v_dot2_f32_bf16 v6, v205, s10, v6
    v_dot2_f32_bf16 v7, v205, v205, v7
    v_lshlrev_b32 v65, 16, v206
    v_and_b32 v66, s11, v206
    v_add_f32 v140, v140, v65
    v_add_f32 v141, v141, v66
    v_cvt_pk_bf16_f32 v206, v140, v141
    v_dot2_f32_bf16 v6, v206, s10, v6
    v_dot2_f32_bf16 v7, v206, v206, v7
    v_lshlrev_b32 v65, 16, v207
    v_and_b32 v66, s11, v207
    v_add_f32 v142, v142, v65
    v_add_f32 v143, v143, v66
    v_cvt_pk_bf16_f32 v207, v142, v143
    v_dot2_f32_bf16 v6, v207, s10, v6
    v_dot2_f32_bf16 v7, v207, v207, v7
    ds_write_b64 v13, v[184:185] offset:25088
    ds_write_b64 v13, v[186:187] offset:25104
    ds_write_b64 v13, v[188:189] offset:25120
    ds_write_b64 v13, v[190:191] offset:25136
    ds_write_b64 v13, v[192:193] offset:25152
    ds_write_b64 v13, v[194:195] offset:25168
    ds_write_b64 v13, v[196:197] offset:25184
    ds_write_b64 v13, v[198:199] offset:25200
    ds_write_b64 v13, v[200:201] offset:25216
    ds_write_b64 v13, v[202:203] offset:25232
    ds_write_b64 v13, v[204:205] offset:25248
    ds_write_b64 v13, v[206:207] offset:25264
    s_nop 2
    v_mov_b32 v64, v6
    s_nop 1
    v_permlane32_swap_b32 v6, v64
    s_nop 1
    v_add_f32 v6, v6, v64
    v_mov_b32 v64, v7
    s_nop 1
    v_permlane32_swap_b32 v7, v64
    s_nop 1
    v_add_f32 v7, v7, v64
    v_lshlrev_b32 v4, 3, v2
    v_add_u32 v4, 91136, v4
    s_lshl_b32 s9, s3, 8
    v_add_u32 v5, s9, v4
    ds_write_b64 v5, v[6:7]
    s_waitcnt lgkmcnt(0)
    s_barrier
    ds_read_b64 v[64:65], v4 offset:0
    ds_read_b64 v[66:67], v4 offset:256
    ds_read_b64 v[68:69], v4 offset:512
    ds_read_b64 v[70:71], v4 offset:768
    ds_read_b128 v[16:19], v9 offset:25088
    ds_read_b128 v[20:23], v9 offset:25216
    ds_read_b128 v[24:27], v9 offset:25344
    ds_read_b128 v[28:31], v9 offset:25472
    ds_read_b128 v[32:35], v9 offset:25600
    ds_read_b128 v[36:39], v9 offset:25728
    s_waitcnt lgkmcnt(6)
    v_add_f32 v64, v64, v66
    v_add_f32 v65, v65, v67
    v_add_f32 v68, v68, v70
    v_add_f32 v69, v69, v71
    v_add_f32 v64, v64, v68
    v_add_f32 v65, v65, v69
    v_mul_f32 v64, 0x3b2aaaab, v64
    v_mul_f32 v65, 0x3b2aaaab, v65
    v_fma_f32 v65, -v64, v64, v65
    v_max_f32 v65, 0, v65
    v_cvt_pk_bf16_f32 v66, v64, v64
    v_lshlrev_b32 v66, 16, v66
    v_cvt_pk_bf16_f32 v68, v65, v65
    v_lshlrev_b32 v68, 16, v68
    v_add_f32 v68, 0x3727c5ac, v68
    v_cvt_pk_bf16_f32 v68, v68, v68
    v_lshlrev_b32 v68, 16, v68
    v_sqrt_f32 v68, v68
    s_nop 0
    v_cvt_pk_bf16_f32 v68, v68, v68
    v_lshlrev_b32 v68, 16, v68
    v_rcp_f32 v67, v68
    s_nop 0
    v_mul_f32 v66, v66, v67
    s_waitcnt lgkmcnt(0)
    buffer_store_dwordx4 v[16:19], v8, s[40:43], 0 offen offset:0 sc1
    buffer_store_dwordx4 v[20:23], v8, s[40:43], 0 offen offset:128 sc1
    buffer_store_dwordx4 v[24:27], v8, s[40:43], 0 offen offset:256 sc1
    buffer_store_dwordx4 v[28:31], v8, s[40:43], 0 offen offset:384 sc1
    buffer_store_dwordx4 v[32:35], v8, s[40:43], 0 offen offset:512 sc1
    buffer_store_dwordx4 v[36:39], v8, s[40:43], 0 offen offset:640 sc1
    v_lshlrev_b32 v72, 16, v184
    v_and_b32 v73, s11, v184
    v_fma_f32 v72, v72, v67, -v66
    v_fma_f32 v73, v73, v67, -v66
    v_cvt_pk_bf16_f32 v144, v72, v73
    v_lshlrev_b32 v72, 16, v185
    v_and_b32 v73, s11, v185
    v_fma_f32 v72, v72, v67, -v66
    v_fma_f32 v73, v73, v67, -v66
    v_cvt_pk_bf16_f32 v145, v72, v73
    v_lshlrev_b32 v72, 16, v186
    v_and_b32 v73, s11, v186
    v_fma_f32 v72, v72, v67, -v66
    v_fma_f32 v73, v73, v67, -v66
    v_cvt_pk_bf16_f32 v146, v72, v73
    v_lshlrev_b32 v72, 16, v187
    v_and_b32 v73, s11, v187
    v_fma_f32 v72, v72, v67, -v66
    v_fma_f32 v73, v73, v67, -v66
    v_cvt_pk_bf16_f32 v147, v72, v73
    v_lshlrev_b32 v72, 16, v188
    v_and_b32 v73, s11, v188
    v_fma_f32 v72, v72, v67, -v66
    v_fma_f32 v73, v73, v67, -v66
    v_cvt_pk_bf16_f32 v148, v72, v73
    v_lshlrev_b32 v72, 16, v189
    v_and_b32 v73, s11, v189
    v_fma_f32 v72, v72, v67, -v66
    v_fma_f32 v73, v73, v67, -v66
    v_cvt_pk_bf16_f32 v149, v72, v73
    v_lshlrev_b32 v72, 16, v190
    v_and_b32 v73, s11, v190
    v_fma_f32 v72, v72, v67, -v66
    v_fma_f32 v73, v73, v67, -v66
    v_cvt_pk_bf16_f32 v150, v72, v73
    v_lshlrev_b32 v72, 16, v191
    v_and_b32 v73, s11, v191
    v_fma_f32 v72, v72, v67, -v66
    v_fma_f32 v73, v73, v67, -v66
    v_cvt_pk_bf16_f32 v151, v72, v73
    v_lshlrev_b32 v72, 16, v192
    v_and_b32 v73, s11, v192
    v_fma_f32 v72, v72, v67, -v66
    v_fma_f32 v73, v73, v67, -v66
    v_cvt_pk_bf16_f32 v152, v72, v73
    v_lshlrev_b32 v72, 16, v193
    v_and_b32 v73, s11, v193
    v_fma_f32 v72, v72, v67, -v66
    v_fma_f32 v73, v73, v67, -v66
    v_cvt_pk_bf16_f32 v153, v72, v73
    v_lshlrev_b32 v72, 16, v194
    v_and_b32 v73, s11, v194
    v_fma_f32 v72, v72, v67, -v66
    v_fma_f32 v73, v73, v67, -v66
    v_cvt_pk_bf16_f32 v154, v72, v73
    v_lshlrev_b32 v72, 16, v195
    v_and_b32 v73, s11, v195
    v_fma_f32 v72, v72, v67, -v66
    v_fma_f32 v73, v73, v67, -v66
    v_cvt_pk_bf16_f32 v155, v72, v73
    v_lshlrev_b32 v72, 16, v196
    v_and_b32 v73, s11, v196
    v_fma_f32 v72, v72, v67, -v66
    v_fma_f32 v73, v73, v67, -v66
    v_cvt_pk_bf16_f32 v156, v72, v73
    v_lshlrev_b32 v72, 16, v197
    v_and_b32 v73, s11, v197
    v_fma_f32 v72, v72, v67, -v66
    v_fma_f32 v73, v73, v67, -v66
    v_cvt_pk_bf16_f32 v157, v72, v73
    v_lshlrev_b32 v72, 16, v198
    v_and_b32 v73, s11, v198
    v_fma_f32 v72, v72, v67, -v66
    v_fma_f32 v73, v73, v67, -v66
    v_cvt_pk_bf16_f32 v158, v72, v73
    v_lshlrev_b32 v72, 16, v199
    v_and_b32 v73, s11, v199
    v_fma_f32 v72, v72, v67, -v66
    v_fma_f32 v73, v73, v67, -v66
    v_cvt_pk_bf16_f32 v159, v72, v73
    v_lshlrev_b32 v72, 16, v200
    v_and_b32 v73, s11, v200
    v_fma_f32 v72, v72, v67, -v66
    v_fma_f32 v73, v73, v67, -v66
    v_cvt_pk_bf16_f32 v160, v72, v73
    v_lshlrev_b32 v72, 16, v201
    v_and_b32 v73, s11, v201
    v_fma_f32 v72, v72, v67, -v66
    v_fma_f32 v73, v73, v67, -v66
    v_cvt_pk_bf16_f32 v161, v72, v73
    v_lshlrev_b32 v72, 16, v202
    v_and_b32 v73, s11, v202
    v_fma_f32 v72, v72, v67, -v66
    v_fma_f32 v73, v73, v67, -v66
    v_cvt_pk_bf16_f32 v162, v72, v73
    v_lshlrev_b32 v72, 16, v203
    v_and_b32 v73, s11, v203
    v_fma_f32 v72, v72, v67, -v66
    v_fma_f32 v73, v73, v67, -v66
    v_cvt_pk_bf16_f32 v163, v72, v73
    v_lshlrev_b32 v72, 16, v204
    v_and_b32 v73, s11, v204
    v_fma_f32 v72, v72, v67, -v66
    v_fma_f32 v73, v73, v67, -v66
    v_cvt_pk_bf16_f32 v164, v72, v73
    v_lshlrev_b32 v72, 16, v205
    v_and_b32 v73, s11, v205
    v_fma_f32 v72, v72, v67, -v66
    v_fma_f32 v73, v73, v67, -v66
    v_cvt_pk_bf16_f32 v165, v72, v73
    v_lshlrev_b32 v72, 16, v206
    v_and_b32 v73, s11, v206
    v_fma_f32 v72, v72, v67, -v66
    v_fma_f32 v73, v73, v67, -v66
    v_cvt_pk_bf16_f32 v166, v72, v73
    v_lshlrev_b32 v72, 16, v207
    v_and_b32 v73, s11, v207
    v_fma_f32 v72, v72, v67, -v66
    v_fma_f32 v73, v73, v67, -v66
    v_cvt_pk_bf16_f32 v167, v72, v73
    ds_write_b64 v13, v[144:145] offset:0
    ds_write_b64 v13, v[146:147] offset:16
    ds_write_b64 v13, v[148:149] offset:32
    ds_write_b64 v13, v[150:151] offset:48
    ds_write_b64 v13, v[152:153] offset:64
    ds_write_b64 v13, v[154:155] offset:80
    ds_write_b64 v13, v[156:157] offset:96
    ds_write_b64 v13, v[158:159] offset:112
    ds_write_b64 v13, v[160:161] offset:128
    ds_write_b64 v13, v[162:163] offset:144
    ds_write_b64 v13, v[164:165] offset:160
    ds_write_b64 v13, v[166:167] offset:176
    s_waitcnt lgkmcnt(0)
    s_barrier
    ds_read_b128 v[40:43], v9 offset:0
    ds_read_b128 v[44:47], v9 offset:128
    ds_read_b128 v[48:51], v9 offset:256
    ds_read_b128 v[52:55], v9 offset:384
    ds_read_b128 v[56:59], v9 offset:512
    ds_read_b128 v[60:63], v9 offset:640
    s_waitcnt lgkmcnt(0)
    buffer_store_dwordx4 v[40:43], v8, s[44:47], 0 offen offset:0 sc1
    buffer_store_dwordx4 v[44:47], v8, s[44:47], 0 offen offset:128 sc1
    buffer_store_dwordx4 v[48:51], v8, s[44:47], 0 offen offset:256 sc1
    buffer_store_dwordx4 v[52:55], v8, s[44:47], 0 offen offset:384 sc1
    buffer_store_dwordx4 v[56:59], v8, s[44:47], 0 offen offset:512 sc1
    buffer_store_dwordx4 v[60:63], v8, s[44:47], 0 offen offset:640 sc1
    s_waitcnt vmcnt(0)
    s_barrier
    s_cmp_lg_u32 s3, 0
    s_cbranch_scc1 L1_sig
    s_cmp_lg_u32 s53, 0
    s_cbranch_scc1 L1_sigz_skip
    v_mov_b32 v245, 0
    s_mov_b32 s61, 0
L1_sigz:
    buffer_load_dword v244, v245, s[64:67], 0 offen sc1
    s_waitcnt vmcnt(0)
    v_readfirstlane_b32 s63, v244
    s_nop 3
    s_cmp_ge_u32 s63, 1
    s_cbranch_scc1 L1_sigz_done
    s_sleep 4
    s_add_u32 s61, s61, 1
    s_cmp_lt_u32 s61, 0x200000
    s_cbranch_scc1 L1_sigz
L1_sigz_done:
    s_mov_b32 s53, 1
L1_sigz_skip:
    v_mov_b32 v244, 1
    s_lshr_b32 s63, s2, 3
    s_and_b32 s63, s63, 7
    s_lshl_b32 s63, s63, 7
    s_add_u32 s63, s63, 16384
    v_mul_u32_u24 v245, 1024, v1
    v_add_u32 v245, s63, v245
    s_mov_b64 s[68:69], exec
    s_mov_b64 exec, 255
    buffer_atomic_add v244, v245, s[80:83], 0 offen sc1
    s_mov_b64 exec, s[68:69]
L1_sig:
L_ph2:
    s_and_b32 s4, s2, 7
    s_lshr_b32 s5, s2, 3
    s_cmp_eq_u32 s4, 0
    s_cselect_b32 s7, 21, 20
    s_cmp_ge_u32 s5, s7
    s_cbranch_scc1 L_fin
    s_mul_i32 s6, s4, 20
    s_min_u32 s7, s4, 1
    s_add_u32 s6, s6, s7
    s_add_u32 s6, s6, s5
    s_mul_hi_u32 s4, s6, 186737709
    s_mul_i32 s5, s4, 23
    s_sub_u32 s5, s6, s5
    s_mul_i32 s6, s4, 559872
    s_add_u32 s7, s6, 9437184
    s_add_u32 s32, s30, s7
    s_addc_u32 s33, s31, 0
    s_mov_b32 s34, 559872
    s_mov_b32 s35, 0x00020000
    s_add_u32 s36, s30, 2097152
    s_addc_u32 s37, s31, 0
    s_mov_b32 s38, 294912
    s_mov_b32 s39, 0x00020000
    s_add_u32 s7, s6, 4194304
    s_add_u32 s40, s30, s7
    s_addc_u32 s41, s31, 0
    s_mov_b32 s42, 559872
    s_mov_b32 s43, 0x00020000
    s_add_u32 s44, s26, s6
    s_addc_u32 s45, s27, 0
    s_mov_b32 s46, 559872
    s_mov_b32 s47, 0x00020000
    s_add_u32 s48, s30, 3145728
    s_addc_u32 s49, s31, 0
    s_mov_b32 s50, 294912
    s_mov_b32 s51, 0x00020000
    v_add_u32 v7, 0, v1
    v_mul_u32_u24 v8, 1366, v7
    v_lshrrev_b32 v8, 16, v8
    v_mul_u32_u24 v9, 48, v8
    v_sub_u32 v9, v7, v9
    v_lshlrev_b32 v10, 2, v8
    v_xor_b32 v9, v9, v10
    v_mul_u32_u24 v8, 768, v8
    v_lshl_add_u32 v4, v9, 4, v8
    v_add_u32 v7, 64, v1
    v_mul_u32_u24 v8, 1366, v7
    v_lshrrev_b32 v8, 16, v8
    v_mul_u32_u24 v9, 48, v8
    v_sub_u32 v9, v7, v9
    v_lshlrev_b32 v10, 2, v8
    v_xor_b32 v9, v9, v10
    v_mul_u32_u24 v8, 768, v8
    v_lshl_add_u32 v5, v9, 4, v8
    v_add_u32 v7, 128, v1
    v_mul_u32_u24 v8, 1366, v7
    v_lshrrev_b32 v8, 16, v8
    v_mul_u32_u24 v9, 48, v8
    v_sub_u32 v9, v7, v9
    v_lshlrev_b32 v10, 2, v8
    v_xor_b32 v9, v9, v10
    v_mul_u32_u24 v8, 768, v8
    v_lshl_add_u32 v6, v9, 4, v8
    s_mul_i32 s8, s3, 36864
    s_lshl_b32 s11, s5, 5
    s_mul_i32 s11, s11, 768
    s_lshl_b32 s14, s3, 5
    s_mul_i32 s14, s14, 768
    s_mul_hi_u32 s15, s5, 0x2AAAAAAB
    s_mul_i32 s15, s15, 6
    s_sub_u32 s15, s5, s15
    v_and_b32 v28, 15, v2
    v_and_b32 v29, 3, v28
    v_lshlrev_b32 v29, 2, v29
    v_lshrrev_b32 v30, 2, v28
    v_or_b32 v29, v29, v30
    v_mul_u32_u24 v28, 768, v28
    v_add_u32 v30, 0, v3
    v_xor_b32 v30, v30, v29
    v_lshl_add_u32 v9, v30, 4, v28
    v_add_u32 v30, 2, v3
    v_xor_b32 v30, v30, v29
    v_lshl_add_u32 v10, v30, 4, v28
    v_add_u32 v30, 4, v3
    v_xor_b32 v30, v30, v29
    v_lshl_add_u32 v11, v30, 4, v28
    v_add_u32 v30, 6, v3
    v_xor_b32 v30, v30, v29
    v_lshl_add_u32 v12, v30, 4, v28
    v_add_u32 v30, 8, v3
    v_xor_b32 v30, v30, v29
    v_lshl_add_u32 v13, v30, 4, v28
    v_add_u32 v30, 10, v3
    v_xor_b32 v30, v30, v29
    v_lshl_add_u32 v14, v30, 4, v28
    v_add_u32 v30, 12, v3
    v_xor_b32 v30, v30, v29
    v_lshl_add_u32 v15, v30, 4, v28
    v_add_u32 v30, 14, v3
    v_xor_b32 v30, v30, v29
    v_lshl_add_u32 v16, v30, 4, v28
    v_lshrrev_b32 v30, 4, v2
    v_mul_u32_u24 v31, 36864, v30
    v_add_u32 v31, 24576, v31
    v_add_u32 v56, v9, v31
    v_add_u32 v57, v10, v31
    v_add_u32 v58, v11, v31
    v_add_u32 v59, v12, v31
    v_add_u32 v60, v13, v31
    v_add_u32 v61, v14, v31
    v_add_u32 v62, v15, v31
    v_add_u32 v63, v16, v31
    v_mul_u32_u24 v31, 12288, v30
    v_add_u32 v31, s8, v31
    v_add_u32 v9, v9, v31
    v_add_u32 v10, v10, v31
    v_add_u32 v11, v11, v31
    v_add_u32 v12, v12, v31
    v_add_u32 v13, v13, v31
    v_add_u32 v14, v14, v31
    v_add_u32 v15, v15, v31
    v_add_u32 v16, v16, v31
    v_cmp_eq_u32 vcc, 0, v30
    v_mov_b32 v31, 24576
    v_mov_b32 v28, 4294955008
    s_nop 0
    v_cndmask_b32 v17, v28, v31, vcc
    v_cndmask_b32 v18, v31, v28, vcc
    v_mov_b32 v19, v28
    v_and_b32 v28, 15, v1
    v_lshrrev_b32 v29, 2, v28
    v_and_b32 v28, 3, v28
    v_bfe_u32 v30, v1, 4, 1
    v_lshlrev_b32 v30, 1, v30
    v_lshrrev_b32 v31, 1, v28
    v_add_u32 v30, v30, v31
    v_and_b32 v28, 1, v28
    v_lshlrev_b32 v28, 3, v28
    v_add_u32 v28, s8, v28
    v_lshl_add_u32 v31, v3, 2, v29
    v_mul_u32_u24 v31, 768, v31
    v_add_u32 v31, v31, v28
    v_add_u32 v32, 0, v3
    v_and_b32 v32, 3, v32
    v_lshl_or_b32 v32, v29, 2, v32
    s_add_u32 s12, s3, 0
    s_and_b32 s12, s12, 3
    s_lshl_b32 s12, s12, 2
    v_add_u32 v33, s12, v30
    v_xor_b32 v33, v33, v32
    v_lshl_add_u32 v20, v33, 4, v31
    s_add_u32 s12, s3, 1
    s_and_b32 s12, s12, 3
    s_lshl_b32 s12, s12, 2
    v_add_u32 v33, s12, v30
    v_xor_b32 v33, v33, v32
    v_lshl_add_u32 v21, v33, 4, v31
    s_add_u32 s12, s3, 2
    s_and_b32 s12, s12, 3
    s_lshl_b32 s12, s12, 2
    v_add_u32 v33, s12, v30
    v_xor_b32 v33, v33, v32
    v_lshl_add_u32 v22, v33, 4, v31
    s_add_u32 s12, s3, 3
    s_and_b32 s12, s12, 3
    s_lshl_b32 s12, s12, 2
    v_add_u32 v33, s12, v30
    v_xor_b32 v33, v33, v32
    v_lshl_add_u32 v23, v33, 4, v31
    v_lshl_add_u32 v31, v3, 2, v29
    v_add_u32 v31, 8, v31
    v_mul_u32_u24 v31, 768, v31
    v_add_u32 v31, v31, v28
    v_add_u32 v32, 2, v3
    v_and_b32 v32, 3, v32
    v_lshl_or_b32 v32, v29, 2, v32
    s_add_u32 s12, s3, 0
    s_and_b32 s12, s12, 3
    s_lshl_b32 s12, s12, 2
    v_add_u32 v33, s12, v30
    v_xor_b32 v33, v33, v32
    v_lshl_add_u32 v24, v33, 4, v31
    s_add_u32 s12, s3, 1
    s_and_b32 s12, s12, 3
    s_lshl_b32 s12, s12, 2
    v_add_u32 v33, s12, v30
    v_xor_b32 v33, v33, v32
    v_lshl_add_u32 v25, v33, 4, v31
    s_add_u32 s12, s3, 2
    s_and_b32 s12, s12, 3
    s_lshl_b32 s12, s12, 2
    v_add_u32 v33, s12, v30
    v_xor_b32 v33, v33, v32
    v_lshl_add_u32 v26, v33, 4, v31
    s_add_u32 s12, s3, 3
    s_and_b32 s12, s12, 3
    s_lshl_b32 s12, s12, 2
    v_add_u32 v33, s12, v30
    v_xor_b32 v33, v33, v32
    v_lshl_add_u32 v27, v33, 4, v31
    v_lshlrev_b32 v34, 4, v1
    s_mul_i32 s58, s3, 73728
    s_cmp_eq_u32 s3, 0
    s_cbranch_scc1 L2_w0
    s_add_u32 s59, s58, 0
    buffer_load_dwordx4 a[0:3], v34, s[36:39], s59 offen offset:0 sc1
    s_add_u32 s59, s58, 24576
    buffer_load_dwordx4 a[4:7], v34, s[36:39], s59 offen offset:0 sc1
    s_add_u32 s59, s58, 49152
    buffer_load_dwordx4 a[8:11], v34, s[36:39], s59 offen offset:0 sc1
    s_add_u32 s59, s58, 0
    buffer_load_dwordx4 a[12:15], v34, s[36:39], s59 offen offset:1024 sc1
    s_add_u32 s59, s58, 24576
    buffer_load_dwordx4 a[16:19], v34, s[36:39], s59 offen offset:1024 sc1
    s_add_u32 s59, s58, 49152
    buffer_load_dwordx4 a[20:23], v34, s[36:39], s59 offen offset:1024 sc1
    s_add_u32 s59, s58, 0
    buffer_load_dwordx4 a[24:27], v34, s[36:39], s59 offen offset:2048 sc1
    s_add_u32 s59, s58, 24576
    buffer_load_dwordx4 a[28:31], v34, s[36:39], s59 offen offset:2048 sc1
    s_add_u32 s59, s58, 49152
    buffer_load_dwordx4 a[32:35], v34, s[36:39], s59 offen offset:2048 sc1
    s_add_u32 s59, s58, 0
    buffer_load_dwordx4 a[36:39], v34, s[36:39], s59 offen offset:3072 sc1
    s_add_u32 s59, s58, 24576
    buffer_load_dwordx4 a[40:43], v34, s[36:39], s59 offen offset:3072 sc1
    s_add_u32 s59, s58, 49152
    buffer_load_dwordx4 a[44:47], v34, s[36:39], s59 offen offset:3072 sc1
    s_add_u32 s59, s58, 4096
    buffer_load_dwordx4 a[48:51], v34, s[36:39], s59 offen offset:0 sc1
    s_add_u32 s59, s58, 28672
    buffer_load_dwordx4 a[52:55], v34, s[36:39], s59 offen offset:0 sc1
    s_add_u32 s59, s58, 53248
    buffer_load_dwordx4 a[56:59], v34, s[36:39], s59 offen offset:0 sc1
    s_add_u32 s59, s58, 4096
    buffer_load_dwordx4 a[60:63], v34, s[36:39], s59 offen offset:1024 sc1
    s_add_u32 s59, s58, 28672
    buffer_load_dwordx4 a[64:67], v34, s[36:39], s59 offen offset:1024 sc1
    s_add_u32 s59, s58, 53248
    buffer_load_dwordx4 a[68:71], v34, s[36:39], s59 offen offset:1024 sc1
    s_add_u32 s59, s58, 4096
    buffer_load_dwordx4 a[72:75], v34, s[36:39], s59 offen offset:2048 sc1
    s_add_u32 s59, s58, 28672
    buffer_load_dwordx4 a[76:79], v34, s[36:39], s59 offen offset:2048 sc1
    s_add_u32 s59, s58, 53248
    buffer_load_dwordx4 a[80:83], v34, s[36:39], s59 offen offset:2048 sc1
    s_add_u32 s59, s58, 4096
    buffer_load_dwordx4 a[84:87], v34, s[36:39], s59 offen offset:3072 sc1
    s_add_u32 s59, s58, 28672
    buffer_load_dwordx4 a[88:91], v34, s[36:39], s59 offen offset:3072 sc1
    s_add_u32 s59, s58, 53248
    buffer_load_dwordx4 a[92:95], v34, s[36:39], s59 offen offset:3072 sc1
    s_add_u32 s59, s58, 8192
    buffer_load_dwordx4 a[96:99], v34, s[36:39], s59 offen offset:0 sc1
    s_add_u32 s59, s58, 32768
    buffer_load_dwordx4 a[100:103], v34, s[36:39], s59 offen offset:0 sc1
    s_add_u32 s59, s58, 57344
    buffer_load_dwordx4 a[104:107], v34, s[36:39], s59 offen offset:0 sc1
    s_add_u32 s59, s58, 8192
    buffer_load_dwordx4 a[108:111], v34, s[36:39], s59 offen offset:1024 sc1
    s_add_u32 s59, s58, 32768
    buffer_load_dwordx4 a[112:115], v34, s[36:39], s59 offen offset:1024 sc1
    s_add_u32 s59, s58, 57344
    buffer_load_dwordx4 a[116:119], v34, s[36:39], s59 offen offset:1024 sc1
    s_add_u32 s59, s58, 8192
    buffer_load_dwordx4 a[120:123], v34, s[36:39], s59 offen offset:2048 sc1
    s_add_u32 s59, s58, 32768
    buffer_load_dwordx4 a[124:127], v34, s[36:39], s59 offen offset:2048 sc1
    s_add_u32 s59, s58, 57344
    buffer_load_dwordx4 a[128:131], v34, s[36:39], s59 offen offset:2048 sc1
    s_add_u32 s59, s58, 8192
    buffer_load_dwordx4 a[132:135], v34, s[36:39], s59 offen offset:3072 sc1
    s_add_u32 s59, s58, 32768
    buffer_load_dwordx4 a[136:139], v34, s[36:39], s59 offen offset:3072 sc1
    s_add_u32 s59, s58, 57344
    buffer_load_dwordx4 a[140:143], v34, s[36:39], s59 offen offset:3072 sc1
    s_add_u32 s59, s58, 12288
    buffer_load_dwordx4 a[144:147], v34, s[36:39], s59 offen offset:0 sc1
    s_add_u32 s59, s58, 36864
    buffer_load_dwordx4 a[148:151], v34, s[36:39], s59 offen offset:0 sc1
    s_add_u32 s59, s58, 61440
    buffer_load_dwordx4 a[152:155], v34, s[36:39], s59 offen offset:0 sc1
    s_add_u32 s59, s58, 12288
    buffer_load_dwordx4 a[156:159], v34, s[36:39], s59 offen offset:1024 sc1
    s_add_u32 s59, s58, 36864
    buffer_load_dwordx4 a[160:163], v34, s[36:39], s59 offen offset:1024 sc1
    s_add_u32 s59, s58, 61440
    buffer_load_dwordx4 a[164:167], v34, s[36:39], s59 offen offset:1024 sc1
    s_add_u32 s59, s58, 12288
    buffer_load_dwordx4 a[168:171], v34, s[36:39], s59 offen offset:2048 sc1
    s_add_u32 s59, s58, 36864
    buffer_load_dwordx4 a[172:175], v34, s[36:39], s59 offen offset:2048 sc1
    s_add_u32 s59, s58, 61440
    buffer_load_dwordx4 a[176:179], v34, s[36:39], s59 offen offset:2048 sc1
    s_add_u32 s59, s58, 12288
    buffer_load_dwordx4 a[180:183], v34, s[36:39], s59 offen offset:3072 sc1
    s_add_u32 s59, s58, 36864
    buffer_load_dwordx4 a[184:187], v34, s[36:39], s59 offen offset:3072 sc1
    s_add_u32 s59, s58, 61440
    buffer_load_dwordx4 a[188:191], v34, s[36:39], s59 offen offset:3072 sc1
    s_add_u32 s59, s58, 16384
    buffer_load_dwordx4 a[192:195], v34, s[36:39], s59 offen offset:0 sc1
    s_add_u32 s59, s58, 40960
    buffer_load_dwordx4 a[196:199], v34, s[36:39], s59 offen offset:0 sc1
    s_add_u32 s59, s58, 65536
    buffer_load_dwordx4 a[200:203], v34, s[36:39], s59 offen offset:0 sc1
    s_add_u32 s59, s58, 16384
    buffer_load_dwordx4 a[204:207], v34, s[36:39], s59 offen offset:1024 sc1
    s_add_u32 s59, s58, 40960
    buffer_load_dwordx4 a[208:211], v34, s[36:39], s59 offen offset:1024 sc1
    s_add_u32 s59, s58, 65536
    buffer_load_dwordx4 a[212:215], v34, s[36:39], s59 offen offset:1024 sc1
    s_add_u32 s59, s58, 16384
    buffer_load_dwordx4 a[216:219], v34, s[36:39], s59 offen offset:2048 sc1
    s_add_u32 s59, s58, 40960
    buffer_load_dwordx4 a[220:223], v34, s[36:39], s59 offen offset:2048 sc1
    s_add_u32 s59, s58, 65536
    buffer_load_dwordx4 a[224:227], v34, s[36:39], s59 offen offset:2048 sc1
    s_add_u32 s59, s58, 16384
    buffer_load_dwordx4 a[228:231], v34, s[36:39], s59 offen offset:3072 sc1
    s_add_u32 s59, s58, 40960
    buffer_load_dwordx4 a[232:235], v34, s[36:39], s59 offen offset:3072 sc1
    s_add_u32 s59, s58, 65536
    buffer_load_dwordx4 a[236:239], v34, s[36:39], s59 offen offset:3072 sc1
    s_branch L2_np2
L2_w0:
    s_cmp_lg_u32 s53, 0
    s_cbranch_scc1 L2_p2z_skip
    v_mov_b32 v245, 0
    s_mov_b32 s61, 0
L2_p2z:
    buffer_load_dword v244, v245, s[64:67], 0 offen sc1
    s_waitcnt vmcnt(0)
    v_readfirstlane_b32 s63, v244
    s_nop 3
    s_cmp_ge_u32 s63, 1
    s_cbranch_scc1 L2_p2z_done
    s_sleep 4
    s_add_u32 s61, s61, 1
    s_cmp_lt_u32 s61, 0x200000
    s_cbranch_scc1 L2_p2z
L2_p2z_done:
    s_mov_b32 s53, 1
L2_p2z_skip:
    s_and_b32 s63, s2, 7
    s_mul_i32 s63, s63, 1024
    s_add_u32 s63, s63, 16384
    v_and_b32 v245, 7, v1
    v_lshlrev_b32 v245, 7, v245
    v_add_u32 v245, s63, v245
    s_mov_b32 s61, 0
L2_p2:
    buffer_load_dword v244, v245, s[80:83], 0 offen sc1
    s_waitcnt vmcnt(0)
    v_readlane_b32 s63, v244, 0
    v_readlane_b32 s52, v244, 1
    s_nop 3
    s_add_u32 s63, s63, s52
    v_readlane_b32 s52, v244, 2
    s_nop 3
    s_add_u32 s63, s63, s52
    v_readlane_b32 s52, v244, 3
    s_nop 3
    s_add_u32 s63, s63, s52
    v_readlane_b32 s52, v244, 4
    s_nop 3
    s_add_u32 s63, s63, s52
    v_readlane_b32 s52, v244, 5
    s_nop 3
    s_add_u32 s63, s63, s52
    v_readlane_b32 s52, v244, 6
    s_nop 3
    s_add_u32 s63, s63, s52
    v_readlane_b32 s52, v244, 7
    s_nop 3
    s_add_u32 s63, s63, s52
    s_cmp_ge_u32 s63, 183
    s_cbranch_scc1 L2_p2_done
    s_sleep 4
    s_add_u32 s61, s61, 1
    s_cmp_lt_u32 s61, 0x200000
    s_cbranch_scc1 L2_p2
L2_p2_done:
L2_np2:
    s_barrier
    s_add_u32 s13, s11, 12288
    s_mov_b32 s12, 0
    s_mov_b32 s9, 36864
    s_cmp_lg_u32 s3, 0
    s_cbranch_scc1 L2_qa
    s_add_u32 s59, s58, 0
    buffer_load_dwordx4 a[0:3], v34, s[36:39], s59 offen offset:0 sc1
    s_add_u32 s59, s58, 24576
    buffer_load_dwordx4 a[4:7], v34, s[36:39], s59 offen offset:0 sc1
    s_add_u32 s59, s58, 49152
    buffer_load_dwordx4 a[8:11], v34, s[36:39], s59 offen offset:0 sc1
    s_add_u32 s59, s58, 0
    buffer_load_dwordx4 a[12:15], v34, s[36:39], s59 offen offset:1024 sc1
    s_add_u32 s59, s58, 24576
    buffer_load_dwordx4 a[16:19], v34, s[36:39], s59 offen offset:1024 sc1
    s_add_u32 s59, s58, 49152
    buffer_load_dwordx4 a[20:23], v34, s[36:39], s59 offen offset:1024 sc1
    s_add_u32 s59, s58, 0
    buffer_load_dwordx4 a[24:27], v34, s[36:39], s59 offen offset:2048 sc1
    s_add_u32 s59, s58, 24576
    buffer_load_dwordx4 a[28:31], v34, s[36:39], s59 offen offset:2048 sc1
    s_add_u32 s59, s58, 49152
    buffer_load_dwordx4 a[32:35], v34, s[36:39], s59 offen offset:2048 sc1
    s_add_u32 s59, s58, 0
    buffer_load_dwordx4 a[36:39], v34, s[36:39], s59 offen offset:3072 sc1
    s_add_u32 s59, s58, 24576
    buffer_load_dwordx4 a[40:43], v34, s[36:39], s59 offen offset:3072 sc1
    s_add_u32 s59, s58, 49152
    buffer_load_dwordx4 a[44:47], v34, s[36:39], s59 offen offset:3072 sc1
    s_add_u32 s59, s58, 4096
    buffer_load_dwordx4 a[48:51], v34, s[36:39], s59 offen offset:0 sc1
    s_add_u32 s59, s58, 28672
    buffer_load_dwordx4 a[52:55], v34, s[36:39], s59 offen offset:0 sc1
    s_add_u32 s59, s58, 53248
    buffer_load_dwordx4 a[56:59], v34, s[36:39], s59 offen offset:0 sc1
    s_add_u32 s59, s58, 4096
    buffer_load_dwordx4 a[60:63], v34, s[36:39], s59 offen offset:1024 sc1
    s_add_u32 s59, s58, 28672
    buffer_load_dwordx4 a[64:67], v34, s[36:39], s59 offen offset:1024 sc1
    s_add_u32 s59, s58, 53248
    buffer_load_dwordx4 a[68:71], v34, s[36:39], s59 offen offset:1024 sc1
    s_add_u32 s59, s58, 4096
    buffer_load_dwordx4 a[72:75], v34, s[36:39], s59 offen offset:2048 sc1
    s_add_u32 s59, s58, 28672
    buffer_load_dwordx4 a[76:79], v34, s[36:39], s59 offen offset:2048 sc1
    s_add_u32 s59, s58, 53248
    buffer_load_dwordx4 a[80:83], v34, s[36:39], s59 offen offset:2048 sc1
    s_add_u32 s59, s58, 4096
    buffer_load_dwordx4 a[84:87], v34, s[36:39], s59 offen offset:3072 sc1
    s_add_u32 s59, s58, 28672
    buffer_load_dwordx4 a[88:91], v34, s[36:39], s59 offen offset:3072 sc1
    s_add_u32 s59, s58, 53248
    buffer_load_dwordx4 a[92:95], v34, s[36:39], s59 offen offset:3072 sc1
    s_add_u32 s59, s58, 8192
    buffer_load_dwordx4 a[96:99], v34, s[36:39], s59 offen offset:0 sc1
    s_add_u32 s59, s58, 32768
    buffer_load_dwordx4 a[100:103], v34, s[36:39], s59 offen offset:0 sc1
    s_add_u32 s59, s58, 57344
    buffer_load_dwordx4 a[104:107], v34, s[36:39], s59 offen offset:0 sc1
    s_add_u32 s59, s58, 8192
    buffer_load_dwordx4 a[108:111], v34, s[36:39], s59 offen offset:1024 sc1
    s_add_u32 s59, s58, 32768
    buffer_load_dwordx4 a[112:115], v34, s[36:39], s59 offen offset:1024 sc1
    s_add_u32 s59, s58, 57344
    buffer_load_dwordx4 a[116:119], v34, s[36:39], s59 offen offset:1024 sc1
    s_add_u32 s59, s58, 8192
    buffer_load_dwordx4 a[120:123], v34, s[36:39], s59 offen offset:2048 sc1
    s_add_u32 s59, s58, 32768
    buffer_load_dwordx4 a[124:127], v34, s[36:39], s59 offen offset:2048 sc1
    s_add_u32 s59, s58, 57344
    buffer_load_dwordx4 a[128:131], v34, s[36:39], s59 offen offset:2048 sc1
    s_add_u32 s59, s58, 8192
    buffer_load_dwordx4 a[132:135], v34, s[36:39], s59 offen offset:3072 sc1
    s_add_u32 s59, s58, 32768
    buffer_load_dwordx4 a[136:139], v34, s[36:39], s59 offen offset:3072 sc1
    s_add_u32 s59, s58, 57344
    buffer_load_dwordx4 a[140:143], v34, s[36:39], s59 offen offset:3072 sc1
    s_add_u32 s59, s58, 12288
    buffer_load_dwordx4 a[144:147], v34, s[36:39], s59 offen offset:0 sc1
    s_add_u32 s59, s58, 36864
    buffer_load_dwordx4 a[148:151], v34, s[36:39], s59 offen offset:0 sc1
    s_add_u32 s59, s58, 61440
    buffer_load_dwordx4 a[152:155], v34, s[36:39], s59 offen offset:0 sc1
    s_add_u32 s59, s58, 12288
    buffer_load_dwordx4 a[156:159], v34, s[36:39], s59 offen offset:1024 sc1
    s_add_u32 s59, s58, 36864
    buffer_load_dwordx4 a[160:163], v34, s[36:39], s59 offen offset:1024 sc1
    s_add_u32 s59, s58, 61440
    buffer_load_dwordx4 a[164:167], v34, s[36:39], s59 offen offset:1024 sc1
    s_add_u32 s59, s58, 12288
    buffer_load_dwordx4 a[168:171], v34, s[36:39], s59 offen offset:2048 sc1
    s_add_u32 s59, s58, 36864
    buffer_load_dwordx4 a[172:175], v34, s[36:39], s59 offen offset:2048 sc1
    s_add_u32 s59, s58, 61440
    buffer_load_dwordx4 a[176:179], v34, s[36:39], s59 offen offset:2048 sc1
    s_add_u32 s59, s58, 12288
    buffer_load_dwordx4 a[180:183], v34, s[36:39], s59 offen offset:3072 sc1
    s_add_u32 s59, s58, 36864
    buffer_load_dwordx4 a[184:187], v34, s[36:39], s59 offen offset:3072 sc1
    s_add_u32 s59, s58, 61440
    buffer_load_dwordx4 a[188:191], v34, s[36:39], s59 offen offset:3072 sc1
    s_add_u32 s59, s58, 16384
    buffer_load_dwordx4 a[192:195], v34, s[36:39], s59 offen offset:0 sc1
    s_add_u32 s59, s58, 40960
    buffer_load_dwordx4 a[196:199], v34, s[36:39], s59 offen offset:0 sc1
    s_add_u32 s59, s58, 65536
    buffer_load_dwordx4 a[200:203], v34, s[36:39], s59 offen offset:0 sc1
    s_add_u32 s59, s58, 16384
    buffer_load_dwordx4 a[204:207], v34, s[36:39], s59 offen offset:1024 sc1
    s_add_u32 s59, s58, 40960
    buffer_load_dwordx4 a[208:211], v34, s[36:39], s59 offen offset:1024 sc1
    s_add_u32 s59, s58, 65536
    buffer_load_dwordx4 a[212:215], v34, s[36:39], s59 offen offset:1024 sc1
    s_add_u32 s59, s58, 16384
    buffer_load_dwordx4 a[216:219], v34, s[36:39], s59 offen offset:2048 sc1
    s_add_u32 s59, s58, 40960
    buffer_load_dwordx4 a[220:223], v34, s[36:39], s59 offen offset:2048 sc1
    s_add_u32 s59, s58, 65536
    buffer_load_dwordx4 a[224:227], v34, s[36:39], s59 offen offset:2048 sc1
    s_add_u32 s59, s58, 16384
    buffer_load_dwordx4 a[228:231], v34, s[36:39], s59 offen offset:3072 sc1
    s_add_u32 s59, s58, 40960
    buffer_load_dwordx4 a[232:235], v34, s[36:39], s59 offen offset:3072 sc1
    s_add_u32 s59, s58, 65536
    buffer_load_dwordx4 a[236:239], v34, s[36:39], s59 offen offset:3072 sc1
    s_branch L2_qd
L2_qa:
    s_cmp_lg_u32 s3, 1
    s_cbranch_scc1 L2_qn1
    s_add_u32 m0, s12, 24576
    s_add_u32 s10, s11, 0
    buffer_load_dwordx4 v4, s[32:35], s10 offen sc1 lds
    s_add_u32 m0, s12, 25600
    s_add_u32 s10, s11, 0
    buffer_load_dwordx4 v5, s[32:35], s10 offen sc1 lds
    s_add_u32 m0, s12, 26624
    s_add_u32 s10, s11, 0
    buffer_load_dwordx4 v6, s[32:35], s10 offen sc1 lds
    v_xor_b32 v7, 16, v4
    s_add_u32 m0, s12, 27648
    s_add_u32 s10, s11, 3072
    buffer_load_dwordx4 v7, s[32:35], s10 offen sc1 lds
    v_xor_b32 v8, 16, v5
    s_add_u32 m0, s12, 28672
    s_add_u32 s10, s11, 3072
    buffer_load_dwordx4 v8, s[32:35], s10 offen sc1 lds
    v_xor_b32 v7, 16, v6
    s_add_u32 m0, s12, 29696
    s_add_u32 s10, s11, 3072
    buffer_load_dwordx4 v7, s[32:35], s10 offen sc1 lds
    v_xor_b32 v8, 32, v4
    s_add_u32 m0, s12, 30720
    s_add_u32 s10, s11, 6144
    buffer_load_dwordx4 v8, s[32:35], s10 offen sc1 lds
    v_xor_b32 v7, 32, v5
    s_add_u32 m0, s12, 31744
    s_add_u32 s10, s11, 6144
    buffer_load_dwordx4 v7, s[32:35], s10 offen sc1 lds
    s_branch L2_qd
L2_qn1:
    s_cmp_lg_u32 s3, 2
    s_cbranch_scc1 L2_qn2
    v_xor_b32 v8, 32, v6
    s_add_u32 m0, s12, 32768
    s_add_u32 s10, s11, 6144
    buffer_load_dwordx4 v8, s[32:35], s10 offen sc1 lds
    v_xor_b32 v7, 48, v4
    s_add_u32 m0, s12, 33792
    s_add_u32 s10, s11, 9216
    buffer_load_dwordx4 v7, s[32:35], s10 offen sc1 lds
    v_xor_b32 v8, 48, v5
    s_add_u32 m0, s12, 34816
    s_add_u32 s10, s11, 9216
    buffer_load_dwordx4 v8, s[32:35], s10 offen sc1 lds
    v_xor_b32 v7, 48, v6
    s_add_u32 m0, s12, 35840
    s_add_u32 s10, s11, 9216
    buffer_load_dwordx4 v7, s[32:35], s10 offen sc1 lds
    s_add_u32 m0, s9, 24576
    s_add_u32 s10, s13, 0
    buffer_load_dwordx4 v4, s[32:35], s10 offen sc1 lds
    s_add_u32 m0, s9, 25600
    s_add_u32 s10, s13, 0
    buffer_load_dwordx4 v5, s[32:35], s10 offen sc1 lds
    s_add_u32 m0, s9, 26624
    s_add_u32 s10, s13, 0
    buffer_load_dwordx4 v6, s[32:35], s10 offen sc1 lds
    v_xor_b32 v8, 16, v4
    s_add_u32 m0, s9, 27648
    s_add_u32 s10, s13, 3072
    buffer_load_dwordx4 v8, s[32:35], s10 offen sc1 lds
    s_branch L2_qd
L2_qn2:
    v_xor_b32 v7, 16, v5
    s_add_u32 m0, s9, 28672
    s_add_u32 s10, s13, 3072
    buffer_load_dwordx4 v7, s[32:35], s10 offen sc1 lds
    v_xor_b32 v8, 16, v6
    s_add_u32 m0, s9, 29696
    s_add_u32 s10, s13, 3072
    buffer_load_dwordx4 v8, s[32:35], s10 offen sc1 lds
    v_xor_b32 v7, 32, v4
    s_add_u32 m0, s9, 30720
    s_add_u32 s10, s13, 6144
    buffer_load_dwordx4 v7, s[32:35], s10 offen sc1 lds
    v_xor_b32 v8, 32, v5
    s_add_u32 m0, s9, 31744
    s_add_u32 s10, s13, 6144
    buffer_load_dwordx4 v8, s[32:35], s10 offen sc1 lds
    v_xor_b32 v7, 32, v6
    s_add_u32 m0, s9, 32768
    s_add_u32 s10, s13, 6144
    buffer_load_dwordx4 v7, s[32:35], s10 offen sc1 lds
    v_xor_b32 v8, 48, v4
    s_add_u32 m0, s9, 33792
    s_add_u32 s10, s13, 9216
    buffer_load_dwordx4 v8, s[32:35], s10 offen sc1 lds
    v_xor_b32 v7, 48, v5
    s_add_u32 m0, s9, 34816
    s_add_u32 s10, s13, 9216
    buffer_load_dwordx4 v7, s[32:35], s10 offen sc1 lds
    v_xor_b32 v8, 48, v6
    s_add_u32 m0, s9, 35840
    s_add_u32 s10, s13, 9216
    buffer_load_dwordx4 v8, s[32:35], s10 offen sc1 lds
L2_qd:
    s_add_u32 s56, s15, 0
    s_cmp_ge_u32 s56, 6
    s_cselect_b32 s12, 6, 0
    s_sub_u32 s56, s56, s12
    s_mul_i32 s56, s56, 98304
    s_add_u32 s56, s56, s14
    s_add_u32 m0, s8, 0
    s_add_u32 s10, s56, 0
    buffer_load_dwordx4 v4, s[32:35], s10 offen sc1 lds
    s_add_u32 m0, s8, 1024
    s_add_u32 s10, s56, 0
    buffer_load_dwordx4 v5, s[32:35], s10 offen sc1 lds
    s_add_u32 m0, s8, 2048
    s_add_u32 s10, s56, 0
    buffer_load_dwordx4 v6, s[32:35], s10 offen sc1 lds
    v_xor_b32 v7, 16, v4
    s_add_u32 m0, s8, 3072
    s_add_u32 s10, s56, 3072
    buffer_load_dwordx4 v7, s[32:35], s10 offen sc1 lds
    v_xor_b32 v8, 16, v5
    s_add_u32 m0, s8, 4096
    s_add_u32 s10, s56, 3072
    buffer_load_dwordx4 v8, s[32:35], s10 offen sc1 lds
    v_xor_b32 v7, 16, v6
    s_add_u32 m0, s8, 5120
    s_add_u32 s10, s56, 3072
    buffer_load_dwordx4 v7, s[32:35], s10 offen sc1 lds
    v_xor_b32 v8, 32, v4
    s_add_u32 m0, s8, 6144
    s_add_u32 s10, s56, 6144
    buffer_load_dwordx4 v8, s[32:35], s10 offen sc1 lds
    v_xor_b32 v7, 32, v5
    s_add_u32 m0, s8, 7168
    s_add_u32 s10, s56, 6144
    buffer_load_dwordx4 v7, s[32:35], s10 offen sc1 lds
    v_xor_b32 v8, 32, v6
    s_add_u32 m0, s8, 8192
    s_add_u32 s10, s56, 6144
    buffer_load_dwordx4 v8, s[32:35], s10 offen sc1 lds
    v_xor_b32 v7, 48, v4
    s_add_u32 m0, s8, 9216
    s_add_u32 s10, s56, 9216
    buffer_load_dwordx4 v7, s[32:35], s10 offen sc1 lds
    v_xor_b32 v8, 48, v5
    s_add_u32 m0, s8, 10240
    s_add_u32 s10, s56, 9216
    buffer_load_dwordx4 v8, s[32:35], s10 offen sc1 lds
    v_xor_b32 v7, 48, v6
    s_add_u32 m0, s8, 11264
    s_add_u32 s10, s56, 9216
    buffer_load_dwordx4 v7, s[32:35], s10 offen sc1 lds
    s_add_u32 s57, s15, 0
    s_cmp_ge_u32 s57, 6
    s_cselect_b32 s12, 6, 0
    s_sub_u32 s57, s57, s12
    s_mul_i32 s57, s57, 98304
    s_add_u32 s57, s57, s14
    s_add_u32 s57, s57, 12288
    s_add_u32 m0, s8, 12288
    s_add_u32 s10, s57, 0
    buffer_load_dwordx4 v4, s[32:35], s10 offen sc1 lds
    s_add_u32 m0, s8, 13312
    s_add_u32 s10, s57, 0
    buffer_load_dwordx4 v5, s[32:35], s10 offen sc1 lds
    s_add_u32 m0, s8, 14336
    s_add_u32 s10, s57, 0
    buffer_load_dwordx4 v6, s[32:35], s10 offen sc1 lds
    v_xor_b32 v8, 16, v4
    s_add_u32 m0, s8, 15360
    s_add_u32 s10, s57, 3072
    buffer_load_dwordx4 v8, s[32:35], s10 offen sc1 lds
    v_xor_b32 v7, 16, v5
    s_add_u32 m0, s8, 16384
    s_add_u32 s10, s57, 3072
    buffer_load_dwordx4 v7, s[32:35], s10 offen sc1 lds
    v_xor_b32 v8, 16, v6
    s_add_u32 m0, s8, 17408
    s_add_u32 s10, s57, 3072
    buffer_load_dwordx4 v8, s[32:35], s10 offen sc1 lds
    v_xor_b32 v7, 32, v4
    s_add_u32 m0, s8, 18432
    s_add_u32 s10, s57, 6144
    buffer_load_dwordx4 v7, s[32:35], s10 offen sc1 lds
    v_xor_b32 v8, 32, v5
    s_add_u32 m0, s8, 19456
    s_add_u32 s10, s57, 6144
    buffer_load_dwordx4 v8, s[32:35], s10 offen sc1 lds
    v_xor_b32 v7, 32, v6
    s_add_u32 m0, s8, 20480
    s_add_u32 s10, s57, 6144
    buffer_load_dwordx4 v7, s[32:35], s10 offen sc1 lds
    v_xor_b32 v8, 48, v4
    s_add_u32 m0, s8, 21504
    s_add_u32 s10, s57, 9216
    buffer_load_dwordx4 v8, s[32:35], s10 offen sc1 lds
    v_xor_b32 v7, 48, v5
    s_add_u32 m0, s8, 22528
    s_add_u32 s10, s57, 9216
    buffer_load_dwordx4 v7, s[32:35], s10 offen sc1 lds
    v_xor_b32 v8, 48, v6
    s_add_u32 m0, s8, 23552
    s_add_u32 s10, s57, 9216
    buffer_load_dwordx4 v8, s[32:35], s10 offen sc1 lds
    s_waitcnt vmcnt(24)
    s_barrier
    ds_read_b128 v[112:115], v56 offset:0
    ds_read_b128 v[116:119], v57 offset:0
    ds_read_b128 v[120:123], v58 offset:0
    ds_read_b128 v[124:127], v59 offset:0
    ds_read_b128 v[128:131], v60 offset:0
    ds_read_b128 v[132:135], v61 offset:0
    ds_read_b128 v[136:139], v62 offset:0
    ds_read_b128 v[140:143], v63 offset:0
    s_waitcnt lgkmcnt(7)
    s_waitcnt vmcnt(63)
    v_mfma_f32_32x32x16_bf16 v[64:79], a[0:3], v[112:115], 0
    s_add_u32 s59, s58, 20480
    buffer_load_dwordx4 a[0:3], v34, s[36:39], s59 offen offset:0 sc1
    s_waitcnt vmcnt(63)
    v_mfma_f32_32x32x16_bf16 v[80:95], a[4:7], v[112:115], 0
    s_add_u32 s59, s58, 45056
    buffer_load_dwordx4 a[4:7], v34, s[36:39], s59 offen offset:0 sc1
    s_waitcnt vmcnt(63)
    v_mfma_f32_32x32x16_bf16 v[96:111], a[8:11], v[112:115], 0
    s_add_u32 s59, s58, 69632
    buffer_load_dwordx4 a[8:11], v34, s[36:39], s59 offen offset:0 sc1
    ds_read_b128 v[112:115], v56 offset:256
    s_waitcnt lgkmcnt(7)
    s_waitcnt vmcnt(63)
    v_mfma_f32_32x32x16_bf16 v[64:79], a[12:15], v[116:119], v[64:79]
    s_add_u32 s59, s58, 20480
    buffer_load_dwordx4 a[12:15], v34, s[36:39], s59 offen offset:1024 sc1
    s_waitcnt vmcnt(63)
    v_mfma_f32_32x32x16_bf16 v[80:95], a[16:19], v[116:119], v[80:95]
    s_add_u32 s59, s58, 45056
    buffer_load_dwordx4 a[16:19], v34, s[36:39], s59 offen offset:1024 sc1
    s_waitcnt vmcnt(63)
    v_mfma_f32_32x32x16_bf16 v[96:111], a[20:23], v[116:119], v[96:111]
    s_add_u32 s59, s58, 69632
    buffer_load_dwordx4 a[20:23], v34, s[36:39], s59 offen offset:1024 sc1
    ds_read_b128 v[116:119], v57 offset:256
    s_waitcnt lgkmcnt(7)
    s_waitcnt vmcnt(63)
    v_mfma_f32_32x32x16_bf16 v[64:79], a[24:27], v[120:123], v[64:79]
    s_add_u32 s59, s58, 20480
    buffer_load_dwordx4 a[24:27], v34, s[36:39], s59 offen offset:2048 sc1
    s_waitcnt vmcnt(63)
    v_mfma_f32_32x32x16_bf16 v[80:95], a[28:31], v[120:123], v[80:95]
    s_add_u32 s59, s58, 45056
    buffer_load_dwordx4 a[28:31], v34, s[36:39], s59 offen offset:2048 sc1
    s_waitcnt vmcnt(63)
    v_mfma_f32_32x32x16_bf16 v[96:111], a[32:35], v[120:123], v[96:111]
    s_add_u32 s59, s58, 69632
    buffer_load_dwordx4 a[32:35], v34, s[36:39], s59 offen offset:2048 sc1
    ds_read_b128 v[120:123], v58 offset:256
    s_waitcnt lgkmcnt(7)
    s_waitcnt vmcnt(63)
    v_mfma_f32_32x32x16_bf16 v[64:79], a[36:39], v[124:127], v[64:79]
    s_add_u32 s59, s58, 20480
    buffer_load_dwordx4 a[36:39], v34, s[36:39], s59 offen offset:3072 sc1
    s_waitcnt vmcnt(63)
    v_mfma_f32_32x32x16_bf16 v[80:95], a[40:43], v[124:127], v[80:95]
    s_add_u32 s59, s58, 45056
    buffer_load_dwordx4 a[40:43], v34, s[36:39], s59 offen offset:3072 sc1
    s_waitcnt vmcnt(63)
    v_mfma_f32_32x32x16_bf16 v[96:111], a[44:47], v[124:127], v[96:111]
    s_add_u32 s59, s58, 69632
    buffer_load_dwordx4 a[44:47], v34, s[36:39], s59 offen offset:3072 sc1
    ds_read_b128 v[124:127], v59 offset:256
    s_waitcnt lgkmcnt(7)
    s_waitcnt vmcnt(63)
    v_mfma_f32_32x32x16_bf16 v[64:79], a[48:51], v[128:131], v[64:79]
    s_waitcnt vmcnt(63)
    v_mfma_f32_32x32x16_bf16 v[80:95], a[52:55], v[128:131], v[80:95]
    s_waitcnt vmcnt(63)
    v_mfma_f32_32x32x16_bf16 v[96:111], a[56:59], v[128:131], v[96:111]
    ds_read_b128 v[128:131], v60 offset:256
    s_waitcnt lgkmcnt(7)
    s_waitcnt vmcnt(63)
    v_mfma_f32_32x32x16_bf16 v[64:79], a[60:63], v[132:135], v[64:79]
    s_waitcnt vmcnt(63)
    v_mfma_f32_32x32x16_bf16 v[80:95], a[64:67], v[132:135], v[80:95]
    s_waitcnt vmcnt(63)
    v_mfma_f32_32x32x16_bf16 v[96:111], a[68:71], v[132:135], v[96:111]
    ds_read_b128 v[132:135], v61 offset:256
    s_waitcnt lgkmcnt(7)
    s_waitcnt vmcnt(63)
    v_mfma_f32_32x32x16_bf16 v[64:79], a[72:75], v[136:139], v[64:79]
    s_waitcnt vmcnt(63)
    v_mfma_f32_32x32x16_bf16 v[80:95], a[76:79], v[136:139], v[80:95]
    s_waitcnt vmcnt(63)
    v_mfma_f32_32x32x16_bf16 v[96:111], a[80:83], v[136:139], v[96:111]
    ds_read_b128 v[136:139], v62 offset:256
    s_waitcnt lgkmcnt(7)
    s_waitcnt vmcnt(63)
    v_mfma_f32_32x32x16_bf16 v[64:79], a[84:87], v[140:143], v[64:79]
    s_waitcnt vmcnt(63)
    v_mfma_f32_32x32x16_bf16 v[80:95], a[88:91], v[140:143], v[80:95]
    s_waitcnt vmcnt(63)
    v_mfma_f32_32x32x16_bf16 v[96:111], a[92:95], v[140:143], v[96:111]
    ds_read_b128 v[140:143], v63 offset:256
    s_waitcnt lgkmcnt(7)
    s_waitcnt vmcnt(63)
    v_mfma_f32_32x32x16_bf16 v[64:79], a[96:99], v[112:115], v[64:79]
    s_waitcnt vmcnt(63)
    v_mfma_f32_32x32x16_bf16 v[80:95], a[100:103], v[112:115], v[80:95]
    s_waitcnt vmcnt(63)
    v_mfma_f32_32x32x16_bf16 v[96:111], a[104:107], v[112:115], v[96:111]
    ds_read_b128 v[112:115], v56 offset:512
    s_waitcnt lgkmcnt(7)
    s_waitcnt vmcnt(63)
    v_mfma_f32_32x32x16_bf16 v[64:79], a[108:111], v[116:119], v[64:79]
    s_waitcnt vmcnt(63)
    v_mfma_f32_32x32x16_bf16 v[80:95], a[112:115], v[116:119], v[80:95]
    s_waitcnt vmcnt(63)
    v_mfma_f32_32x32x16_bf16 v[96:111], a[116:119], v[116:119], v[96:111]
    ds_read_b128 v[116:119], v57 offset:512
    s_waitcnt lgkmcnt(7)
    s_waitcnt vmcnt(63)
    v_mfma_f32_32x32x16_bf16 v[64:79], a[120:123], v[120:123], v[64:79]
    s_waitcnt vmcnt(63)
    v_mfma_f32_32x32x16_bf16 v[80:95], a[124:127], v[120:123], v[80:95]
    s_waitcnt vmcnt(63)
    v_mfma_f32_32x32x16_bf16 v[96:111], a[128:131], v[120:123], v[96:111]
    ds_read_b128 v[120:123], v58 offset:512
    s_waitcnt lgkmcnt(7)
    s_waitcnt vmcnt(63)
    v_mfma_f32_32x32x16_bf16 v[64:79], a[132:135], v[124:127], v[64:79]
    s_waitcnt vmcnt(63)
    v_mfma_f32_32x32x16_bf16 v[80:95], a[136:139], v[124:127], v[80:95]
    s_waitcnt vmcnt(63)
    v_mfma_f32_32x32x16_bf16 v[96:111], a[140:143], v[124:127], v[96:111]
    ds_read_b128 v[124:127], v59 offset:512
    s_waitcnt lgkmcnt(7)
    s_waitcnt vmcnt(63)
    v_mfma_f32_32x32x16_bf16 v[64:79], a[144:147], v[128:131], v[64:79]
    s_waitcnt vmcnt(63)
    v_mfma_f32_32x32x16_bf16 v[80:95], a[148:151], v[128:131], v[80:95]
    s_waitcnt vmcnt(63)
    v_mfma_f32_32x32x16_bf16 v[96:111], a[152:155], v[128:131], v[96:111]
    ds_read_b128 v[128:131], v60 offset:512
    s_waitcnt lgkmcnt(7)
    s_waitcnt vmcnt(63)
    v_mfma_f32_32x32x16_bf16 v[64:79], a[156:159], v[132:135], v[64:79]
    s_waitcnt vmcnt(63)
    v_mfma_f32_32x32x16_bf16 v[80:95], a[160:163], v[132:135], v[80:95]
    s_waitcnt vmcnt(62)
    v_mfma_f32_32x32x16_bf16 v[96:111], a[164:167], v[132:135], v[96:111]
    ds_read_b128 v[132:135], v61 offset:512
    s_waitcnt lgkmcnt(7)
    s_waitcnt vmcnt(61)
    v_mfma_f32_32x32x16_bf16 v[64:79], a[168:171], v[136:139], v[64:79]
    s_waitcnt vmcnt(60)
    v_mfma_f32_32x32x16_bf16 v[80:95], a[172:175], v[136:139], v[80:95]
    s_waitcnt vmcnt(59)
    v_mfma_f32_32x32x16_bf16 v[96:111], a[176:179], v[136:139], v[96:111]
    ds_read_b128 v[136:139], v62 offset:512
    s_waitcnt lgkmcnt(7)
    s_waitcnt vmcnt(58)
    v_mfma_f32_32x32x16_bf16 v[64:79], a[180:183], v[140:143], v[64:79]
    s_waitcnt vmcnt(57)
    v_mfma_f32_32x32x16_bf16 v[80:95], a[184:187], v[140:143], v[80:95]
    s_waitcnt vmcnt(56)
    v_mfma_f32_32x32x16_bf16 v[96:111], a[188:191], v[140:143], v[96:111]
    ds_read_b128 v[140:143], v63 offset:512
    s_waitcnt lgkmcnt(7)
    s_waitcnt vmcnt(55)
    v_mfma_f32_32x32x16_bf16 v[64:79], a[192:195], v[112:115], v[64:79]
    s_waitcnt vmcnt(54)
    v_mfma_f32_32x32x16_bf16 v[80:95], a[196:199], v[112:115], v[80:95]
    s_waitcnt vmcnt(53)
    v_mfma_f32_32x32x16_bf16 v[96:111], a[200:203], v[112:115], v[96:111]
    s_waitcnt lgkmcnt(6)
    s_waitcnt vmcnt(52)
    v_mfma_f32_32x32x16_bf16 v[64:79], a[204:207], v[116:119], v[64:79]
    s_waitcnt vmcnt(51)
    v_mfma_f32_32x32x16_bf16 v[80:95], a[208:211], v[116:119], v[80:95]
    s_waitcnt vmcnt(50)
    v_mfma_f32_32x32x16_bf16 v[96:111], a[212:215], v[116:119], v[96:111]
    s_waitcnt lgkmcnt(5)
    s_waitcnt vmcnt(49)
    v_mfma_f32_32x32x16_bf16 v[64:79], a[216:219], v[120:123], v[64:79]
    s_waitcnt vmcnt(48)
    v_mfma_f32_32x32x16_bf16 v[80:95], a[220:223], v[120:123], v[80:95]
    s_waitcnt vmcnt(47)
    v_mfma_f32_32x32x16_bf16 v[96:111], a[224:227], v[120:123], v[96:111]
    s_waitcnt lgkmcnt(4)
    s_waitcnt vmcnt(46)
    v_mfma_f32_32x32x16_bf16 v[64:79], a[228:231], v[124:127], v[64:79]
    s_waitcnt vmcnt(45)
    v_mfma_f32_32x32x16_bf16 v[80:95], a[232:235], v[124:127], v[80:95]
    s_waitcnt vmcnt(44)
    v_mfma_f32_32x32x16_bf16 v[96:111], a[236:239], v[124:127], v[96:111]
    s_waitcnt lgkmcnt(3)
    s_waitcnt vmcnt(11)
    v_mfma_f32_32x32x16_bf16 v[64:79], a[0:3], v[128:131], v[64:79]
    s_waitcnt vmcnt(10)
    v_mfma_f32_32x32x16_bf16 v[80:95], a[4:7], v[128:131], v[80:95]
    s_waitcnt vmcnt(9)
    v_mfma_f32_32x32x16_bf16 v[96:111], a[8:11], v[128:131], v[96:111]
    s_waitcnt lgkmcnt(2)
    s_waitcnt vmcnt(8)
    v_mfma_f32_32x32x16_bf16 v[64:79], a[12:15], v[132:135], v[64:79]
    s_waitcnt vmcnt(7)
    v_mfma_f32_32x32x16_bf16 v[80:95], a[16:19], v[132:135], v[80:95]
    s_waitcnt vmcnt(6)
    v_mfma_f32_32x32x16_bf16 v[96:111], a[20:23], v[132:135], v[96:111]
    s_waitcnt lgkmcnt(1)
    s_waitcnt vmcnt(5)
    v_mfma_f32_32x32x16_bf16 v[64:79], a[24:27], v[136:139], v[64:79]
    s_waitcnt vmcnt(4)
    v_mfma_f32_32x32x16_bf16 v[80:95], a[28:31], v[136:139], v[80:95]
    s_waitcnt vmcnt(3)
    v_mfma_f32_32x32x16_bf16 v[96:111], a[32:35], v[136:139], v[96:111]
    s_waitcnt lgkmcnt(0)
    s_waitcnt vmcnt(2)
    v_mfma_f32_32x32x16_bf16 v[64:79], a[36:39], v[140:143], v[64:79]
    s_waitcnt vmcnt(1)
    v_mfma_f32_32x32x16_bf16 v[80:95], a[40:43], v[140:143], v[80:95]
    s_waitcnt vmcnt(0)
    v_mfma_f32_32x32x16_bf16 v[96:111], a[44:47], v[140:143], v[96:111]
    s_nop 15
    v_cvt_pk_bf16_f32 v112, v64, v65
    v_cvt_pk_bf16_f32 v113, v66, v67
    v_cvt_pk_bf16_f32 v114, v68, v69
    v_cvt_pk_bf16_f32 v115, v70, v71
    v_cvt_pk_bf16_f32 v116, v72, v73
    v_cvt_pk_bf16_f32 v117, v74, v75
    v_cvt_pk_bf16_f32 v118, v76, v77
    v_cvt_pk_bf16_f32 v119, v78, v79
    v_cvt_pk_bf16_f32 v120, v80, v81
    v_cvt_pk_bf16_f32 v121, v82, v83
    v_cvt_pk_bf16_f32 v122, v84, v85
    v_cvt_pk_bf16_f32 v123, v86, v87
    v_cvt_pk_bf16_f32 v124, v88, v89
    v_cvt_pk_bf16_f32 v125, v90, v91
    v_cvt_pk_bf16_f32 v126, v92, v93
    v_cvt_pk_bf16_f32 v127, v94, v95
    v_cvt_pk_bf16_f32 v128, v96, v97
    v_cvt_pk_bf16_f32 v129, v98, v99
    v_cvt_pk_bf16_f32 v130, v100, v101
    v_cvt_pk_bf16_f32 v131, v102, v103
    v_cvt_pk_bf16_f32 v132, v104, v105
    v_cvt_pk_bf16_f32 v133, v106, v107
    v_cvt_pk_bf16_f32 v134, v108, v109
    v_cvt_pk_bf16_f32 v135, v110, v111
    s_nop 1
    v_permlane32_swap_b32 v112, v114
    v_permlane32_swap_b32 v113, v115
    v_permlane32_swap_b32 v116, v118
    v_permlane32_swap_b32 v117, v119
    v_permlane32_swap_b32 v120, v122
    v_permlane32_swap_b32 v121, v123
    v_permlane32_swap_b32 v124, v126
    v_permlane32_swap_b32 v125, v127
    v_permlane32_swap_b32 v128, v130
    v_permlane32_swap_b32 v129, v131
    v_permlane32_swap_b32 v132, v134
    v_permlane32_swap_b32 v133, v135
    s_lshr_b32 s12, s3, 1
    s_mul_i32 s12, s12, 36864
    s_and_b32 s9, s3, 1
    s_mul_i32 s9, s9, 6144
    s_add_u32 s12, s12, s9
    s_add_u32 s12, s12, 98304
    v_add_u32 v35, s12, v34
    s_nop 1
    ds_write_b128 v35, v[112:115] offset:0
    ds_write_b128 v35, v[116:119] offset:1024
    ds_write_b128 v35, v[120:123] offset:2048
    ds_write_b128 v35, v[124:127] offset:3072
    ds_write_b128 v35, v[128:131] offset:4096
    ds_write_b128 v35, v[132:135] offset:5120
    v_add_u32 v35, 98304, v34
    v_add_u32 v36, 135168, v34
    s_waitcnt lgkmcnt(0)
    s_barrier
    ds_read_b128 a[0:3], v35 offset:0
    ds_read_b128 a[4:7], v35 offset:1024
    ds_read_b128 a[8:11], v35 offset:2048
    ds_read_b128 a[12:15], v35 offset:3072
    ds_read_b128 a[16:19], v35 offset:4096
    ds_read_b128 a[20:23], v35 offset:5120
    ds_read_b128 a[24:27], v35 offset:6144
    ds_read_b128 a[28:31], v35 offset:7168
    ds_read_b128 a[32:35], v35 offset:8192
    ds_read_b128 a[36:39], v35 offset:9216
    ds_read_b128 a[40:43], v35 offset:10240
    ds_read_b128 a[44:47], v35 offset:11264
    ds_read_b128 a[48:51], v36 offset:0
    ds_read_b128 a[52:55], v36 offset:1024
    ds_read_b128 a[56:59], v36 offset:2048
    ds_read_b128 a[60:63], v36 offset:3072
    ds_read_b128 a[64:67], v36 offset:4096
    ds_read_b128 a[68:71], v36 offset:5120
    ds_read_b128 a[72:75], v36 offset:6144
    ds_read_b128 a[76:79], v36 offset:7168
    ds_read_b128 a[80:83], v36 offset:8192
    ds_read_b128 a[84:87], v36 offset:9216
    ds_read_b128 a[88:91], v36 offset:10240
    ds_read_b128 a[92:95], v36 offset:11264
    s_waitcnt lgkmcnt(0)
    s_barrier
    v_lshlrev_b32 v63, 4, v1
    s_mul_i32 s58, s3, 73728
    s_waitcnt vmcnt(12)
    ds_read_b128 a[192:195], v9 offset:0
    ds_read_b128 a[196:199], v10 offset:0
    ds_read_b128 a[200:203], v11 offset:0
    ds_read_b128 a[204:207], v12 offset:0
    ds_read_b128 a[208:211], v13 offset:0
    ds_read_b128 a[212:215], v14 offset:0
    s_waitcnt lgkmcnt(5)
    v_mfma_f32_32x32x16_bf16 v[32:47], a[192:195], a[0:3], 0
    ds_read_b128 a[216:219], v15 offset:0
    s_waitcnt lgkmcnt(5)
    v_mfma_f32_32x32x16_bf16 v[32:47], a[196:199], a[4:7], v[32:47]
    s_add_u32 s56, s15, 1
    s_cmp_ge_u32 s56, 6
    s_cselect_b32 s12, 6, 0
    s_sub_u32 s56, s56, s12
    s_mul_i32 s56, s56, 98304
    s_add_u32 s56, s56, s14
    s_add_u32 m0, s8, 24576
    s_add_u32 s10, s56, 0
    buffer_load_dwordx4 v4, s[32:35], s10 offen sc1 lds
    ds_read_b128 a[220:223], v16 offset:0
    ds_read_b64_tr_b16 a[96:97], v20 offset:0
    ds_read_b64_tr_b16 a[98:99], v24 offset:0
    s_waitcnt lgkmcnt(7)
    v_mfma_f32_32x32x16_bf16 v[32:47], a[200:203], a[8:11], v[32:47]
    ds_read_b128 a[192:195], v9 offset:256
    ds_read_b64_tr_b16 a[104:105], v21 offset:0
    ds_read_b64_tr_b16 a[106:107], v25 offset:0
    s_waitcnt lgkmcnt(9)
    v_mfma_f32_32x32x16_bf16 v[32:47], a[204:207], a[12:15], v[32:47]
    s_add_u32 m0, s8, 25600
    s_add_u32 s10, s56, 0
    buffer_load_dwordx4 v5, s[32:35], s10 offen sc1 lds
    ds_read_b128 a[196:199], v10 offset:256
    ds_read_b64_tr_b16 a[112:113], v22 offset:0
    ds_read_b64_tr_b16 a[114:115], v26 offset:0
    s_waitcnt lgkmcnt(11)
    v_mfma_f32_32x32x16_bf16 v[32:47], a[208:211], a[16:19], v[32:47]
    ds_read_b128 a[200:203], v11 offset:256
    ds_read_b64_tr_b16 a[120:121], v23 offset:0
    ds_read_b64_tr_b16 a[122:123], v27 offset:0
    s_waitcnt lgkmcnt(13)
    v_mfma_f32_32x32x16_bf16 v[32:47], a[212:215], a[20:23], v[32:47]
    s_add_u32 m0, s8, 26624
    s_add_u32 s10, s56, 0
    buffer_load_dwordx4 v6, s[32:35], s10 offen sc1 lds
    ds_read_b128 a[204:207], v12 offset:256
    ds_read_b64_tr_b16 a[128:129], v20 offset:256
    ds_read_b64_tr_b16 a[130:131], v24 offset:256
    s_waitcnt lgkmcnt(15)
    v_mfma_f32_32x32x16_bf16 v[32:47], a[216:219], a[24:27], v[32:47]
    ds_read_b128 a[208:211], v13 offset:256
    ds_read_b64_tr_b16 a[136:137], v21 offset:256
    ds_read_b64_tr_b16 a[138:139], v25 offset:256
    s_waitcnt lgkmcnt(15)
    v_mfma_f32_32x32x16_bf16 v[32:47], a[220:223], a[28:31], v[32:47]
    v_xor_b32 v7, 16, v4
    s_add_u32 m0, s8, 27648
    s_add_u32 s10, s56, 3072
    buffer_load_dwordx4 v7, s[32:35], s10 offen sc1 lds
    ds_read_b128 a[212:215], v14 offset:256
    ds_read_b64_tr_b16 a[144:145], v22 offset:256
    ds_read_b64_tr_b16 a[146:147], v26 offset:256
    s_waitcnt lgkmcnt(15)
    v_mfma_f32_32x32x16_bf16 v[32:47], a[192:195], a[32:35], v[32:47]
    ds_read_b128 a[216:219], v15 offset:256
    ds_read_b64_tr_b16 a[152:153], v23 offset:256
    ds_read_b64_tr_b16 a[154:155], v27 offset:256
    s_waitcnt lgkmcnt(15)
    v_mfma_f32_32x32x16_bf16 v[32:47], a[196:199], a[36:39], v[32:47]
    v_xor_b32 v8, 16, v5
    s_add_u32 m0, s8, 28672
    s_add_u32 s10, s56, 3072
    buffer_load_dwordx4 v8, s[32:35], s10 offen sc1 lds
    ds_read_b128 a[220:223], v16 offset:256
    ds_read_b64_tr_b16 a[160:161], v20 offset:512
    ds_read_b64_tr_b16 a[162:163], v24 offset:512
    s_waitcnt lgkmcnt(15)
    v_mfma_f32_32x32x16_bf16 v[32:47], a[200:203], a[40:43], v[32:47]
    ds_read_b128 a[192:195], v9 offset:512
    ds_read_b64_tr_b16 a[168:169], v21 offset:512
    ds_read_b64_tr_b16 a[170:171], v25 offset:512
    s_waitcnt lgkmcnt(15)
    v_mfma_f32_32x32x16_bf16 v[32:47], a[204:207], a[44:47], v[32:47]
    v_xor_b32 v7, 16, v6
    s_add_u32 m0, s8, 29696
    s_add_u32 s10, s56, 3072
    buffer_load_dwordx4 v7, s[32:35], s10 offen sc1 lds
    ds_read_b128 a[196:199], v10 offset:512
    ds_read_b64_tr_b16 a[176:177], v22 offset:512
    ds_read_b64_tr_b16 a[178:179], v26 offset:512
    s_waitcnt lgkmcnt(15)
    v_mfma_f32_32x32x16_bf16 v[32:47], a[208:211], a[48:51], v[32:47]
    ds_read_b128 a[200:203], v11 offset:512
    ds_read_b64_tr_b16 a[184:185], v23 offset:512
    ds_read_b64_tr_b16 a[186:187], v27 offset:512
    s_waitcnt lgkmcnt(15)
    v_mfma_f32_32x32x16_bf16 v[32:47], a[212:215], a[52:55], v[32:47]
    v_xor_b32 v8, 32, v4
    s_add_u32 m0, s8, 30720
    s_add_u32 s10, s56, 6144
    buffer_load_dwordx4 v8, s[32:35], s10 offen sc1 lds
    ds_read_b128 a[204:207], v12 offset:512
    ds_read_b64_tr_b16 a[100:101], v20 offset:12288
    ds_read_b64_tr_b16 a[102:103], v24 offset:12288
    s_waitcnt lgkmcnt(15)
    v_mfma_f32_32x32x16_bf16 v[32:47], a[216:219], a[56:59], v[32:47]
    ds_read_b128 a[208:211], v13 offset:512
    ds_read_b64_tr_b16 a[108:109], v21 offset:12288
    ds_read_b64_tr_b16 a[110:111], v25 offset:12288
    s_waitcnt lgkmcnt(15)
    v_mfma_f32_32x32x16_bf16 v[32:47], a[220:223], a[60:63], v[32:47]
    v_xor_b32 v7, 32, v5
    s_add_u32 m0, s8, 31744
    s_add_u32 s10, s56, 6144
    buffer_load_dwordx4 v7, s[32:35], s10 offen sc1 lds
    ds_read_b128 a[212:215], v14 offset:512
    ds_read_b64_tr_b16 a[116:117], v22 offset:12288
    ds_read_b64_tr_b16 a[118:119], v26 offset:12288
    s_waitcnt lgkmcnt(15)
    v_mfma_f32_32x32x16_bf16 v[32:47], a[192:195], a[64:67], v[32:47]
    ds_read_b128 a[216:219], v15 offset:512
    ds_read_b64_tr_b16 a[124:125], v23 offset:12288
    ds_read_b64_tr_b16 a[126:127], v27 offset:12288
    s_waitcnt lgkmcnt(15)
    v_mfma_f32_32x32x16_bf16 v[32:47], a[196:199], a[68:71], v[32:47]
    v_xor_b32 v8, 32, v6
    s_add_u32 m0, s8, 32768
    s_add_u32 s10, s56, 6144
    buffer_load_dwordx4 v8, s[32:35], s10 offen sc1 lds
    ds_read_b128 a[220:223], v16 offset:512
    ds_read_b64_tr_b16 a[132:133], v20 offset:12544
    ds_read_b64_tr_b16 a[134:135], v24 offset:12544
    s_waitcnt lgkmcnt(15)
    v_mfma_f32_32x32x16_bf16 v[32:47], a[200:203], a[72:75], v[32:47]
    ds_read_b64_tr_b16 a[140:141], v21 offset:12544
    ds_read_b64_tr_b16 a[142:143], v25 offset:12544
    s_waitcnt lgkmcnt(15)
    v_mfma_f32_32x32x16_bf16 v[32:47], a[204:207], a[76:79], v[32:47]
    v_xor_b32 v7, 48, v4
    s_add_u32 m0, s8, 33792
    s_add_u32 s10, s56, 9216
    buffer_load_dwordx4 v7, s[32:35], s10 offen sc1 lds
    ds_read_b64_tr_b16 a[148:149], v22 offset:12544
    ds_read_b64_tr_b16 a[150:151], v26 offset:12544
    s_waitcnt lgkmcnt(15)
    v_mfma_f32_32x32x16_bf16 v[32:47], a[208:211], a[80:83], v[32:47]
    ds_read_b64_tr_b16 a[156:157], v23 offset:12544
    ds_read_b64_tr_b16 a[158:159], v27 offset:12544
    s_waitcnt lgkmcnt(14)
    v_mfma_f32_32x32x16_bf16 v[32:47], a[212:215], a[84:87], v[32:47]
    v_xor_b32 v8, 48, v5
    s_add_u32 m0, s8, 34816
    s_add_u32 s10, s56, 9216
    buffer_load_dwordx4 v8, s[32:35], s10 offen sc1 lds
    ds_read_b64_tr_b16 a[164:165], v20 offset:12800
    ds_read_b64_tr_b16 a[166:167], v24 offset:12800
    s_waitcnt lgkmcnt(13)
    v_mfma_f32_32x32x16_bf16 v[32:47], a[216:219], a[88:91], v[32:47]
    ds_read_b64_tr_b16 a[172:173], v21 offset:12800
    ds_read_b64_tr_b16 a[174:175], v25 offset:12800
    ds_read_b64_tr_b16 a[180:181], v22 offset:12800
    ds_read_b64_tr_b16 a[182:183], v26 offset:12800
    s_waitcnt lgkmcnt(14)
    v_mfma_f32_32x32x16_bf16 v[32:47], a[220:223], a[92:95], v[32:47]
    v_xor_b32 v7, 48, v6
    s_add_u32 m0, s8, 35840
    s_add_u32 s10, s56, 9216
    buffer_load_dwordx4 v7, s[32:35], s10 offen sc1 lds
    ds_read_b64_tr_b16 a[188:189], v23 offset:12800
    ds_read_b64_tr_b16 a[190:191], v27 offset:12800
    v_add_u32 v9, v9, v17
    v_add_u32 v10, v10, v17
    v_add_u32 v11, v11, v17
    v_add_u32 v12, v12, v17
    v_add_u32 v13, v13, v17
    v_add_u32 v14, v14, v17
    v_add_u32 v15, v15, v17
    v_add_u32 v16, v16, v17
    s_waitcnt lgkmcnt(0)
    s_add_u32 s57, s15, 1
    s_cmp_ge_u32 s57, 6
    s_cselect_b32 s12, 6, 0
    s_sub_u32 s57, s57, s12
    s_mul_i32 s57, s57, 98304
    s_add_u32 s57, s57, s14
    s_add_u32 s57, s57, 12288
    s_add_u32 m0, s8, 0
    s_add_u32 s10, s57, 0
    buffer_load_dwordx4 v4, s[32:35], s10 offen sc1 lds
    s_add_u32 m0, s8, 1024
    s_add_u32 s10, s57, 0
    buffer_load_dwordx4 v5, s[32:35], s10 offen sc1 lds
    s_add_u32 s60, s15, 0
    s_cmp_eq_u32 s60, 5
    s_cselect_b32 s12, 1, 0
    s_cmp_eq_u32 s60, 11
    s_cselect_b32 s12, 1, s12
    s_cmp_lg_u32 s12, 0
    s_cbranch_scc1 L2_mask0
L2_nomask0:
    v_max3_f32 v30, v32, v33, v34
    v_max3_f32 v30, v30, v35, v36
    v_max3_f32 v30, v30, v37, v38
    v_max3_f32 v30, v30, v39, v40
    v_max3_f32 v30, v30, v41, v42
    v_max3_f32 v30, v30, v43, v44
    v_max3_f32 v30, v30, v45, v46
    v_max_f32 v30, v30, v47
    v_mov_b32 v31, v30
    s_nop 1
    v_permlane32_swap_b32 v30, v31
    s_nop 1
    v_max_f32 v30, v30, v31
    s_add_u32 m0, s8, 2048
    s_add_u32 s10, s57, 0
    buffer_load_dwordx4 v6, s[32:35], s10 offen sc1 lds
    v_max_f32 v28, 0xf149f2ca, v30
    v_mov_b32 v29, 0
    v_sub_f32 v32, v32, v28
    v_sub_f32 v33, v33, v28
    v_sub_f32 v34, v34, v28
    v_sub_f32 v35, v35, v28
    v_sub_f32 v36, v36, v28
    v_sub_f32 v37, v37, v28
    v_sub_f32 v38, v38, v28
    v_sub_f32 v39, v39, v28
    v_exp_f32 v32, v32
    v_exp_f32 v33, v33
    v_exp_f32 v34, v34
    v_exp_f32 v35, v35
    v_exp_f32 v36, v36
    v_exp_f32 v37, v37
    v_exp_f32 v38, v38
    v_exp_f32 v39, v39
    v_xor_b32 v8, 16, v4
    s_add_u32 m0, s8, 3072
    s_add_u32 s10, s57, 3072
    buffer_load_dwordx4 v8, s[32:35], s10 offen sc1 lds
    v_cvt_pk_bf16_f32 v48, v32, v33
    v_cvt_pk_bf16_f32 v49, v34, v35
    v_cvt_pk_bf16_f32 v50, v36, v37
    v_cvt_pk_bf16_f32 v51, v38, v39
    s_nop 1
    v_mfma_f32_32x32x16_bf16 v[64:79], a[96:99], v[48:51], 0
    v_sub_f32 v40, v40, v28
    v_sub_f32 v41, v41, v28
    v_sub_f32 v42, v42, v28
    v_mfma_f32_32x32x16_bf16 v[80:95], a[104:107], v[48:51], 0
    v_sub_f32 v43, v43, v28
    v_sub_f32 v44, v44, v28
    v_sub_f32 v45, v45, v28
    v_xor_b32 v7, 16, v5
    s_add_u32 m0, s8, 4096
    s_add_u32 s10, s57, 3072
    buffer_load_dwordx4 v7, s[32:35], s10 offen sc1 lds
    v_mfma_f32_32x32x16_bf16 v[96:111], a[112:115], v[48:51], 0
    v_sub_f32 v46, v46, v28
    v_sub_f32 v47, v47, v28
    v_exp_f32 v40, v40
    v_mfma_f32_32x32x16_bf16 v[112:127], a[120:123], v[48:51], 0
    v_exp_f32 v41, v41
    v_exp_f32 v42, v42
    v_exp_f32 v43, v43
    v_xor_b32 v8, 16, v6
    s_add_u32 m0, s8, 5120
    s_add_u32 s10, s57, 3072
    buffer_load_dwordx4 v8, s[32:35], s10 offen sc1 lds
    v_mfma_f32_32x32x16_bf16 v[128:143], a[128:131], v[48:51], 0
    v_exp_f32 v44, v44
    v_exp_f32 v45, v45
    v_exp_f32 v46, v46
    v_mfma_f32_32x32x16_bf16 v[144:159], a[136:139], v[48:51], 0
    v_exp_f32 v47, v47
    v_add_f32 v30, v32, v33
    v_cvt_pk_bf16_f32 v52, v40, v41
    v_xor_b32 v7, 32, v4
    s_add_u32 m0, s8, 6144
    s_add_u32 s10, s57, 6144
    buffer_load_dwordx4 v7, s[32:35], s10 offen sc1 lds
    v_mfma_f32_32x32x16_bf16 v[160:175], a[144:147], v[48:51], 0
    v_cvt_pk_bf16_f32 v53, v42, v43
    v_cvt_pk_bf16_f32 v54, v44, v45
    v_cvt_pk_bf16_f32 v55, v46, v47
    v_mfma_f32_32x32x16_bf16 v[176:191], a[152:155], v[48:51], 0
    v_add_f32 v31, v34, v35
    v_add_f32 v30, v30, v36
    v_add_f32 v31, v31, v37
    v_xor_b32 v8, 32, v5
    s_add_u32 m0, s8, 7168
    s_add_u32 s10, s57, 6144
    buffer_load_dwordx4 v8, s[32:35], s10 offen sc1 lds
    v_mfma_f32_32x32x16_bf16 v[192:207], a[160:163], v[48:51], 0
    v_add_f32 v30, v30, v38
    v_add_f32 v31, v31, v39
    v_mfma_f32_32x32x16_bf16 v[208:223], a[168:171], v[48:51], 0
    v_add_f32 v30, v30, v40
    v_add_f32 v31, v31, v41
    v_xor_b32 v7, 32, v6
    s_add_u32 m0, s8, 8192
    s_add_u32 s10, s57, 6144
    buffer_load_dwordx4 v7, s[32:35], s10 offen sc1 lds
    v_mfma_f32_32x32x16_bf16 v[224:239], a[176:179], v[48:51], 0
    v_add_f32 v30, v30, v42
    v_add_f32 v31, v31, v43
    v_xor_b32 v8, 48, v4
    s_add_u32 m0, s8, 9216
    s_add_u32 s10, s57, 9216
    buffer_load_dwordx4 v8, s[32:35], s10 offen sc1 lds
    v_mfma_f32_32x32x16_bf16 v[240:255], a[184:187], v[48:51], 0
    v_add_f32 v30, v30, v44
    v_add_f32 v31, v31, v45
    v_xor_b32 v7, 48, v5
    s_add_u32 m0, s8, 10240
    s_add_u32 s10, s57, 9216
    buffer_load_dwordx4 v7, s[32:35], s10 offen sc1 lds
    v_mfma_f32_32x32x16_bf16 v[64:79], a[100:103], v[52:55], v[64:79]
    v_add_f32 v30, v30, v46
    v_add_f32 v31, v31, v47
    v_xor_b32 v8, 48, v6
    s_add_u32 m0, s8, 11264
    s_add_u32 s10, s57, 9216
    buffer_load_dwordx4 v8, s[32:35], s10 offen sc1 lds
    v_mfma_f32_32x32x16_bf16 v[80:95], a[108:111], v[52:55], v[80:95]
    v_add_f32 v29, v29, v30
    v_add_f32 v29, v29, v31
    v_mfma_f32_32x32x16_bf16 v[96:111], a[116:119], v[52:55], v[96:111]
    v_mfma_f32_32x32x16_bf16 v[112:127], a[124:127], v[52:55], v[112:127]
    v_mfma_f32_32x32x16_bf16 v[128:143], a[132:135], v[52:55], v[128:143]
    v_mfma_f32_32x32x16_bf16 v[144:159], a[140:143], v[52:55], v[144:159]
    s_waitcnt vmcnt(0)
    ds_read_b128 a[192:195], v9 offset:0
    ds_read_b128 a[196:199], v10 offset:0
    ds_read_b128 a[200:203], v11 offset:0
    ds_read_b128 a[204:207], v12 offset:0
    ds_read_b128 a[208:211], v13 offset:0
    v_mfma_f32_32x32x16_bf16 v[160:175], a[148:151], v[52:55], v[160:175]
    v_mfma_f32_32x32x16_bf16 v[176:191], a[156:159], v[52:55], v[176:191]
    v_mfma_f32_32x32x16_bf16 v[192:207], a[164:167], v[52:55], v[192:207]
    v_mfma_f32_32x32x16_bf16 v[208:223], a[172:175], v[52:55], v[208:223]
    v_mfma_f32_32x32x16_bf16 v[224:239], a[180:183], v[52:55], v[224:239]
    v_mfma_f32_32x32x16_bf16 v[240:255], a[188:191], v[52:55], v[240:255]
    ds_read_b128 a[212:215], v14 offset:0
    s_waitcnt lgkmcnt(5)
    v_mfma_f32_32x32x16_bf16 v[32:47], a[192:195], a[0:3], 0
    ds_read_b128 a[216:219], v15 offset:0
    s_waitcnt lgkmcnt(5)
    v_mfma_f32_32x32x16_bf16 v[32:47], a[196:199], a[4:7], v[32:47]
    s_add_u32 s56, s15, 2
    s_cmp_ge_u32 s56, 6
    s_cselect_b32 s12, 6, 0
    s_sub_u32 s56, s56, s12
    s_mul_i32 s56, s56, 98304
    s_add_u32 s56, s56, s14
    s_add_u32 m0, s8, 12288
    s_add_u32 s10, s56, 0
    buffer_load_dwordx4 v4, s[32:35], s10 offen sc1 lds
    ds_read_b128 a[220:223], v16 offset:0
    ds_read_b64_tr_b16 a[96:97], v20 offset:24576
    ds_read_b64_tr_b16 a[98:99], v24 offset:24576
    s_waitcnt lgkmcnt(7)
    v_mfma_f32_32x32x16_bf16 v[32:47], a[200:203], a[8:11], v[32:47]
    ds_read_b128 a[192:195], v9 offset:256
    ds_read_b64_tr_b16 a[104:105], v21 offset:24576
    ds_read_b64_tr_b16 a[106:107], v25 offset:24576
    s_waitcnt lgkmcnt(9)
    v_mfma_f32_32x32x16_bf16 v[32:47], a[204:207], a[12:15], v[32:47]
    s_add_u32 m0, s8, 13312
    s_add_u32 s10, s56, 0
    buffer_load_dwordx4 v5, s[32:35], s10 offen sc1 lds
    ds_read_b128 a[196:199], v10 offset:256
    ds_read_b64_tr_b16 a[112:113], v22 offset:24576
    ds_read_b64_tr_b16 a[114:115], v26 offset:24576
    s_waitcnt lgkmcnt(11)
    v_mfma_f32_32x32x16_bf16 v[32:47], a[208:211], a[16:19], v[32:47]
    ds_read_b128 a[200:203], v11 offset:256
    ds_read_b64_tr_b16 a[120:121], v23 offset:24576
    ds_read_b64_tr_b16 a[122:123], v27 offset:24576
    s_waitcnt lgkmcnt(13)
    v_mfma_f32_32x32x16_bf16 v[32:47], a[212:215], a[20:23], v[32:47]
    s_add_u32 m0, s8, 14336
    s_add_u32 s10, s56, 0
    buffer_load_dwordx4 v6, s[32:35], s10 offen sc1 lds
    ds_read_b128 a[204:207], v12 offset:256
    ds_read_b64_tr_b16 a[128:129], v20 offset:24832
    ds_read_b64_tr_b16 a[130:131], v24 offset:24832
    s_waitcnt lgkmcnt(15)
    v_mfma_f32_32x32x16_bf16 v[32:47], a[216:219], a[24:27], v[32:47]
    ds_read_b128 a[208:211], v13 offset:256
    ds_read_b64_tr_b16 a[136:137], v21 offset:24832
    ds_read_b64_tr_b16 a[138:139], v25 offset:24832
    s_waitcnt lgkmcnt(15)
    v_mfma_f32_32x32x16_bf16 v[32:47], a[220:223], a[28:31], v[32:47]
    v_xor_b32 v7, 16, v4
    s_add_u32 m0, s8, 15360
    s_add_u32 s10, s56, 3072
    buffer_load_dwordx4 v7, s[32:35], s10 offen sc1 lds
    ds_read_b128 a[212:215], v14 offset:256
    ds_read_b64_tr_b16 a[144:145], v22 offset:24832
    ds_read_b64_tr_b16 a[146:147], v26 offset:24832
    s_waitcnt lgkmcnt(15)
    v_mfma_f32_32x32x16_bf16 v[32:47], a[192:195], a[32:35], v[32:47]
    ds_read_b128 a[216:219], v15 offset:256
    ds_read_b64_tr_b16 a[152:153], v23 offset:24832
    ds_read_b64_tr_b16 a[154:155], v27 offset:24832
    s_waitcnt lgkmcnt(15)
    v_mfma_f32_32x32x16_bf16 v[32:47], a[196:199], a[36:39], v[32:47]
    v_xor_b32 v8, 16, v5
    s_add_u32 m0, s8, 16384
    s_add_u32 s10, s56, 3072
    buffer_load_dwordx4 v8, s[32:35], s10 offen sc1 lds
    ds_read_b128 a[220:223], v16 offset:256
    ds_read_b64_tr_b16 a[160:161], v20 offset:25088
    ds_read_b64_tr_b16 a[162:163], v24 offset:25088
    s_waitcnt lgkmcnt(15)
    v_mfma_f32_32x32x16_bf16 v[32:47], a[200:203], a[40:43], v[32:47]
    ds_read_b128 a[192:195], v9 offset:512
    ds_read_b64_tr_b16 a[168:169], v21 offset:25088
    ds_read_b64_tr_b16 a[170:171], v25 offset:25088
    s_waitcnt lgkmcnt(15)
    v_mfma_f32_32x32x16_bf16 v[32:47], a[204:207], a[44:47], v[32:47]
    v_xor_b32 v7, 16, v6
    s_add_u32 m0, s8, 17408
    s_add_u32 s10, s56, 3072
    buffer_load_dwordx4 v7, s[32:35], s10 offen sc1 lds
    ds_read_b128 a[196:199], v10 offset:512
    ds_read_b64_tr_b16 a[176:177], v22 offset:25088
    ds_read_b64_tr_b16 a[178:179], v26 offset:25088
    s_waitcnt lgkmcnt(15)
    v_mfma_f32_32x32x16_bf16 v[32:47], a[208:211], a[48:51], v[32:47]
    ds_read_b128 a[200:203], v11 offset:512
    ds_read_b64_tr_b16 a[184:185], v23 offset:25088
    ds_read_b64_tr_b16 a[186:187], v27 offset:25088
    s_waitcnt lgkmcnt(15)
    v_mfma_f32_32x32x16_bf16 v[32:47], a[212:215], a[52:55], v[32:47]
    v_xor_b32 v8, 32, v4
    s_add_u32 m0, s8, 18432
    s_add_u32 s10, s56, 6144
    buffer_load_dwordx4 v8, s[32:35], s10 offen sc1 lds
    ds_read_b128 a[204:207], v12 offset:512
    ds_read_b64_tr_b16 a[100:101], v20 offset:0
    ds_read_b64_tr_b16 a[102:103], v24 offset:0
    s_waitcnt lgkmcnt(15)
    v_mfma_f32_32x32x16_bf16 v[32:47], a[216:219], a[56:59], v[32:47]
    ds_read_b128 a[208:211], v13 offset:512
    ds_read_b64_tr_b16 a[108:109], v21 offset:0
    ds_read_b64_tr_b16 a[110:111], v25 offset:0
    s_waitcnt lgkmcnt(15)
    v_mfma_f32_32x32x16_bf16 v[32:47], a[220:223], a[60:63], v[32:47]
    v_xor_b32 v7, 32, v5
    s_add_u32 m0, s8, 19456
    s_add_u32 s10, s56, 6144
    buffer_load_dwordx4 v7, s[32:35], s10 offen sc1 lds
    ds_read_b128 a[212:215], v14 offset:512
    ds_read_b64_tr_b16 a[116:117], v22 offset:0
    ds_read_b64_tr_b16 a[118:119], v26 offset:0
    s_waitcnt lgkmcnt(15)
    v_mfma_f32_32x32x16_bf16 v[32:47], a[192:195], a[64:67], v[32:47]
    ds_read_b128 a[216:219], v15 offset:512
    ds_read_b64_tr_b16 a[124:125], v23 offset:0
    ds_read_b64_tr_b16 a[126:127], v27 offset:0
    s_waitcnt lgkmcnt(15)
    v_mfma_f32_32x32x16_bf16 v[32:47], a[196:199], a[68:71], v[32:47]
    v_xor_b32 v8, 32, v6
    s_add_u32 m0, s8, 20480
    s_add_u32 s10, s56, 6144
    buffer_load_dwordx4 v8, s[32:35], s10 offen sc1 lds
    ds_read_b128 a[220:223], v16 offset:512
    ds_read_b64_tr_b16 a[132:133], v20 offset:256
    ds_read_b64_tr_b16 a[134:135], v24 offset:256
    s_waitcnt lgkmcnt(15)
    v_mfma_f32_32x32x16_bf16 v[32:47], a[200:203], a[72:75], v[32:47]
    ds_read_b64_tr_b16 a[140:141], v21 offset:256
    ds_read_b64_tr_b16 a[142:143], v25 offset:256
    s_waitcnt lgkmcnt(15)
    v_mfma_f32_32x32x16_bf16 v[32:47], a[204:207], a[76:79], v[32:47]
    v_xor_b32 v7, 48, v4
    s_add_u32 m0, s8, 21504
    s_add_u32 s10, s56, 9216
    buffer_load_dwordx4 v7, s[32:35], s10 offen sc1 lds
    ds_read_b64_tr_b16 a[148:149], v22 offset:256
    ds_read_b64_tr_b16 a[150:151], v26 offset:256
    s_waitcnt lgkmcnt(15)
    v_mfma_f32_32x32x16_bf16 v[32:47], a[208:211], a[80:83], v[32:47]
    ds_read_b64_tr_b16 a[156:157], v23 offset:256
    ds_read_b64_tr_b16 a[158:159], v27 offset:256
    s_waitcnt lgkmcnt(14)
    v_mfma_f32_32x32x16_bf16 v[32:47], a[212:215], a[84:87], v[32:47]
    v_xor_b32 v8, 48, v5
    s_add_u32 m0, s8, 22528
    s_add_u32 s10, s56, 9216
    buffer_load_dwordx4 v8, s[32:35], s10 offen sc1 lds
    ds_read_b64_tr_b16 a[164:165], v20 offset:512
    ds_read_b64_tr_b16 a[166:167], v24 offset:512
    s_waitcnt lgkmcnt(13)
    v_mfma_f32_32x32x16_bf16 v[32:47], a[216:219], a[88:91], v[32:47]
    ds_read_b64_tr_b16 a[172:173], v21 offset:512
    ds_read_b64_tr_b16 a[174:175], v25 offset:512
    ds_read_b64_tr_b16 a[180:181], v22 offset:512
    ds_read_b64_tr_b16 a[182:183], v26 offset:512
    s_waitcnt lgkmcnt(14)
    v_mfma_f32_32x32x16_bf16 v[32:47], a[220:223], a[92:95], v[32:47]
    v_xor_b32 v7, 48, v6
    s_add_u32 m0, s8, 23552
    s_add_u32 s10, s56, 9216
    buffer_load_dwordx4 v7, s[32:35], s10 offen sc1 lds
    ds_read_b64_tr_b16 a[188:189], v23 offset:512
    ds_read_b64_tr_b16 a[190:191], v27 offset:512
    v_add_u32 v9, v9, v18
    v_add_u32 v10, v10, v18
    v_add_u32 v11, v11, v18
    v_add_u32 v12, v12, v18
    v_add_u32 v13, v13, v18
    v_add_u32 v14, v14, v18
    v_add_u32 v15, v15, v18
    v_add_u32 v16, v16, v18
    s_waitcnt lgkmcnt(0)
    s_add_u32 s57, s15, 2
    s_cmp_ge_u32 s57, 6
    s_cselect_b32 s12, 6, 0
    s_sub_u32 s57, s57, s12
    s_mul_i32 s57, s57, 98304
    s_add_u32 s57, s57, s14
    s_add_u32 s57, s57, 12288
    s_add_u32 m0, s8, 24576
    s_add_u32 s10, s57, 0
    buffer_load_dwordx4 v4, s[32:35], s10 offen sc1 lds
    s_add_u32 m0, s8, 25600
    s_add_u32 s10, s57, 0
    buffer_load_dwordx4 v5, s[32:35], s10 offen sc1 lds
    s_add_u32 s60, s15, 1
    s_cmp_eq_u32 s60, 5
    s_cselect_b32 s12, 1, 0
    s_cmp_eq_u32 s60, 11
    s_cselect_b32 s12, 1, s12
    s_cmp_lg_u32 s12, 0
    s_cbranch_scc1 L2_mask1
L2_nomask1:
    v_max3_f32 v30, v32, v33, v34
    v_max3_f32 v30, v30, v35, v36
    v_max3_f32 v30, v30, v37, v38
    v_max3_f32 v30, v30, v39, v40
    v_max3_f32 v30, v30, v41, v42
    v_max3_f32 v30, v30, v43, v44
    v_max3_f32 v30, v30, v45, v46
    v_max_f32 v30, v30, v47
    v_mov_b32 v31, v30
    s_nop 1
    v_permlane32_swap_b32 v30, v31
    s_nop 1
    v_max_f32 v30, v30, v31
    s_add_u32 m0, s8, 26624
    s_add_u32 s10, s57, 0
    buffer_load_dwordx4 v6, s[32:35], s10 offen sc1 lds
    v_add_f32 v31, 0x41000000, v28
    v_cmp_gt_f32 vcc, v30, v31
    s_cbranch_vccnz L2_rs1
L2_nors1:
    v_sub_f32 v32, v32, v28
    v_sub_f32 v33, v33, v28
    v_sub_f32 v34, v34, v28
    v_sub_f32 v35, v35, v28
    v_sub_f32 v36, v36, v28
    v_sub_f32 v37, v37, v28
    v_sub_f32 v38, v38, v28
    v_sub_f32 v39, v39, v28
    v_exp_f32 v32, v32
    v_exp_f32 v33, v33
    v_exp_f32 v34, v34
    v_exp_f32 v35, v35
    v_exp_f32 v36, v36
    v_exp_f32 v37, v37
    v_exp_f32 v38, v38
    v_exp_f32 v39, v39
    v_xor_b32 v8, 16, v4
    s_add_u32 m0, s8, 27648
    s_add_u32 s10, s57, 3072
    buffer_load_dwordx4 v8, s[32:35], s10 offen sc1 lds
    v_cvt_pk_bf16_f32 v48, v32, v33
    v_cvt_pk_bf16_f32 v49, v34, v35
    v_cvt_pk_bf16_f32 v50, v36, v37
    v_cvt_pk_bf16_f32 v51, v38, v39
    s_nop 1
    v_mfma_f32_32x32x16_bf16 v[64:79], a[96:99], v[48:51], v[64:79]
    v_sub_f32 v40, v40, v28
    v_sub_f32 v41, v41, v28
    v_sub_f32 v42, v42, v28
    v_mfma_f32_32x32x16_bf16 v[80:95], a[104:107], v[48:51], v[80:95]
    v_sub_f32 v43, v43, v28
    v_sub_f32 v44, v44, v28
    v_sub_f32 v45, v45, v28
    v_xor_b32 v7, 16, v5
    s_add_u32 m0, s8, 28672
    s_add_u32 s10, s57, 3072
    buffer_load_dwordx4 v7, s[32:35], s10 offen sc1 lds
    v_mfma_f32_32x32x16_bf16 v[96:111], a[112:115], v[48:51], v[96:111]
    v_sub_f32 v46, v46, v28
    v_sub_f32 v47, v47, v28
    v_exp_f32 v40, v40
    v_mfma_f32_32x32x16_bf16 v[112:127], a[120:123], v[48:51], v[112:127]
    v_exp_f32 v41, v41
    v_exp_f32 v42, v42
    v_exp_f32 v43, v43
    v_xor_b32 v8, 16, v6
    s_add_u32 m0, s8, 29696
    s_add_u32 s10, s57, 3072
    buffer_load_dwordx4 v8, s[32:35], s10 offen sc1 lds
    v_mfma_f32_32x32x16_bf16 v[128:143], a[128:131], v[48:51], v[128:143]
    v_exp_f32 v44, v44
    v_exp_f32 v45, v45
    v_exp_f32 v46, v46
    v_mfma_f32_32x32x16_bf16 v[144:159], a[136:139], v[48:51], v[144:159]
    v_exp_f32 v47, v47
    v_add_f32 v30, v32, v33
    v_cvt_pk_bf16_f32 v52, v40, v41
    v_xor_b32 v7, 32, v4
    s_add_u32 m0, s8, 30720
    s_add_u32 s10, s57, 6144
    buffer_load_dwordx4 v7, s[32:35], s10 offen sc1 lds
    v_mfma_f32_32x32x16_bf16 v[160:175], a[144:147], v[48:51], v[160:175]
    v_cvt_pk_bf16_f32 v53, v42, v43
    v_cvt_pk_bf16_f32 v54, v44, v45
    v_cvt_pk_bf16_f32 v55, v46, v47
    v_mfma_f32_32x32x16_bf16 v[176:191], a[152:155], v[48:51], v[176:191]
    v_add_f32 v31, v34, v35
    v_add_f32 v30, v30, v36
    v_add_f32 v31, v31, v37
    v_xor_b32 v8, 32, v5
    s_add_u32 m0, s8, 31744
    s_add_u32 s10, s57, 6144
    buffer_load_dwordx4 v8, s[32:35], s10 offen sc1 lds
    v_mfma_f32_32x32x16_bf16 v[192:207], a[160:163], v[48:51], v[192:207]
    v_add_f32 v30, v30, v38
    v_add_f32 v31, v31, v39
    v_mfma_f32_32x32x16_bf16 v[208:223], a[168:171], v[48:51], v[208:223]
    v_add_f32 v30, v30, v40
    v_add_f32 v31, v31, v41
    v_xor_b32 v7, 32, v6
    s_add_u32 m0, s8, 32768
    s_add_u32 s10, s57, 6144
    buffer_load_dwordx4 v7, s[32:35], s10 offen sc1 lds
    v_mfma_f32_32x32x16_bf16 v[224:239], a[176:179], v[48:51], v[224:239]
    v_add_f32 v30, v30, v42
    v_add_f32 v31, v31, v43
    v_xor_b32 v8, 48, v4
    s_add_u32 m0, s8, 33792
    s_add_u32 s10, s57, 9216
    buffer_load_dwordx4 v8, s[32:35], s10 offen sc1 lds
    v_mfma_f32_32x32x16_bf16 v[240:255], a[184:187], v[48:51], v[240:255]
    v_add_f32 v30, v30, v44
    v_add_f32 v31, v31, v45
    v_xor_b32 v7, 48, v5
    s_add_u32 m0, s8, 34816
    s_add_u32 s10, s57, 9216
    buffer_load_dwordx4 v7, s[32:35], s10 offen sc1 lds
    v_mfma_f32_32x32x16_bf16 v[64:79], a[100:103], v[52:55], v[64:79]
    v_add_f32 v30, v30, v46
    v_add_f32 v31, v31, v47
    v_xor_b32 v8, 48, v6
    s_add_u32 m0, s8, 35840
    s_add_u32 s10, s57, 9216
    buffer_load_dwordx4 v8, s[32:35], s10 offen sc1 lds
    v_mfma_f32_32x32x16_bf16 v[80:95], a[108:111], v[52:55], v[80:95]
    v_add_f32 v29, v29, v30
    v_add_f32 v29, v29, v31
    v_mfma_f32_32x32x16_bf16 v[96:111], a[116:119], v[52:55], v[96:111]
    v_mfma_f32_32x32x16_bf16 v[112:127], a[124:127], v[52:55], v[112:127]
    v_mfma_f32_32x32x16_bf16 v[128:143], a[132:135], v[52:55], v[128:143]
    v_mfma_f32_32x32x16_bf16 v[144:159], a[140:143], v[52:55], v[144:159]
    s_waitcnt vmcnt(0)
    ds_read_b128 a[192:195], v9 offset:0
    ds_read_b128 a[196:199], v10 offset:0
    ds_read_b128 a[200:203], v11 offset:0
    ds_read_b128 a[204:207], v12 offset:0
    ds_read_b128 a[208:211], v13 offset:0
    v_mfma_f32_32x32x16_bf16 v[160:175], a[148:151], v[52:55], v[160:175]
    v_mfma_f32_32x32x16_bf16 v[176:191], a[156:159], v[52:55], v[176:191]
    v_mfma_f32_32x32x16_bf16 v[192:207], a[164:167], v[52:55], v[192:207]
    v_mfma_f32_32x32x16_bf16 v[208:223], a[172:175], v[52:55], v[208:223]
    v_mfma_f32_32x32x16_bf16 v[224:239], a[180:183], v[52:55], v[224:239]
    v_mfma_f32_32x32x16_bf16 v[240:255], a[188:191], v[52:55], v[240:255]
    ds_read_b128 a[212:215], v14 offset:0
    s_waitcnt lgkmcnt(5)
    v_mfma_f32_32x32x16_bf16 v[32:47], a[192:195], a[0:3], 0
    ds_read_b128 a[216:219], v15 offset:0
    s_waitcnt lgkmcnt(5)
    v_mfma_f32_32x32x16_bf16 v[32:47], a[196:199], a[4:7], v[32:47]
    s_add_u32 s56, s15, 3
    s_cmp_ge_u32 s56, 6
    s_cselect_b32 s12, 6, 0
    s_sub_u32 s56, s56, s12
    s_mul_i32 s56, s56, 98304
    s_add_u32 s56, s56, s14
    s_add_u32 m0, s8, 0
    s_add_u32 s10, s56, 0
    buffer_load_dwordx4 v4, s[32:35], s10 offen sc1 lds
    ds_read_b128 a[220:223], v16 offset:0
    ds_read_b64_tr_b16 a[96:97], v20 offset:12288
    ds_read_b64_tr_b16 a[98:99], v24 offset:12288
    s_waitcnt lgkmcnt(7)
    v_mfma_f32_32x32x16_bf16 v[32:47], a[200:203], a[8:11], v[32:47]
    ds_read_b128 a[192:195], v9 offset:256
    ds_read_b64_tr_b16 a[104:105], v21 offset:12288
    ds_read_b64_tr_b16 a[106:107], v25 offset:12288
    s_waitcnt lgkmcnt(9)
    v_mfma_f32_32x32x16_bf16 v[32:47], a[204:207], a[12:15], v[32:47]
    s_add_u32 m0, s8, 1024
    s_add_u32 s10, s56, 0
    buffer_load_dwordx4 v5, s[32:35], s10 offen sc1 lds
    ds_read_b128 a[196:199], v10 offset:256
    ds_read_b64_tr_b16 a[112:113], v22 offset:12288
    ds_read_b64_tr_b16 a[114:115], v26 offset:12288
    s_waitcnt lgkmcnt(11)
    v_mfma_f32_32x32x16_bf16 v[32:47], a[208:211], a[16:19], v[32:47]
    ds_read_b128 a[200:203], v11 offset:256
    ds_read_b64_tr_b16 a[120:121], v23 offset:12288
    ds_read_b64_tr_b16 a[122:123], v27 offset:12288
    s_waitcnt lgkmcnt(13)
    v_mfma_f32_32x32x16_bf16 v[32:47], a[212:215], a[20:23], v[32:47]
    s_add_u32 m0, s8, 2048
    s_add_u32 s10, s56, 0
    buffer_load_dwordx4 v6, s[32:35], s10 offen sc1 lds
    ds_read_b128 a[204:207], v12 offset:256
    ds_read_b64_tr_b16 a[128:129], v20 offset:12544
    ds_read_b64_tr_b16 a[130:131], v24 offset:12544
    s_waitcnt lgkmcnt(15)
    v_mfma_f32_32x32x16_bf16 v[32:47], a[216:219], a[24:27], v[32:47]
    ds_read_b128 a[208:211], v13 offset:256
    ds_read_b64_tr_b16 a[136:137], v21 offset:12544
    ds_read_b64_tr_b16 a[138:139], v25 offset:12544
    s_waitcnt lgkmcnt(15)
    v_mfma_f32_32x32x16_bf16 v[32:47], a[220:223], a[28:31], v[32:47]
    v_xor_b32 v7, 16, v4
    s_add_u32 m0, s8, 3072
    s_add_u32 s10, s56, 3072
    buffer_load_dwordx4 v7, s[32:35], s10 offen sc1 lds
    ds_read_b128 a[212:215], v14 offset:256
    ds_read_b64_tr_b16 a[144:145], v22 offset:12544
    ds_read_b64_tr_b16 a[146:147], v26 offset:12544
    s_waitcnt lgkmcnt(15)
    v_mfma_f32_32x32x16_bf16 v[32:47], a[192:195], a[32:35], v[32:47]
    ds_read_b128 a[216:219], v15 offset:256
    ds_read_b64_tr_b16 a[152:153], v23 offset:12544
    ds_read_b64_tr_b16 a[154:155], v27 offset:12544
    s_waitcnt lgkmcnt(15)
    v_mfma_f32_32x32x16_bf16 v[32:47], a[196:199], a[36:39], v[32:47]
    v_xor_b32 v8, 16, v5
    s_add_u32 m0, s8, 4096
    s_add_u32 s10, s56, 3072
    buffer_load_dwordx4 v8, s[32:35], s10 offen sc1 lds
    ds_read_b128 a[220:223], v16 offset:256
    ds_read_b64_tr_b16 a[160:161], v20 offset:12800
    ds_read_b64_tr_b16 a[162:163], v24 offset:12800
    s_waitcnt lgkmcnt(15)
    v_mfma_f32_32x32x16_bf16 v[32:47], a[200:203], a[40:43], v[32:47]
    ds_read_b128 a[192:195], v9 offset:512
    ds_read_b64_tr_b16 a[168:169], v21 offset:12800
    ds_read_b64_tr_b16 a[170:171], v25 offset:12800
    s_waitcnt lgkmcnt(15)
    v_mfma_f32_32x32x16_bf16 v[32:47], a[204:207], a[44:47], v[32:47]
    v_xor_b32 v7, 16, v6
    s_add_u32 m0, s8, 5120
    s_add_u32 s10, s56, 3072
    buffer_load_dwordx4 v7, s[32:35], s10 offen sc1 lds
    ds_read_b128 a[196:199], v10 offset:512
    ds_read_b64_tr_b16 a[176:177], v22 offset:12800
    ds_read_b64_tr_b16 a[178:179], v26 offset:12800
    s_waitcnt lgkmcnt(15)
    v_mfma_f32_32x32x16_bf16 v[32:47], a[208:211], a[48:51], v[32:47]
    ds_read_b128 a[200:203], v11 offset:512
    ds_read_b64_tr_b16 a[184:185], v23 offset:12800
    ds_read_b64_tr_b16 a[186:187], v27 offset:12800
    s_waitcnt lgkmcnt(15)
    v_mfma_f32_32x32x16_bf16 v[32:47], a[212:215], a[52:55], v[32:47]
    v_xor_b32 v8, 32, v4
    s_add_u32 m0, s8, 6144
    s_add_u32 s10, s56, 6144
    buffer_load_dwordx4 v8, s[32:35], s10 offen sc1 lds
    ds_read_b128 a[204:207], v12 offset:512
    ds_read_b64_tr_b16 a[100:101], v20 offset:24576
    ds_read_b64_tr_b16 a[102:103], v24 offset:24576
    s_waitcnt lgkmcnt(15)
    v_mfma_f32_32x32x16_bf16 v[32:47], a[216:219], a[56:59], v[32:47]
    ds_read_b128 a[208:211], v13 offset:512
    ds_read_b64_tr_b16 a[108:109], v21 offset:24576
    ds_read_b64_tr_b16 a[110:111], v25 offset:24576
    s_waitcnt lgkmcnt(15)
    v_mfma_f32_32x32x16_bf16 v[32:47], a[220:223], a[60:63], v[32:47]
    v_xor_b32 v7, 32, v5
    s_add_u32 m0, s8, 7168
    s_add_u32 s10, s56, 6144
    buffer_load_dwordx4 v7, s[32:35], s10 offen sc1 lds
    ds_read_b128 a[212:215], v14 offset:512
    ds_read_b64_tr_b16 a[116:117], v22 offset:24576
    ds_read_b64_tr_b16 a[118:119], v26 offset:24576
    s_waitcnt lgkmcnt(15)
    v_mfma_f32_32x32x16_bf16 v[32:47], a[192:195], a[64:67], v[32:47]
    ds_read_b128 a[216:219], v15 offset:512
    ds_read_b64_tr_b16 a[124:125], v23 offset:24576
    ds_read_b64_tr_b16 a[126:127], v27 offset:24576
    s_waitcnt lgkmcnt(15)
    v_mfma_f32_32x32x16_bf16 v[32:47], a[196:199], a[68:71], v[32:47]
    v_xor_b32 v8, 32, v6
    s_add_u32 m0, s8, 8192
    s_add_u32 s10, s56, 6144
    buffer_load_dwordx4 v8, s[32:35], s10 offen sc1 lds
    ds_read_b128 a[220:223], v16 offset:512
    ds_read_b64_tr_b16 a[132:133], v20 offset:24832
    ds_read_b64_tr_b16 a[134:135], v24 offset:24832
    s_waitcnt lgkmcnt(15)
    v_mfma_f32_32x32x16_bf16 v[32:47], a[200:203], a[72:75], v[32:47]
    ds_read_b64_tr_b16 a[140:141], v21 offset:24832
    ds_read_b64_tr_b16 a[142:143], v25 offset:24832
    s_waitcnt lgkmcnt(15)
    v_mfma_f32_32x32x16_bf16 v[32:47], a[204:207], a[76:79], v[32:47]
    v_xor_b32 v7, 48, v4
    s_add_u32 m0, s8, 9216
    s_add_u32 s10, s56, 9216
    buffer_load_dwordx4 v7, s[32:35], s10 offen sc1 lds
    ds_read_b64_tr_b16 a[148:149], v22 offset:24832
    ds_read_b64_tr_b16 a[150:151], v26 offset:24832
    s_waitcnt lgkmcnt(15)
    v_mfma_f32_32x32x16_bf16 v[32:47], a[208:211], a[80:83], v[32:47]
    ds_read_b64_tr_b16 a[156:157], v23 offset:24832
    ds_read_b64_tr_b16 a[158:159], v27 offset:24832
    s_waitcnt lgkmcnt(14)
    v_mfma_f32_32x32x16_bf16 v[32:47], a[212:215], a[84:87], v[32:47]
    v_xor_b32 v8, 48, v5
    s_add_u32 m0, s8, 10240
    s_add_u32 s10, s56, 9216
    buffer_load_dwordx4 v8, s[32:35], s10 offen sc1 lds
    ds_read_b64_tr_b16 a[164:165], v20 offset:25088
    ds_read_b64_tr_b16 a[166:167], v24 offset:25088
    s_waitcnt lgkmcnt(13)
    v_mfma_f32_32x32x16_bf16 v[32:47], a[216:219], a[88:91], v[32:47]
    ds_read_b64_tr_b16 a[172:173], v21 offset:25088
    ds_read_b64_tr_b16 a[174:175], v25 offset:25088
    ds_read_b64_tr_b16 a[180:181], v22 offset:25088
    ds_read_b64_tr_b16 a[182:183], v26 offset:25088
    s_waitcnt lgkmcnt(14)
    v_mfma_f32_32x32x16_bf16 v[32:47], a[220:223], a[92:95], v[32:47]
    v_xor_b32 v7, 48, v6
    s_add_u32 m0, s8, 11264
    s_add_u32 s10, s56, 9216
    buffer_load_dwordx4 v7, s[32:35], s10 offen sc1 lds
    ds_read_b64_tr_b16 a[188:189], v23 offset:25088
    ds_read_b64_tr_b16 a[190:191], v27 offset:25088
    v_add_u32 v9, v9, v19
    v_add_u32 v10, v10, v19
    v_add_u32 v11, v11, v19
    v_add_u32 v12, v12, v19
    v_add_u32 v13, v13, v19
    v_add_u32 v14, v14, v19
    v_add_u32 v15, v15, v19
    v_add_u32 v16, v16, v19
    s_waitcnt lgkmcnt(0)
    s_add_u32 s57, s15, 3
    s_cmp_ge_u32 s57, 6
    s_cselect_b32 s12, 6, 0
    s_sub_u32 s57, s57, s12
    s_mul_i32 s57, s57, 98304
    s_add_u32 s57, s57, s14
    s_add_u32 s57, s57, 12288
    s_add_u32 m0, s8, 12288
    s_add_u32 s10, s57, 0
    buffer_load_dwordx4 v4, s[32:35], s10 offen sc1 lds
    s_add_u32 m0, s8, 13312
    s_add_u32 s10, s57, 0
    buffer_load_dwordx4 v5, s[32:35], s10 offen sc1 lds
    s_add_u32 s60, s15, 2
    s_cmp_eq_u32 s60, 5
    s_cselect_b32 s12, 1, 0
    s_cmp_eq_u32 s60, 11
    s_cselect_b32 s12, 1, s12
    s_cmp_lg_u32 s12, 0
    s_cbranch_scc1 L2_mask2
L2_nomask2:
    v_max3_f32 v30, v32, v33, v34
    v_max3_f32 v30, v30, v35, v36
    v_max3_f32 v30, v30, v37, v38
    v_max3_f32 v30, v30, v39, v40
    v_max3_f32 v30, v30, v41, v42
    v_max3_f32 v30, v30, v43, v44
    v_max3_f32 v30, v30, v45, v46
    v_max_f32 v30, v30, v47
    v_mov_b32 v31, v30
    s_nop 1
    v_permlane32_swap_b32 v30, v31
    s_nop 1
    v_max_f32 v30, v30, v31
    s_add_u32 m0, s8, 14336
    s_add_u32 s10, s57, 0
    buffer_load_dwordx4 v6, s[32:35], s10 offen sc1 lds
    v_add_f32 v31, 0x41000000, v28
    v_cmp_gt_f32 vcc, v30, v31
    s_cbranch_vccnz L2_rs2
L2_nors2:
    v_sub_f32 v32, v32, v28
    v_sub_f32 v33, v33, v28
    v_sub_f32 v34, v34, v28
    v_sub_f32 v35, v35, v28
    v_sub_f32 v36, v36, v28
    v_sub_f32 v37, v37, v28
    v_sub_f32 v38, v38, v28
    v_sub_f32 v39, v39, v28
    v_exp_f32 v32, v32
    v_exp_f32 v33, v33
    v_exp_f32 v34, v34
    v_exp_f32 v35, v35
    v_exp_f32 v36, v36
    v_exp_f32 v37, v37
    v_exp_f32 v38, v38
    v_exp_f32 v39, v39
    v_xor_b32 v8, 16, v4
    s_add_u32 m0, s8, 15360
    s_add_u32 s10, s57, 3072
    buffer_load_dwordx4 v8, s[32:35], s10 offen sc1 lds
    v_cvt_pk_bf16_f32 v48, v32, v33
    v_cvt_pk_bf16_f32 v49, v34, v35
    v_cvt_pk_bf16_f32 v50, v36, v37
    v_cvt_pk_bf16_f32 v51, v38, v39
    s_nop 1
    v_mfma_f32_32x32x16_bf16 v[64:79], a[96:99], v[48:51], v[64:79]
    v_sub_f32 v40, v40, v28
    v_sub_f32 v41, v41, v28
    v_sub_f32 v42, v42, v28
    v_mfma_f32_32x32x16_bf16 v[80:95], a[104:107], v[48:51], v[80:95]
    v_sub_f32 v43, v43, v28
    v_sub_f32 v44, v44, v28
    v_sub_f32 v45, v45, v28
    v_xor_b32 v7, 16, v5
    s_add_u32 m0, s8, 16384
    s_add_u32 s10, s57, 3072
    buffer_load_dwordx4 v7, s[32:35], s10 offen sc1 lds
    v_mfma_f32_32x32x16_bf16 v[96:111], a[112:115], v[48:51], v[96:111]
    v_sub_f32 v46, v46, v28
    v_sub_f32 v47, v47, v28
    v_exp_f32 v40, v40
    v_mfma_f32_32x32x16_bf16 v[112:127], a[120:123], v[48:51], v[112:127]
    v_exp_f32 v41, v41
    v_exp_f32 v42, v42
    v_exp_f32 v43, v43
    v_xor_b32 v8, 16, v6
    s_add_u32 m0, s8, 17408
    s_add_u32 s10, s57, 3072
    buffer_load_dwordx4 v8, s[32:35], s10 offen sc1 lds
    v_mfma_f32_32x32x16_bf16 v[128:143], a[128:131], v[48:51], v[128:143]
    v_exp_f32 v44, v44
    v_exp_f32 v45, v45
    v_exp_f32 v46, v46
    v_mfma_f32_32x32x16_bf16 v[144:159], a[136:139], v[48:51], v[144:159]
    v_exp_f32 v47, v47
    v_add_f32 v30, v32, v33
    v_cvt_pk_bf16_f32 v52, v40, v41
    v_xor_b32 v7, 32, v4
    s_add_u32 m0, s8, 18432
    s_add_u32 s10, s57, 6144
    buffer_load_dwordx4 v7, s[32:35], s10 offen sc1 lds
    v_mfma_f32_32x32x16_bf16 v[160:175], a[144:147], v[48:51], v[160:175]
    v_cvt_pk_bf16_f32 v53, v42, v43
    v_cvt_pk_bf16_f32 v54, v44, v45
    v_cvt_pk_bf16_f32 v55, v46, v47
    v_mfma_f32_32x32x16_bf16 v[176:191], a[152:155], v[48:51], v[176:191]
    v_add_f32 v31, v34, v35
    v_add_f32 v30, v30, v36
    v_add_f32 v31, v31, v37
    v_xor_b32 v8, 32, v5
    s_add_u32 m0, s8, 19456
    s_add_u32 s10, s57, 6144
    buffer_load_dwordx4 v8, s[32:35], s10 offen sc1 lds
    v_mfma_f32_32x32x16_bf16 v[192:207], a[160:163], v[48:51], v[192:207]
    v_add_f32 v30, v30, v38
    v_add_f32 v31, v31, v39
    v_mfma_f32_32x32x16_bf16 v[208:223], a[168:171], v[48:51], v[208:223]
    v_add_f32 v30, v30, v40
    v_add_f32 v31, v31, v41
    v_xor_b32 v7, 32, v6
    s_add_u32 m0, s8, 20480
    s_add_u32 s10, s57, 6144
    buffer_load_dwordx4 v7, s[32:35], s10 offen sc1 lds
    v_mfma_f32_32x32x16_bf16 v[224:239], a[176:179], v[48:51], v[224:239]
    v_add_f32 v30, v30, v42
    v_add_f32 v31, v31, v43
    v_xor_b32 v8, 48, v4
    s_add_u32 m0, s8, 21504
    s_add_u32 s10, s57, 9216
    buffer_load_dwordx4 v8, s[32:35], s10 offen sc1 lds
    v_mfma_f32_32x32x16_bf16 v[240:255], a[184:187], v[48:51], v[240:255]
    v_add_f32 v30, v30, v44
    v_add_f32 v31, v31, v45
    v_xor_b32 v7, 48, v5
    s_add_u32 m0, s8, 22528
    s_add_u32 s10, s57, 9216
    buffer_load_dwordx4 v7, s[32:35], s10 offen sc1 lds
    v_mfma_f32_32x32x16_bf16 v[64:79], a[100:103], v[52:55], v[64:79]
    v_add_f32 v30, v30, v46
    v_add_f32 v31, v31, v47
    v_xor_b32 v8, 48, v6
    s_add_u32 m0, s8, 23552
    s_add_u32 s10, s57, 9216
    buffer_load_dwordx4 v8, s[32:35], s10 offen sc1 lds
    v_mfma_f32_32x32x16_bf16 v[80:95], a[108:111], v[52:55], v[80:95]
    v_add_f32 v29, v29, v30
    v_add_f32 v29, v29, v31
    v_mfma_f32_32x32x16_bf16 v[96:111], a[116:119], v[52:55], v[96:111]
    v_mfma_f32_32x32x16_bf16 v[112:127], a[124:127], v[52:55], v[112:127]
    v_mfma_f32_32x32x16_bf16 v[128:143], a[132:135], v[52:55], v[128:143]
    v_mfma_f32_32x32x16_bf16 v[144:159], a[140:143], v[52:55], v[144:159]
    s_waitcnt vmcnt(0)
    ds_read_b128 a[192:195], v9 offset:0
    ds_read_b128 a[196:199], v10 offset:0
    ds_read_b128 a[200:203], v11 offset:0
    ds_read_b128 a[204:207], v12 offset:0
    ds_read_b128 a[208:211], v13 offset:0
    v_mfma_f32_32x32x16_bf16 v[160:175], a[148:151], v[52:55], v[160:175]
    v_mfma_f32_32x32x16_bf16 v[176:191], a[156:159], v[52:55], v[176:191]
    v_mfma_f32_32x32x16_bf16 v[192:207], a[164:167], v[52:55], v[192:207]
    v_mfma_f32_32x32x16_bf16 v[208:223], a[172:175], v[52:55], v[208:223]
    v_mfma_f32_32x32x16_bf16 v[224:239], a[180:183], v[52:55], v[224:239]
    v_mfma_f32_32x32x16_bf16 v[240:255], a[188:191], v[52:55], v[240:255]
    ds_read_b128 a[212:215], v14 offset:0
    s_waitcnt lgkmcnt(5)
    v_mfma_f32_32x32x16_bf16 v[32:47], a[192:195], a[0:3], 0
    ds_read_b128 a[216:219], v15 offset:0
    s_waitcnt lgkmcnt(5)
    v_mfma_f32_32x32x16_bf16 v[32:47], a[196:199], a[4:7], v[32:47]
    s_add_u32 s56, s15, 4
    s_cmp_ge_u32 s56, 6
    s_cselect_b32 s12, 6, 0
    s_sub_u32 s56, s56, s12
    s_mul_i32 s56, s56, 98304
    s_add_u32 s56, s56, s14
    s_add_u32 m0, s8, 24576
    s_add_u32 s10, s56, 0
    buffer_load_dwordx4 v4, s[32:35], s10 offen sc1 lds
    ds_read_b128 a[220:223], v16 offset:0
    ds_read_b64_tr_b16 a[96:97], v20 offset:0
    ds_read_b64_tr_b16 a[98:99], v24 offset:0
    s_waitcnt lgkmcnt(7)
    v_mfma_f32_32x32x16_bf16 v[32:47], a[200:203], a[8:11], v[32:47]
    ds_read_b128 a[192:195], v9 offset:256
    ds_read_b64_tr_b16 a[104:105], v21 offset:0
    ds_read_b64_tr_b16 a[106:107], v25 offset:0
    s_waitcnt lgkmcnt(9)
    v_mfma_f32_32x32x16_bf16 v[32:47], a[204:207], a[12:15], v[32:47]
    s_add_u32 m0, s8, 25600
    s_add_u32 s10, s56, 0
    buffer_load_dwordx4 v5, s[32:35], s10 offen sc1 lds
    ds_read_b128 a[196:199], v10 offset:256
    ds_read_b64_tr_b16 a[112:113], v22 offset:0
    ds_read_b64_tr_b16 a[114:115], v26 offset:0
    s_waitcnt lgkmcnt(11)
    v_mfma_f32_32x32x16_bf16 v[32:47], a[208:211], a[16:19], v[32:47]
    ds_read_b128 a[200:203], v11 offset:256
    ds_read_b64_tr_b16 a[120:121], v23 offset:0
    ds_read_b64_tr_b16 a[122:123], v27 offset:0
    s_waitcnt lgkmcnt(13)
    v_mfma_f32_32x32x16_bf16 v[32:47], a[212:215], a[20:23], v[32:47]
    s_add_u32 m0, s8, 26624
    s_add_u32 s10, s56, 0
    buffer_load_dwordx4 v6, s[32:35], s10 offen sc1 lds
    ds_read_b128 a[204:207], v12 offset:256
    ds_read_b64_tr_b16 a[128:129], v20 offset:256
    ds_read_b64_tr_b16 a[130:131], v24 offset:256
    s_waitcnt lgkmcnt(15)
    v_mfma_f32_32x32x16_bf16 v[32:47], a[216:219], a[24:27], v[32:47]
    ds_read_b128 a[208:211], v13 offset:256
    ds_read_b64_tr_b16 a[136:137], v21 offset:256
    ds_read_b64_tr_b16 a[138:139], v25 offset:256
    s_waitcnt lgkmcnt(15)
    v_mfma_f32_32x32x16_bf16 v[32:47], a[220:223], a[28:31], v[32:47]
    v_xor_b32 v7, 16, v4
    s_add_u32 m0, s8, 27648
    s_add_u32 s10, s56, 3072
    buffer_load_dwordx4 v7, s[32:35], s10 offen sc1 lds
    ds_read_b128 a[212:215], v14 offset:256
    ds_read_b64_tr_b16 a[144:145], v22 offset:256
    ds_read_b64_tr_b16 a[146:147], v26 offset:256
    s_waitcnt lgkmcnt(15)
    v_mfma_f32_32x32x16_bf16 v[32:47], a[192:195], a[32:35], v[32:47]
    ds_read_b128 a[216:219], v15 offset:256
    ds_read_b64_tr_b16 a[152:153], v23 offset:256
    ds_read_b64_tr_b16 a[154:155], v27 offset:256
    s_waitcnt lgkmcnt(15)
    v_mfma_f32_32x32x16_bf16 v[32:47], a[196:199], a[36:39], v[32:47]
    v_xor_b32 v8, 16, v5
    s_add_u32 m0, s8, 28672
    s_add_u32 s10, s56, 3072
    buffer_load_dwordx4 v8, s[32:35], s10 offen sc1 lds
    ds_read_b128 a[220:223], v16 offset:256
    ds_read_b64_tr_b16 a[160:161], v20 offset:512
    ds_read_b64_tr_b16 a[162:163], v24 offset:512
    s_waitcnt lgkmcnt(15)
    v_mfma_f32_32x32x16_bf16 v[32:47], a[200:203], a[40:43], v[32:47]
    ds_read_b128 a[192:195], v9 offset:512
    ds_read_b64_tr_b16 a[168:169], v21 offset:512
    ds_read_b64_tr_b16 a[170:171], v25 offset:512
    s_waitcnt lgkmcnt(15)
    v_mfma_f32_32x32x16_bf16 v[32:47], a[204:207], a[44:47], v[32:47]
    v_xor_b32 v7, 16, v6
    s_add_u32 m0, s8, 29696
    s_add_u32 s10, s56, 3072
    buffer_load_dwordx4 v7, s[32:35], s10 offen sc1 lds
    ds_read_b128 a[196:199], v10 offset:512
    ds_read_b64_tr_b16 a[176:177], v22 offset:512
    ds_read_b64_tr_b16 a[178:179], v26 offset:512
    s_waitcnt lgkmcnt(15)
    v_mfma_f32_32x32x16_bf16 v[32:47], a[208:211], a[48:51], v[32:47]
    ds_read_b128 a[200:203], v11 offset:512
    ds_read_b64_tr_b16 a[184:185], v23 offset:512
    ds_read_b64_tr_b16 a[186:187], v27 offset:512
    s_waitcnt lgkmcnt(15)
    v_mfma_f32_32x32x16_bf16 v[32:47], a[212:215], a[52:55], v[32:47]
    v_xor_b32 v8, 32, v4
    s_add_u32 m0, s8, 30720
    s_add_u32 s10, s56, 6144
    buffer_load_dwordx4 v8, s[32:35], s10 offen sc1 lds
    ds_read_b128 a[204:207], v12 offset:512
    ds_read_b64_tr_b16 a[100:101], v20 offset:12288
    ds_read_b64_tr_b16 a[102:103], v24 offset:12288
    s_waitcnt lgkmcnt(15)
    v_mfma_f32_32x32x16_bf16 v[32:47], a[216:219], a[56:59], v[32:47]
    ds_read_b128 a[208:211], v13 offset:512
    ds_read_b64_tr_b16 a[108:109], v21 offset:12288
    ds_read_b64_tr_b16 a[110:111], v25 offset:12288
    s_waitcnt lgkmcnt(15)
    v_mfma_f32_32x32x16_bf16 v[32:47], a[220:223], a[60:63], v[32:47]
    v_xor_b32 v7, 32, v5
    s_add_u32 m0, s8, 31744
    s_add_u32 s10, s56, 6144
    buffer_load_dwordx4 v7, s[32:35], s10 offen sc1 lds
    ds_read_b128 a[212:215], v14 offset:512
    ds_read_b64_tr_b16 a[116:117], v22 offset:12288
    ds_read_b64_tr_b16 a[118:119], v26 offset:12288
    s_waitcnt lgkmcnt(15)
    v_mfma_f32_32x32x16_bf16 v[32:47], a[192:195], a[64:67], v[32:47]
    ds_read_b128 a[216:219], v15 offset:512
    ds_read_b64_tr_b16 a[124:125], v23 offset:12288
    ds_read_b64_tr_b16 a[126:127], v27 offset:12288
    s_waitcnt lgkmcnt(15)
    v_mfma_f32_32x32x16_bf16 v[32:47], a[196:199], a[68:71], v[32:47]
    v_xor_b32 v8, 32, v6
    s_add_u32 m0, s8, 32768
    s_add_u32 s10, s56, 6144
    buffer_load_dwordx4 v8, s[32:35], s10 offen sc1 lds
    ds_read_b128 a[220:223], v16 offset:512
    ds_read_b64_tr_b16 a[132:133], v20 offset:12544
    ds_read_b64_tr_b16 a[134:135], v24 offset:12544
    s_waitcnt lgkmcnt(15)
    v_mfma_f32_32x32x16_bf16 v[32:47], a[200:203], a[72:75], v[32:47]
    ds_read_b64_tr_b16 a[140:141], v21 offset:12544
    ds_read_b64_tr_b16 a[142:143], v25 offset:12544
    s_waitcnt lgkmcnt(15)
    v_mfma_f32_32x32x16_bf16 v[32:47], a[204:207], a[76:79], v[32:47]
    v_xor_b32 v7, 48, v4
    s_add_u32 m0, s8, 33792
    s_add_u32 s10, s56, 9216
    buffer_load_dwordx4 v7, s[32:35], s10 offen sc1 lds
    ds_read_b64_tr_b16 a[148:149], v22 offset:12544
    ds_read_b64_tr_b16 a[150:151], v26 offset:12544
    s_waitcnt lgkmcnt(15)
    v_mfma_f32_32x32x16_bf16 v[32:47], a[208:211], a[80:83], v[32:47]
    ds_read_b64_tr_b16 a[156:157], v23 offset:12544
    ds_read_b64_tr_b16 a[158:159], v27 offset:12544
    s_waitcnt lgkmcnt(14)
    v_mfma_f32_32x32x16_bf16 v[32:47], a[212:215], a[84:87], v[32:47]
    v_xor_b32 v8, 48, v5
    s_add_u32 m0, s8, 34816
    s_add_u32 s10, s56, 9216
    buffer_load_dwordx4 v8, s[32:35], s10 offen sc1 lds
    ds_read_b64_tr_b16 a[164:165], v20 offset:12800
    ds_read_b64_tr_b16 a[166:167], v24 offset:12800
    s_waitcnt lgkmcnt(13)
    v_mfma_f32_32x32x16_bf16 v[32:47], a[216:219], a[88:91], v[32:47]
    ds_read_b64_tr_b16 a[172:173], v21 offset:12800
    ds_read_b64_tr_b16 a[174:175], v25 offset:12800
    ds_read_b64_tr_b16 a[180:181], v22 offset:12800
    ds_read_b64_tr_b16 a[182:183], v26 offset:12800
    s_waitcnt lgkmcnt(14)
    v_mfma_f32_32x32x16_bf16 v[32:47], a[220:223], a[92:95], v[32:47]
    v_xor_b32 v7, 48, v6
    s_add_u32 m0, s8, 35840
    s_add_u32 s10, s56, 9216
    buffer_load_dwordx4 v7, s[32:35], s10 offen sc1 lds
    ds_read_b64_tr_b16 a[188:189], v23 offset:12800
    ds_read_b64_tr_b16 a[190:191], v27 offset:12800
    v_add_u32 v9, v9, v17
    v_add_u32 v10, v10, v17
    v_add_u32 v11, v11, v17
    v_add_u32 v12, v12, v17
    v_add_u32 v13, v13, v17
    v_add_u32 v14, v14, v17
    v_add_u32 v15, v15, v17
    v_add_u32 v16, v16, v17
    s_waitcnt lgkmcnt(0)
    s_add_u32 s57, s15, 4
    s_cmp_ge_u32 s57, 6
    s_cselect_b32 s12, 6, 0
    s_sub_u32 s57, s57, s12
    s_mul_i32 s57, s57, 98304
    s_add_u32 s57, s57, s14
    s_add_u32 s57, s57, 12288
    s_add_u32 m0, s8, 0
    s_add_u32 s10, s57, 0
    buffer_load_dwordx4 v4, s[32:35], s10 offen sc1 lds
    s_add_u32 m0, s8, 1024
    s_add_u32 s10, s57, 0
    buffer_load_dwordx4 v5, s[32:35], s10 offen sc1 lds
    s_add_u32 s60, s15, 3
    s_cmp_eq_u32 s60, 5
    s_cselect_b32 s12, 1, 0
    s_cmp_eq_u32 s60, 11
    s_cselect_b32 s12, 1, s12
    s_cmp_lg_u32 s12, 0
    s_cbranch_scc1 L2_mask3
L2_nomask3:
    v_max3_f32 v30, v32, v33, v34
    v_max3_f32 v30, v30, v35, v36
    v_max3_f32 v30, v30, v37, v38
    v_max3_f32 v30, v30, v39, v40
    v_max3_f32 v30, v30, v41, v42
    v_max3_f32 v30, v30, v43, v44
    v_max3_f32 v30, v30, v45, v46
    v_max_f32 v30, v30, v47
    v_mov_b32 v31, v30
    s_nop 1
    v_permlane32_swap_b32 v30, v31
    s_nop 1
    v_max_f32 v30, v30, v31
    s_add_u32 m0, s8, 2048
    s_add_u32 s10, s57, 0
    buffer_load_dwordx4 v6, s[32:35], s10 offen sc1 lds
    v_add_f32 v31, 0x41000000, v28
    v_cmp_gt_f32 vcc, v30, v31
    s_cbranch_vccnz L2_rs3
L2_nors3:
    v_sub_f32 v32, v32, v28
    v_sub_f32 v33, v33, v28
    v_sub_f32 v34, v34, v28
    v_sub_f32 v35, v35, v28
    v_sub_f32 v36, v36, v28
    v_sub_f32 v37, v37, v28
    v_sub_f32 v38, v38, v28
    v_sub_f32 v39, v39, v28
    v_exp_f32 v32, v32
    v_exp_f32 v33, v33
    v_exp_f32 v34, v34
    v_exp_f32 v35, v35
    v_exp_f32 v36, v36
    v_exp_f32 v37, v37
    v_exp_f32 v38, v38
    v_exp_f32 v39, v39
    v_xor_b32 v8, 16, v4
    s_add_u32 m0, s8, 3072
    s_add_u32 s10, s57, 3072
    buffer_load_dwordx4 v8, s[32:35], s10 offen sc1 lds
    v_cvt_pk_bf16_f32 v48, v32, v33
    v_cvt_pk_bf16_f32 v49, v34, v35
    v_cvt_pk_bf16_f32 v50, v36, v37
    v_cvt_pk_bf16_f32 v51, v38, v39
    s_nop 1
    v_mfma_f32_32x32x16_bf16 v[64:79], a[96:99], v[48:51], v[64:79]
    v_sub_f32 v40, v40, v28
    v_sub_f32 v41, v41, v28
    v_sub_f32 v42, v42, v28
    v_mfma_f32_32x32x16_bf16 v[80:95], a[104:107], v[48:51], v[80:95]
    v_sub_f32 v43, v43, v28
    v_sub_f32 v44, v44, v28
    v_sub_f32 v45, v45, v28
    v_xor_b32 v7, 16, v5
    s_add_u32 m0, s8, 4096
    s_add_u32 s10, s57, 3072
    buffer_load_dwordx4 v7, s[32:35], s10 offen sc1 lds
    v_mfma_f32_32x32x16_bf16 v[96:111], a[112:115], v[48:51], v[96:111]
    v_sub_f32 v46, v46, v28
    v_sub_f32 v47, v47, v28
    v_exp_f32 v40, v40
    v_mfma_f32_32x32x16_bf16 v[112:127], a[120:123], v[48:51], v[112:127]
    v_exp_f32 v41, v41
    v_exp_f32 v42, v42
    v_exp_f32 v43, v43
    v_xor_b32 v8, 16, v6
    s_add_u32 m0, s8, 5120
    s_add_u32 s10, s57, 3072
    buffer_load_dwordx4 v8, s[32:35], s10 offen sc1 lds
    v_mfma_f32_32x32x16_bf16 v[128:143], a[128:131], v[48:51], v[128:143]
    v_exp_f32 v44, v44
    v_exp_f32 v45, v45
    v_exp_f32 v46, v46
    v_mfma_f32_32x32x16_bf16 v[144:159], a[136:139], v[48:51], v[144:159]
    v_exp_f32 v47, v47
    v_add_f32 v30, v32, v33
    v_cvt_pk_bf16_f32 v52, v40, v41
    v_xor_b32 v7, 32, v4
    s_add_u32 m0, s8, 6144
    s_add_u32 s10, s57, 6144
    buffer_load_dwordx4 v7, s[32:35], s10 offen sc1 lds
    v_mfma_f32_32x32x16_bf16 v[160:175], a[144:147], v[48:51], v[160:175]
    v_cvt_pk_bf16_f32 v53, v42, v43
    v_cvt_pk_bf16_f32 v54, v44, v45
    v_cvt_pk_bf16_f32 v55, v46, v47
    v_mfma_f32_32x32x16_bf16 v[176:191], a[152:155], v[48:51], v[176:191]
    v_add_f32 v31, v34, v35
    v_add_f32 v30, v30, v36
    v_add_f32 v31, v31, v37
    v_xor_b32 v8, 32, v5
    s_add_u32 m0, s8, 7168
    s_add_u32 s10, s57, 6144
    buffer_load_dwordx4 v8, s[32:35], s10 offen sc1 lds
    v_mfma_f32_32x32x16_bf16 v[192:207], a[160:163], v[48:51], v[192:207]
    v_add_f32 v30, v30, v38
    v_add_f32 v31, v31, v39
    v_mfma_f32_32x32x16_bf16 v[208:223], a[168:171], v[48:51], v[208:223]
    v_add_f32 v30, v30, v40
    v_add_f32 v31, v31, v41
    v_xor_b32 v7, 32, v6
    s_add_u32 m0, s8, 8192
    s_add_u32 s10, s57, 6144
    buffer_load_dwordx4 v7, s[32:35], s10 offen sc1 lds
    v_mfma_f32_32x32x16_bf16 v[224:239], a[176:179], v[48:51], v[224:239]
    v_add_f32 v30, v30, v42
    v_add_f32 v31, v31, v43
    v_xor_b32 v8, 48, v4
    s_add_u32 m0, s8, 9216
    s_add_u32 s10, s57, 9216
    buffer_load_dwordx4 v8, s[32:35], s10 offen sc1 lds
    v_mfma_f32_32x32x16_bf16 v[240:255], a[184:187], v[48:51], v[240:255]
    v_add_f32 v30, v30, v44
    v_add_f32 v31, v31, v45
    v_xor_b32 v7, 48, v5
    s_add_u32 m0, s8, 10240
    s_add_u32 s10, s57, 9216
    buffer_load_dwordx4 v7, s[32:35], s10 offen sc1 lds
    v_mfma_f32_32x32x16_bf16 v[64:79], a[100:103], v[52:55], v[64:79]
    v_add_f32 v30, v30, v46
    v_add_f32 v31, v31, v47
    v_xor_b32 v8, 48, v6
    s_add_u32 m0, s8, 11264
    s_add_u32 s10, s57, 9216
    buffer_load_dwordx4 v8, s[32:35], s10 offen sc1 lds
    v_mfma_f32_32x32x16_bf16 v[80:95], a[108:111], v[52:55], v[80:95]
    v_add_f32 v29, v29, v30
    v_add_f32 v29, v29, v31
    v_mfma_f32_32x32x16_bf16 v[96:111], a[116:119], v[52:55], v[96:111]
    v_mfma_f32_32x32x16_bf16 v[112:127], a[124:127], v[52:55], v[112:127]
    v_mfma_f32_32x32x16_bf16 v[128:143], a[132:135], v[52:55], v[128:143]
    v_mfma_f32_32x32x16_bf16 v[144:159], a[140:143], v[52:55], v[144:159]
    s_waitcnt vmcnt(0)
    ds_read_b128 a[192:195], v9 offset:0
    ds_read_b128 a[196:199], v10 offset:0
    ds_read_b128 a[200:203], v11 offset:0
    ds_read_b128 a[204:207], v12 offset:0
    ds_read_b128 a[208:211], v13 offset:0
    v_mfma_f32_32x32x16_bf16 v[160:175], a[148:151], v[52:55], v[160:175]
    v_mfma_f32_32x32x16_bf16 v[176:191], a[156:159], v[52:55], v[176:191]
    v_mfma_f32_32x32x16_bf16 v[192:207], a[164:167], v[52:55], v[192:207]
    v_mfma_f32_32x32x16_bf16 v[208:223], a[172:175], v[52:55], v[208:223]
    v_mfma_f32_32x32x16_bf16 v[224:239], a[180:183], v[52:55], v[224:239]
    v_mfma_f32_32x32x16_bf16 v[240:255], a[188:191], v[52:55], v[240:255]
    ds_read_b128 a[212:215], v14 offset:0
    s_waitcnt lgkmcnt(5)
    v_mfma_f32_32x32x16_bf16 v[32:47], a[192:195], a[0:3], 0
    ds_read_b128 a[216:219], v15 offset:0
    s_waitcnt lgkmcnt(5)
    v_mfma_f32_32x32x16_bf16 v[32:47], a[196:199], a[4:7], v[32:47]
    s_add_u32 s56, s15, 5
    s_cmp_ge_u32 s56, 6
    s_cselect_b32 s12, 6, 0
    s_sub_u32 s56, s56, s12
    s_mul_i32 s56, s56, 98304
    s_add_u32 s56, s56, s14
    s_add_u32 m0, s8, 12288
    s_add_u32 s10, s56, 0
    buffer_load_dwordx4 v4, s[32:35], s10 offen sc1 lds
    ds_read_b128 a[220:223], v16 offset:0
    ds_read_b64_tr_b16 a[96:97], v20 offset:24576
    ds_read_b64_tr_b16 a[98:99], v24 offset:24576
    s_waitcnt lgkmcnt(7)
    v_mfma_f32_32x32x16_bf16 v[32:47], a[200:203], a[8:11], v[32:47]
    ds_read_b128 a[192:195], v9 offset:256
    ds_read_b64_tr_b16 a[104:105], v21 offset:24576
    ds_read_b64_tr_b16 a[106:107], v25 offset:24576
    s_waitcnt lgkmcnt(9)
    v_mfma_f32_32x32x16_bf16 v[32:47], a[204:207], a[12:15], v[32:47]
    s_add_u32 m0, s8, 13312
    s_add_u32 s10, s56, 0
    buffer_load_dwordx4 v5, s[32:35], s10 offen sc1 lds
    ds_read_b128 a[196:199], v10 offset:256
    ds_read_b64_tr_b16 a[112:113], v22 offset:24576
    ds_read_b64_tr_b16 a[114:115], v26 offset:24576
    s_waitcnt lgkmcnt(11)
    v_mfma_f32_32x32x16_bf16 v[32:47], a[208:211], a[16:19], v[32:47]
    ds_read_b128 a[200:203], v11 offset:256
    ds_read_b64_tr_b16 a[120:121], v23 offset:24576
    ds_read_b64_tr_b16 a[122:123], v27 offset:24576
    s_waitcnt lgkmcnt(13)
    v_mfma_f32_32x32x16_bf16 v[32:47], a[212:215], a[20:23], v[32:47]
    s_add_u32 m0, s8, 14336
    s_add_u32 s10, s56, 0
    buffer_load_dwordx4 v6, s[32:35], s10 offen sc1 lds
    ds_read_b128 a[204:207], v12 offset:256
    ds_read_b64_tr_b16 a[128:129], v20 offset:24832
    ds_read_b64_tr_b16 a[130:131], v24 offset:24832
    s_waitcnt lgkmcnt(15)
    v_mfma_f32_32x32x16_bf16 v[32:47], a[216:219], a[24:27], v[32:47]
    ds_read_b128 a[208:211], v13 offset:256
    ds_read_b64_tr_b16 a[136:137], v21 offset:24832
    ds_read_b64_tr_b16 a[138:139], v25 offset:24832
    s_waitcnt lgkmcnt(15)
    v_mfma_f32_32x32x16_bf16 v[32:47], a[220:223], a[28:31], v[32:47]
    v_xor_b32 v7, 16, v4
    s_add_u32 m0, s8, 15360
    s_add_u32 s10, s56, 3072
    buffer_load_dwordx4 v7, s[32:35], s10 offen sc1 lds
    ds_read_b128 a[212:215], v14 offset:256
    ds_read_b64_tr_b16 a[144:145], v22 offset:24832
    ds_read_b64_tr_b16 a[146:147], v26 offset:24832
    s_waitcnt lgkmcnt(15)
    v_mfma_f32_32x32x16_bf16 v[32:47], a[192:195], a[32:35], v[32:47]
    ds_read_b128 a[216:219], v15 offset:256
    ds_read_b64_tr_b16 a[152:153], v23 offset:24832
    ds_read_b64_tr_b16 a[154:155], v27 offset:24832
    s_waitcnt lgkmcnt(15)
    v_mfma_f32_32x32x16_bf16 v[32:47], a[196:199], a[36:39], v[32:47]
    v_xor_b32 v8, 16, v5
    s_add_u32 m0, s8, 16384
    s_add_u32 s10, s56, 3072
    buffer_load_dwordx4 v8, s[32:35], s10 offen sc1 lds
    ds_read_b128 a[220:223], v16 offset:256
    ds_read_b64_tr_b16 a[160:161], v20 offset:25088
    ds_read_b64_tr_b16 a[162:163], v24 offset:25088
    s_waitcnt lgkmcnt(15)
    v_mfma_f32_32x32x16_bf16 v[32:47], a[200:203], a[40:43], v[32:47]
    ds_read_b128 a[192:195], v9 offset:512
    ds_read_b64_tr_b16 a[168:169], v21 offset:25088
    ds_read_b64_tr_b16 a[170:171], v25 offset:25088
    s_waitcnt lgkmcnt(15)
    v_mfma_f32_32x32x16_bf16 v[32:47], a[204:207], a[44:47], v[32:47]
    v_xor_b32 v7, 16, v6
    s_add_u32 m0, s8, 17408
    s_add_u32 s10, s56, 3072
    buffer_load_dwordx4 v7, s[32:35], s10 offen sc1 lds
    ds_read_b128 a[196:199], v10 offset:512
    ds_read_b64_tr_b16 a[176:177], v22 offset:25088
    ds_read_b64_tr_b16 a[178:179], v26 offset:25088
    s_waitcnt lgkmcnt(15)
    v_mfma_f32_32x32x16_bf16 v[32:47], a[208:211], a[48:51], v[32:47]
    ds_read_b128 a[200:203], v11 offset:512
    ds_read_b64_tr_b16 a[184:185], v23 offset:25088
    ds_read_b64_tr_b16 a[186:187], v27 offset:25088
    s_waitcnt lgkmcnt(15)
    v_mfma_f32_32x32x16_bf16 v[32:47], a[212:215], a[52:55], v[32:47]
    v_xor_b32 v8, 32, v4
    s_add_u32 m0, s8, 18432
    s_add_u32 s10, s56, 6144
    buffer_load_dwordx4 v8, s[32:35], s10 offen sc1 lds
    ds_read_b128 a[204:207], v12 offset:512
    ds_read_b64_tr_b16 a[100:101], v20 offset:0
    ds_read_b64_tr_b16 a[102:103], v24 offset:0
    s_waitcnt lgkmcnt(15)
    v_mfma_f32_32x32x16_bf16 v[32:47], a[216:219], a[56:59], v[32:47]
    ds_read_b128 a[208:211], v13 offset:512
    ds_read_b64_tr_b16 a[108:109], v21 offset:0
    ds_read_b64_tr_b16 a[110:111], v25 offset:0
    s_waitcnt lgkmcnt(15)
    v_mfma_f32_32x32x16_bf16 v[32:47], a[220:223], a[60:63], v[32:47]
    v_xor_b32 v7, 32, v5
    s_add_u32 m0, s8, 19456
    s_add_u32 s10, s56, 6144
    buffer_load_dwordx4 v7, s[32:35], s10 offen sc1 lds
    ds_read_b128 a[212:215], v14 offset:512
    ds_read_b64_tr_b16 a[116:117], v22 offset:0
    ds_read_b64_tr_b16 a[118:119], v26 offset:0
    s_waitcnt lgkmcnt(15)
    v_mfma_f32_32x32x16_bf16 v[32:47], a[192:195], a[64:67], v[32:47]
    ds_read_b128 a[216:219], v15 offset:512
    ds_read_b64_tr_b16 a[124:125], v23 offset:0
    ds_read_b64_tr_b16 a[126:127], v27 offset:0
    s_waitcnt lgkmcnt(15)
    v_mfma_f32_32x32x16_bf16 v[32:47], a[196:199], a[68:71], v[32:47]
    v_xor_b32 v8, 32, v6
    s_add_u32 m0, s8, 20480
    s_add_u32 s10, s56, 6144
    buffer_load_dwordx4 v8, s[32:35], s10 offen sc1 lds
    ds_read_b128 a[220:223], v16 offset:512
    ds_read_b64_tr_b16 a[132:133], v20 offset:256
    ds_read_b64_tr_b16 a[134:135], v24 offset:256
    s_waitcnt lgkmcnt(15)
    v_mfma_f32_32x32x16_bf16 v[32:47], a[200:203], a[72:75], v[32:47]
    ds_read_b64_tr_b16 a[140:141], v21 offset:256
    ds_read_b64_tr_b16 a[142:143], v25 offset:256
    s_waitcnt lgkmcnt(15)
    v_mfma_f32_32x32x16_bf16 v[32:47], a[204:207], a[76:79], v[32:47]
    v_xor_b32 v7, 48, v4
    s_add_u32 m0, s8, 21504
    s_add_u32 s10, s56, 9216
    buffer_load_dwordx4 v7, s[32:35], s10 offen sc1 lds
    ds_read_b64_tr_b16 a[148:149], v22 offset:256
    ds_read_b64_tr_b16 a[150:151], v26 offset:256
    s_waitcnt lgkmcnt(15)
    v_mfma_f32_32x32x16_bf16 v[32:47], a[208:211], a[80:83], v[32:47]
    ds_read_b64_tr_b16 a[156:157], v23 offset:256
    ds_read_b64_tr_b16 a[158:159], v27 offset:256
    s_waitcnt lgkmcnt(14)
    v_mfma_f32_32x32x16_bf16 v[32:47], a[212:215], a[84:87], v[32:47]
    v_xor_b32 v8, 48, v5
    s_add_u32 m0, s8, 22528
    s_add_u32 s10, s56, 9216
    buffer_load_dwordx4 v8, s[32:35], s10 offen sc1 lds
    ds_read_b64_tr_b16 a[164:165], v20 offset:512
    ds_read_b64_tr_b16 a[166:167], v24 offset:512
    s_waitcnt lgkmcnt(13)
    v_mfma_f32_32x32x16_bf16 v[32:47], a[216:219], a[88:91], v[32:47]
    ds_read_b64_tr_b16 a[172:173], v21 offset:512
    ds_read_b64_tr_b16 a[174:175], v25 offset:512
    ds_read_b64_tr_b16 a[180:181], v22 offset:512
    ds_read_b64_tr_b16 a[182:183], v26 offset:512
    s_waitcnt lgkmcnt(14)
    v_mfma_f32_32x32x16_bf16 v[32:47], a[220:223], a[92:95], v[32:47]
    v_xor_b32 v7, 48, v6
    s_add_u32 m0, s8, 23552
    s_add_u32 s10, s56, 9216
    buffer_load_dwordx4 v7, s[32:35], s10 offen sc1 lds
    ds_read_b64_tr_b16 a[188:189], v23 offset:512
    ds_read_b64_tr_b16 a[190:191], v27 offset:512
    v_add_u32 v9, v9, v18
    v_add_u32 v10, v10, v18
    v_add_u32 v11, v11, v18
    v_add_u32 v12, v12, v18
    v_add_u32 v13, v13, v18
    v_add_u32 v14, v14, v18
    v_add_u32 v15, v15, v18
    v_add_u32 v16, v16, v18
    s_waitcnt lgkmcnt(0)
    s_add_u32 s57, s15, 5
    s_cmp_ge_u32 s57, 6
    s_cselect_b32 s12, 6, 0
    s_sub_u32 s57, s57, s12
    s_mul_i32 s57, s57, 98304
    s_add_u32 s57, s57, s14
    s_add_u32 s57, s57, 12288
    s_add_u32 m0, s8, 24576
    s_add_u32 s10, s57, 0
    buffer_load_dwordx4 v4, s[32:35], s10 offen sc1 lds
    s_add_u32 m0, s8, 25600
    s_add_u32 s10, s57, 0
    buffer_load_dwordx4 v5, s[32:35], s10 offen sc1 lds
    s_add_u32 s60, s15, 4
    s_cmp_eq_u32 s60, 5
    s_cselect_b32 s12, 1, 0
    s_cmp_eq_u32 s60, 11
    s_cselect_b32 s12, 1, s12
    s_cmp_lg_u32 s12, 0
    s_cbranch_scc1 L2_mask4
L2_nomask4:
    v_max3_f32 v30, v32, v33, v34
    v_max3_f32 v30, v30, v35, v36
    v_max3_f32 v30, v30, v37, v38
    v_max3_f32 v30, v30, v39, v40
    v_max3_f32 v30, v30, v41, v42
    v_max3_f32 v30, v30, v43, v44
    v_max3_f32 v30, v30, v45, v46
    v_max_f32 v30, v30, v47
    v_mov_b32 v31, v30
    s_nop 1
    v_permlane32_swap_b32 v30, v31
    s_nop 1
    v_max_f32 v30, v30, v31
    s_add_u32 m0, s8, 26624
    s_add_u32 s10, s57, 0
    buffer_load_dwordx4 v6, s[32:35], s10 offen sc1 lds
    v_add_f32 v31, 0x41000000, v28
    v_cmp_gt_f32 vcc, v30, v31
    s_cbranch_vccnz L2_rs4
L2_nors4:
    v_sub_f32 v32, v32, v28
    v_sub_f32 v33, v33, v28
    v_sub_f32 v34, v34, v28
    v_sub_f32 v35, v35, v28
    v_sub_f32 v36, v36, v28
    v_sub_f32 v37, v37, v28
    v_sub_f32 v38, v38, v28
    v_sub_f32 v39, v39, v28
    v_exp_f32 v32, v32
    v_exp_f32 v33, v33
    v_exp_f32 v34, v34
    v_exp_f32 v35, v35
    v_exp_f32 v36, v36
    v_exp_f32 v37, v37
    v_exp_f32 v38, v38
    v_exp_f32 v39, v39
    v_xor_b32 v8, 16, v4
    s_add_u32 m0, s8, 27648
    s_add_u32 s10, s57, 3072
    buffer_load_dwordx4 v8, s[32:35], s10 offen sc1 lds
    v_cvt_pk_bf16_f32 v48, v32, v33
    v_cvt_pk_bf16_f32 v49, v34, v35
    v_cvt_pk_bf16_f32 v50, v36, v37
    v_cvt_pk_bf16_f32 v51, v38, v39
    s_nop 1
    v_mfma_f32_32x32x16_bf16 v[64:79], a[96:99], v[48:51], v[64:79]
    v_sub_f32 v40, v40, v28
    v_sub_f32 v41, v41, v28
    v_sub_f32 v42, v42, v28
    v_mfma_f32_32x32x16_bf16 v[80:95], a[104:107], v[48:51], v[80:95]
    v_sub_f32 v43, v43, v28
    v_sub_f32 v44, v44, v28
    v_sub_f32 v45, v45, v28
    v_xor_b32 v7, 16, v5
    s_add_u32 m0, s8, 28672
    s_add_u32 s10, s57, 3072
    buffer_load_dwordx4 v7, s[32:35], s10 offen sc1 lds
    v_mfma_f32_32x32x16_bf16 v[96:111], a[112:115], v[48:51], v[96:111]
    v_sub_f32 v46, v46, v28
    v_sub_f32 v47, v47, v28
    v_exp_f32 v40, v40
    v_mfma_f32_32x32x16_bf16 v[112:127], a[120:123], v[48:51], v[112:127]
    v_exp_f32 v41, v41
    v_exp_f32 v42, v42
    v_exp_f32 v43, v43
    v_xor_b32 v8, 16, v6
    s_add_u32 m0, s8, 29696
    s_add_u32 s10, s57, 3072
    buffer_load_dwordx4 v8, s[32:35], s10 offen sc1 lds
    v_mfma_f32_32x32x16_bf16 v[128:143], a[128:131], v[48:51], v[128:143]
    v_exp_f32 v44, v44
    v_exp_f32 v45, v45
    v_exp_f32 v46, v46
    v_mfma_f32_32x32x16_bf16 v[144:159], a[136:139], v[48:51], v[144:159]
    v_exp_f32 v47, v47
    v_add_f32 v30, v32, v33
    v_cvt_pk_bf16_f32 v52, v40, v41
    v_xor_b32 v7, 32, v4
    s_add_u32 m0, s8, 30720
    s_add_u32 s10, s57, 6144
    buffer_load_dwordx4 v7, s[32:35], s10 offen sc1 lds
    v_mfma_f32_32x32x16_bf16 v[160:175], a[144:147], v[48:51], v[160:175]
    v_cvt_pk_bf16_f32 v53, v42, v43
    v_cvt_pk_bf16_f32 v54, v44, v45
    v_cvt_pk_bf16_f32 v55, v46, v47
    v_mfma_f32_32x32x16_bf16 v[176:191], a[152:155], v[48:51], v[176:191]
    v_add_f32 v31, v34, v35
    v_add_f32 v30, v30, v36
    v_add_f32 v31, v31, v37
    v_xor_b32 v8, 32, v5
    s_add_u32 m0, s8, 31744
    s_add_u32 s10, s57, 6144
    buffer_load_dwordx4 v8, s[32:35], s10 offen sc1 lds
    v_mfma_f32_32x32x16_bf16 v[192:207], a[160:163], v[48:51], v[192:207]
    v_add_f32 v30, v30, v38
    v_add_f32 v31, v31, v39
    v_mfma_f32_32x32x16_bf16 v[208:223], a[168:171], v[48:51], v[208:223]
    v_add_f32 v30, v30, v40
    v_add_f32 v31, v31, v41
    v_xor_b32 v7, 32, v6
    s_add_u32 m0, s8, 32768
    s_add_u32 s10, s57, 6144
    buffer_load_dwordx4 v7, s[32:35], s10 offen sc1 lds
    v_mfma_f32_32x32x16_bf16 v[224:239], a[176:179], v[48:51], v[224:239]
    v_add_f32 v30, v30, v42
    v_add_f32 v31, v31, v43
    v_xor_b32 v8, 48, v4
    s_add_u32 m0, s8, 33792
    s_add_u32 s10, s57, 9216
    buffer_load_dwordx4 v8, s[32:35], s10 offen sc1 lds
    v_mfma_f32_32x32x16_bf16 v[240:255], a[184:187], v[48:51], v[240:255]
    v_add_f32 v30, v30, v44
    v_add_f32 v31, v31, v45
    v_xor_b32 v7, 48, v5
    s_add_u32 m0, s8, 34816
    s_add_u32 s10, s57, 9216
    buffer_load_dwordx4 v7, s[32:35], s10 offen sc1 lds
    v_mfma_f32_32x32x16_bf16 v[64:79], a[100:103], v[52:55], v[64:79]
    v_add_f32 v30, v30, v46
    v_add_f32 v31, v31, v47
    v_xor_b32 v8, 48, v6
    s_add_u32 m0, s8, 35840
    s_add_u32 s10, s57, 9216
    buffer_load_dwordx4 v8, s[32:35], s10 offen sc1 lds
    v_mfma_f32_32x32x16_bf16 v[80:95], a[108:111], v[52:55], v[80:95]
    v_add_f32 v29, v29, v30
    v_add_f32 v29, v29, v31
    v_mfma_f32_32x32x16_bf16 v[96:111], a[116:119], v[52:55], v[96:111]
    v_mfma_f32_32x32x16_bf16 v[112:127], a[124:127], v[52:55], v[112:127]
    v_mfma_f32_32x32x16_bf16 v[128:143], a[132:135], v[52:55], v[128:143]
    v_mfma_f32_32x32x16_bf16 v[144:159], a[140:143], v[52:55], v[144:159]
    s_waitcnt vmcnt(0)
    ds_read_b128 a[192:195], v9 offset:0
    ds_read_b128 a[196:199], v10 offset:0
    ds_read_b128 a[200:203], v11 offset:0
    ds_read_b128 a[204:207], v12 offset:0
    ds_read_b128 a[208:211], v13 offset:0
    v_mfma_f32_32x32x16_bf16 v[160:175], a[148:151], v[52:55], v[160:175]
    v_mfma_f32_32x32x16_bf16 v[176:191], a[156:159], v[52:55], v[176:191]
    v_mfma_f32_32x32x16_bf16 v[192:207], a[164:167], v[52:55], v[192:207]
    v_mfma_f32_32x32x16_bf16 v[208:223], a[172:175], v[52:55], v[208:223]
    v_mfma_f32_32x32x16_bf16 v[224:239], a[180:183], v[52:55], v[224:239]
    v_mfma_f32_32x32x16_bf16 v[240:255], a[188:191], v[52:55], v[240:255]
    ds_read_b128 a[212:215], v14 offset:0
    s_waitcnt lgkmcnt(5)
    v_mfma_f32_32x32x16_bf16 v[32:47], a[192:195], a[0:3], 0
    ds_read_b128 a[216:219], v15 offset:0
    s_waitcnt lgkmcnt(5)
    v_mfma_f32_32x32x16_bf16 v[32:47], a[196:199], a[4:7], v[32:47]
    ds_read_b128 a[220:223], v16 offset:0
    ds_read_b64_tr_b16 a[96:97], v20 offset:12288
    ds_read_b64_tr_b16 a[98:99], v24 offset:12288
    s_waitcnt lgkmcnt(7)
    v_mfma_f32_32x32x16_bf16 v[32:47], a[200:203], a[8:11], v[32:47]
    s_add_u32 s59, s58, 0
    buffer_load_dwordx4 a[224:227], v63, s[48:51], s59 offen offset:0 sc1
    ds_read_b128 a[192:195], v9 offset:256
    ds_read_b64_tr_b16 a[104:105], v21 offset:12288
    ds_read_b64_tr_b16 a[106:107], v25 offset:12288
    s_waitcnt lgkmcnt(9)
    v_mfma_f32_32x32x16_bf16 v[32:47], a[204:207], a[12:15], v[32:47]
    ds_read_b128 a[196:199], v10 offset:256
    ds_read_b64_tr_b16 a[112:113], v22 offset:12288
    ds_read_b64_tr_b16 a[114:115], v26 offset:12288
    s_waitcnt lgkmcnt(11)
    v_mfma_f32_32x32x16_bf16 v[32:47], a[208:211], a[16:19], v[32:47]
    ds_read_b128 a[200:203], v11 offset:256
    ds_read_b64_tr_b16 a[120:121], v23 offset:12288
    ds_read_b64_tr_b16 a[122:123], v27 offset:12288
    s_waitcnt lgkmcnt(13)
    v_mfma_f32_32x32x16_bf16 v[32:47], a[212:215], a[20:23], v[32:47]
    s_add_u32 s59, s58, 24576
    buffer_load_dwordx4 a[228:231], v63, s[48:51], s59 offen offset:0 sc1
    ds_read_b128 a[204:207], v12 offset:256
    ds_read_b64_tr_b16 a[128:129], v20 offset:12544
    ds_read_b64_tr_b16 a[130:131], v24 offset:12544
    s_waitcnt lgkmcnt(15)
    v_mfma_f32_32x32x16_bf16 v[32:47], a[216:219], a[24:27], v[32:47]
    ds_read_b128 a[208:211], v13 offset:256
    ds_read_b64_tr_b16 a[136:137], v21 offset:12544
    ds_read_b64_tr_b16 a[138:139], v25 offset:12544
    s_waitcnt lgkmcnt(15)
    v_mfma_f32_32x32x16_bf16 v[32:47], a[220:223], a[28:31], v[32:47]
    ds_read_b128 a[212:215], v14 offset:256
    ds_read_b64_tr_b16 a[144:145], v22 offset:12544
    ds_read_b64_tr_b16 a[146:147], v26 offset:12544
    s_waitcnt lgkmcnt(15)
    v_mfma_f32_32x32x16_bf16 v[32:47], a[192:195], a[32:35], v[32:47]
    s_add_u32 s59, s58, 49152
    buffer_load_dwordx4 a[232:235], v63, s[48:51], s59 offen offset:0 sc1
    ds_read_b128 a[216:219], v15 offset:256
    ds_read_b64_tr_b16 a[152:153], v23 offset:12544
    ds_read_b64_tr_b16 a[154:155], v27 offset:12544
    s_waitcnt lgkmcnt(15)
    v_mfma_f32_32x32x16_bf16 v[32:47], a[196:199], a[36:39], v[32:47]
    ds_read_b128 a[220:223], v16 offset:256
    ds_read_b64_tr_b16 a[160:161], v20 offset:12800
    ds_read_b64_tr_b16 a[162:163], v24 offset:12800
    s_waitcnt lgkmcnt(15)
    v_mfma_f32_32x32x16_bf16 v[32:47], a[200:203], a[40:43], v[32:47]
    ds_read_b128 a[192:195], v9 offset:512
    ds_read_b64_tr_b16 a[168:169], v21 offset:12800
    ds_read_b64_tr_b16 a[170:171], v25 offset:12800
    s_waitcnt lgkmcnt(15)
    v_mfma_f32_32x32x16_bf16 v[32:47], a[204:207], a[44:47], v[32:47]
    s_add_u32 s59, s58, 0
    buffer_load_dwordx4 a[236:239], v63, s[48:51], s59 offen offset:1024 sc1
    ds_read_b128 a[196:199], v10 offset:512
    ds_read_b64_tr_b16 a[176:177], v22 offset:12800
    ds_read_b64_tr_b16 a[178:179], v26 offset:12800
    s_waitcnt lgkmcnt(15)
    v_mfma_f32_32x32x16_bf16 v[32:47], a[208:211], a[48:51], v[32:47]
    ds_read_b128 a[200:203], v11 offset:512
    ds_read_b64_tr_b16 a[184:185], v23 offset:12800
    ds_read_b64_tr_b16 a[186:187], v27 offset:12800
    s_waitcnt lgkmcnt(15)
    v_mfma_f32_32x32x16_bf16 v[32:47], a[212:215], a[52:55], v[32:47]
    ds_read_b128 a[204:207], v12 offset:512
    ds_read_b64_tr_b16 a[100:101], v20 offset:24576
    ds_read_b64_tr_b16 a[102:103], v24 offset:24576
    s_waitcnt lgkmcnt(15)
    v_mfma_f32_32x32x16_bf16 v[32:47], a[216:219], a[56:59], v[32:47]
    s_add_u32 s59, s58, 24576
    buffer_load_dwordx4 a[240:243], v63, s[48:51], s59 offen offset:1024 sc1
    ds_read_b128 a[208:211], v13 offset:512
    ds_read_b64_tr_b16 a[108:109], v21 offset:24576
    ds_read_b64_tr_b16 a[110:111], v25 offset:24576
    s_waitcnt lgkmcnt(15)
    v_mfma_f32_32x32x16_bf16 v[32:47], a[220:223], a[60:63], v[32:47]
    ds_read_b128 a[212:215], v14 offset:512
    ds_read_b64_tr_b16 a[116:117], v22 offset:24576
    ds_read_b64_tr_b16 a[118:119], v26 offset:24576
    s_waitcnt lgkmcnt(15)
    v_mfma_f32_32x32x16_bf16 v[32:47], a[192:195], a[64:67], v[32:47]
    ds_read_b128 a[216:219], v15 offset:512
    ds_read_b64_tr_b16 a[124:125], v23 offset:24576
    ds_read_b64_tr_b16 a[126:127], v27 offset:24576
    s_waitcnt lgkmcnt(15)
    v_mfma_f32_32x32x16_bf16 v[32:47], a[196:199], a[68:71], v[32:47]
    s_add_u32 s59, s58, 49152
    buffer_load_dwordx4 a[244:247], v63, s[48:51], s59 offen offset:1024 sc1
    ds_read_b128 a[220:223], v16 offset:512
    ds_read_b64_tr_b16 a[132:133], v20 offset:24832
    ds_read_b64_tr_b16 a[134:135], v24 offset:24832
    s_waitcnt lgkmcnt(15)
    v_mfma_f32_32x32x16_bf16 v[32:47], a[200:203], a[72:75], v[32:47]
    ds_read_b64_tr_b16 a[140:141], v21 offset:24832
    ds_read_b64_tr_b16 a[142:143], v25 offset:24832
    s_waitcnt lgkmcnt(15)
    v_mfma_f32_32x32x16_bf16 v[32:47], a[204:207], a[76:79], v[32:47]
    ds_read_b64_tr_b16 a[148:149], v22 offset:24832
    ds_read_b64_tr_b16 a[150:151], v26 offset:24832
    s_waitcnt lgkmcnt(15)
    v_mfma_f32_32x32x16_bf16 v[32:47], a[208:211], a[80:83], v[32:47]
    s_add_u32 s59, s58, 0
    buffer_load_dwordx4 a[248:251], v63, s[48:51], s59 offen offset:2048 sc1
    ds_read_b64_tr_b16 a[156:157], v23 offset:24832
    ds_read_b64_tr_b16 a[158:159], v27 offset:24832
    s_waitcnt lgkmcnt(14)
    v_mfma_f32_32x32x16_bf16 v[32:47], a[212:215], a[84:87], v[32:47]
    ds_read_b64_tr_b16 a[164:165], v20 offset:25088
    ds_read_b64_tr_b16 a[166:167], v24 offset:25088
    s_waitcnt lgkmcnt(13)
    v_mfma_f32_32x32x16_bf16 v[32:47], a[216:219], a[88:91], v[32:47]
    ds_read_b64_tr_b16 a[172:173], v21 offset:25088
    ds_read_b64_tr_b16 a[174:175], v25 offset:25088
    ds_read_b64_tr_b16 a[180:181], v22 offset:25088
    ds_read_b64_tr_b16 a[182:183], v26 offset:25088
    s_waitcnt lgkmcnt(14)
    v_mfma_f32_32x32x16_bf16 v[32:47], a[220:223], a[92:95], v[32:47]
    s_add_u32 s59, s58, 24576
    buffer_load_dwordx4 a[252:255], v63, s[48:51], s59 offen offset:2048 sc1
    ds_read_b64_tr_b16 a[188:189], v23 offset:25088
    ds_read_b64_tr_b16 a[190:191], v27 offset:25088
    s_nop 7
    s_waitcnt lgkmcnt(0)
    s_add_u32 s59, s58, 49152
    buffer_load_dwordx4 a[0:3], v63, s[48:51], s59 offen offset:2048 sc1
    s_add_u32 s59, s58, 0
    buffer_load_dwordx4 a[4:7], v63, s[48:51], s59 offen offset:3072 sc1
    s_add_u32 s60, s15, 5
    s_cmp_eq_u32 s60, 5
    s_cselect_b32 s12, 1, 0
    s_cmp_eq_u32 s60, 11
    s_cselect_b32 s12, 1, s12
    s_cmp_lg_u32 s12, 0
    s_cbranch_scc1 L2_mask5
L2_nomask5:
    v_max3_f32 v30, v32, v33, v34
    v_max3_f32 v30, v30, v35, v36
    v_max3_f32 v30, v30, v37, v38
    v_max3_f32 v30, v30, v39, v40
    v_max3_f32 v30, v30, v41, v42
    v_max3_f32 v30, v30, v43, v44
    v_max3_f32 v30, v30, v45, v46
    v_max_f32 v30, v30, v47
    v_mov_b32 v31, v30
    s_nop 1
    v_permlane32_swap_b32 v30, v31
    s_nop 1
    v_max_f32 v30, v30, v31
    s_add_u32 s59, s58, 24576
    buffer_load_dwordx4 a[8:11], v63, s[48:51], s59 offen offset:3072 sc1
    v_add_f32 v31, 0x41000000, v28
    v_cmp_gt_f32 vcc, v30, v31
    s_cbranch_vccnz L2_rs5
L2_nors5:
    v_sub_f32 v32, v32, v28
    v_sub_f32 v33, v33, v28
    v_sub_f32 v34, v34, v28
    v_sub_f32 v35, v35, v28
    v_sub_f32 v36, v36, v28
    v_sub_f32 v37, v37, v28
    v_sub_f32 v38, v38, v28
    v_sub_f32 v39, v39, v28
    v_exp_f32 v32, v32
    v_exp_f32 v33, v33
    v_exp_f32 v34, v34
    v_exp_f32 v35, v35
    v_exp_f32 v36, v36
    v_exp_f32 v37, v37
    v_exp_f32 v38, v38
    v_exp_f32 v39, v39
    s_add_u32 s59, s58, 49152
    buffer_load_dwordx4 a[12:15], v63, s[48:51], s59 offen offset:3072 sc1
    v_cvt_pk_bf16_f32 v48, v32, v33
    v_cvt_pk_bf16_f32 v49, v34, v35
    v_cvt_pk_bf16_f32 v50, v36, v37
    v_cvt_pk_bf16_f32 v51, v38, v39
    s_nop 1
    v_mfma_f32_32x32x16_bf16 v[64:79], a[96:99], v[48:51], v[64:79]
    v_sub_f32 v40, v40, v28
    v_sub_f32 v41, v41, v28
    v_sub_f32 v42, v42, v28
    v_mfma_f32_32x32x16_bf16 v[80:95], a[104:107], v[48:51], v[80:95]
    v_sub_f32 v43, v43, v28
    v_sub_f32 v44, v44, v28
    v_sub_f32 v45, v45, v28
    s_add_u32 s59, s58, 4096
    buffer_load_dwordx4 a[16:19], v63, s[48:51], s59 offen offset:0 sc1
    v_mfma_f32_32x32x16_bf16 v[96:111], a[112:115], v[48:51], v[96:111]
    v_sub_f32 v46, v46, v28
    v_sub_f32 v47, v47, v28
    v_exp_f32 v40, v40
    v_mfma_f32_32x32x16_bf16 v[112:127], a[120:123], v[48:51], v[112:127]
    v_exp_f32 v41, v41
    v_exp_f32 v42, v42
    v_exp_f32 v43, v43
    s_add_u32 s59, s58, 28672
    buffer_load_dwordx4 a[20:23], v63, s[48:51], s59 offen offset:0 sc1
    v_mfma_f32_32x32x16_bf16 v[128:143], a[128:131], v[48:51], v[128:143]
    v_exp_f32 v44, v44
    v_exp_f32 v45, v45
    v_exp_f32 v46, v46
    v_mfma_f32_32x32x16_bf16 v[144:159], a[136:139], v[48:51], v[144:159]
    v_exp_f32 v47, v47
    v_add_f32 v30, v32, v33
    v_cvt_pk_bf16_f32 v52, v40, v41
    s_add_u32 s59, s58, 53248
    buffer_load_dwordx4 a[24:27], v63, s[48:51], s59 offen offset:0 sc1
    v_mfma_f32_32x32x16_bf16 v[160:175], a[144:147], v[48:51], v[160:175]
    v_cvt_pk_bf16_f32 v53, v42, v43
    v_cvt_pk_bf16_f32 v54, v44, v45
    v_cvt_pk_bf16_f32 v55, v46, v47
    v_mfma_f32_32x32x16_bf16 v[176:191], a[152:155], v[48:51], v[176:191]
    v_add_f32 v31, v34, v35
    v_add_f32 v30, v30, v36
    v_add_f32 v31, v31, v37
    s_add_u32 s59, s58, 4096
    buffer_load_dwordx4 a[28:31], v63, s[48:51], s59 offen offset:1024 sc1
    v_mfma_f32_32x32x16_bf16 v[192:207], a[160:163], v[48:51], v[192:207]
    v_add_f32 v30, v30, v38
    v_add_f32 v31, v31, v39
    v_mfma_f32_32x32x16_bf16 v[208:223], a[168:171], v[48:51], v[208:223]
    v_add_f32 v30, v30, v40
    v_add_f32 v31, v31, v41
    s_add_u32 s59, s58, 28672
    buffer_load_dwordx4 a[32:35], v63, s[48:51], s59 offen offset:1024 sc1
    v_mfma_f32_32x32x16_bf16 v[224:239], a[176:179], v[48:51], v[224:239]
    v_add_f32 v30, v30, v42
    v_add_f32 v31, v31, v43
    s_add_u32 s59, s58, 53248
    buffer_load_dwordx4 a[36:39], v63, s[48:51], s59 offen offset:1024 sc1
    v_mfma_f32_32x32x16_bf16 v[240:255], a[184:187], v[48:51], v[240:255]
    v_add_f32 v30, v30, v44
    v_add_f32 v31, v31, v45
    s_add_u32 s59, s58, 4096
    buffer_load_dwordx4 a[40:43], v63, s[48:51], s59 offen offset:2048 sc1
    v_mfma_f32_32x32x16_bf16 v[64:79], a[100:103], v[52:55], v[64:79]
    v_add_f32 v30, v30, v46
    v_add_f32 v31, v31, v47
    s_add_u32 s59, s58, 28672
    buffer_load_dwordx4 a[44:47], v63, s[48:51], s59 offen offset:2048 sc1
    v_mfma_f32_32x32x16_bf16 v[80:95], a[108:111], v[52:55], v[80:95]
    v_add_f32 v29, v29, v30
    v_add_f32 v29, v29, v31
    s_add_u32 s59, s58, 53248
    buffer_load_dwordx4 a[48:51], v63, s[48:51], s59 offen offset:2048 sc1
    v_mfma_f32_32x32x16_bf16 v[96:111], a[116:119], v[52:55], v[96:111]
    s_add_u32 s59, s58, 4096
    buffer_load_dwordx4 a[52:55], v63, s[48:51], s59 offen offset:3072 sc1
    v_mfma_f32_32x32x16_bf16 v[112:127], a[124:127], v[52:55], v[112:127]
    s_add_u32 s59, s58, 28672
    buffer_load_dwordx4 a[56:59], v63, s[48:51], s59 offen offset:3072 sc1
    v_mfma_f32_32x32x16_bf16 v[128:143], a[132:135], v[52:55], v[128:143]
    s_add_u32 s59, s58, 53248
    buffer_load_dwordx4 a[60:63], v63, s[48:51], s59 offen offset:3072 sc1
    v_mfma_f32_32x32x16_bf16 v[144:159], a[140:143], v[52:55], v[144:159]
    s_add_u32 s59, s58, 8192
    buffer_load_dwordx4 a[64:67], v63, s[48:51], s59 offen offset:0 sc1
    v_mfma_f32_32x32x16_bf16 v[160:175], a[148:151], v[52:55], v[160:175]
    s_add_u32 s59, s58, 32768
    buffer_load_dwordx4 a[68:71], v63, s[48:51], s59 offen offset:0 sc1
    v_mfma_f32_32x32x16_bf16 v[176:191], a[156:159], v[52:55], v[176:191]
    s_add_u32 s59, s58, 57344
    buffer_load_dwordx4 a[72:75], v63, s[48:51], s59 offen offset:0 sc1
    v_mfma_f32_32x32x16_bf16 v[192:207], a[164:167], v[52:55], v[192:207]
    s_add_u32 s59, s58, 8192
    buffer_load_dwordx4 a[76:79], v63, s[48:51], s59 offen offset:1024 sc1
    v_mfma_f32_32x32x16_bf16 v[208:223], a[172:175], v[52:55], v[208:223]
    s_add_u32 s59, s58, 32768
    buffer_load_dwordx4 a[80:83], v63, s[48:51], s59 offen offset:1024 sc1
    v_mfma_f32_32x32x16_bf16 v[224:239], a[180:183], v[52:55], v[224:239]
    s_add_u32 s59, s58, 57344
    buffer_load_dwordx4 a[84:87], v63, s[48:51], s59 offen offset:1024 sc1
    v_mfma_f32_32x32x16_bf16 v[240:255], a[188:191], v[52:55], v[240:255]
    s_add_u32 s59, s58, 8192
    buffer_load_dwordx4 a[88:91], v63, s[48:51], s59 offen offset:2048 sc1
    s_add_u32 s59, s58, 32768
    buffer_load_dwordx4 a[92:95], v63, s[48:51], s59 offen offset:2048 sc1
    v_mov_b32 v30, v29
    s_nop 1
    v_permlane32_swap_b32 v29, v30
    s_nop 1
    v_add_f32 v29, v29, v30
    v_lshlrev_b32 v30, 3, v2
    v_add_u32 v30, 147456, v30
    s_lshl_b32 s60, s3, 8
    v_add_u32 v31, s60, v30
    ds_write_b64 v31, v[28:29]
    v_add_u32 v31, s8, v63
    s_nop 4
    ds_write_b128 v31, v[80:83] offset:0
    ds_write_b128 v31, v[84:87] offset:1024
    ds_write_b128 v31, v[88:91] offset:2048
    ds_write_b128 v31, v[92:95] offset:3072
    ds_write_b128 v31, v[144:147] offset:4096
    ds_write_b128 v31, v[148:151] offset:5120
    ds_write_b128 v31, v[152:155] offset:6144
    ds_write_b128 v31, v[156:159] offset:7168
    ds_write_b128 v31, v[208:211] offset:8192
    ds_write_b128 v31, v[212:215] offset:9216
    ds_write_b128 v31, v[216:219] offset:10240
    ds_write_b128 v31, v[220:223] offset:11264
    s_add_u32 s59, s58, 57344
    buffer_load_dwordx4 a[96:99], v63, s[48:51], s59 offen offset:2048 sc1
    s_add_u32 s59, s58, 8192
    buffer_load_dwordx4 a[100:103], v63, s[48:51], s59 offen offset:3072 sc1
    s_add_u32 s59, s58, 32768
    buffer_load_dwordx4 a[104:107], v63, s[48:51], s59 offen offset:3072 sc1
    ds_write_b128 v31, v[96:99] offset:12288
    ds_write_b128 v31, v[100:103] offset:13312
    ds_write_b128 v31, v[104:107] offset:14336
    ds_write_b128 v31, v[108:111] offset:15360
    ds_write_b128 v31, v[160:163] offset:16384
    ds_write_b128 v31, v[164:167] offset:17408
    ds_write_b128 v31, v[168:171] offset:18432
    ds_write_b128 v31, v[172:175] offset:19456
    ds_write_b128 v31, v[224:227] offset:20480
    ds_write_b128 v31, v[228:231] offset:21504
    ds_write_b128 v31, v[232:235] offset:22528
    ds_write_b128 v31, v[236:239] offset:23552
    s_add_u32 s59, s58, 57344
    buffer_load_dwordx4 a[108:111], v63, s[48:51], s59 offen offset:3072 sc1
    s_add_u32 s59, s58, 12288
    buffer_load_dwordx4 a[112:115], v63, s[48:51], s59 offen offset:0 sc1
    s_add_u32 s59, s58, 36864
    buffer_load_dwordx4 a[116:119], v63, s[48:51], s59 offen offset:0 sc1
    ds_write_b128 v31, v[112:115] offset:24576
    ds_write_b128 v31, v[116:119] offset:25600
    ds_write_b128 v31, v[120:123] offset:26624
    ds_write_b128 v31, v[124:127] offset:27648
    ds_write_b128 v31, v[176:179] offset:28672
    ds_write_b128 v31, v[180:183] offset:29696
    ds_write_b128 v31, v[184:187] offset:30720
    ds_write_b128 v31, v[188:191] offset:31744
    ds_write_b128 v31, v[240:243] offset:32768
    ds_write_b128 v31, v[244:247] offset:33792
    ds_write_b128 v31, v[248:251] offset:34816
    ds_write_b128 v31, v[252:255] offset:35840
    s_add_u32 s59, s58, 61440
    buffer_load_dwordx4 a[120:123], v63, s[48:51], s59 offen offset:0 sc1
    s_add_u32 s59, s58, 12288
    buffer_load_dwordx4 a[124:127], v63, s[48:51], s59 offen offset:1024 sc1
    s_add_u32 s59, s58, 36864
    buffer_load_dwordx4 a[128:131], v63, s[48:51], s59 offen offset:1024 sc1
    s_sub_u32 s60, s3, 0
    s_and_b32 s60, s60, 3
    s_lshl_b32 s12, s60, 8
    v_add_u32 v56, s12, v30
    s_sub_u32 s60, s3, 1
    s_and_b32 s60, s60, 3
    s_lshl_b32 s12, s60, 8
    v_add_u32 v57, s12, v30
    s_mul_i32 s12, s60, 36864
    s_add_u32 s12, s12, 0
    v_add_u32 v60, s12, v63
    s_sub_u32 s60, s3, 2
    s_and_b32 s60, s60, 3
    s_lshl_b32 s12, s60, 8
    v_add_u32 v58, s12, v30
    s_mul_i32 s12, s60, 36864
    s_add_u32 s12, s12, 12288
    v_add_u32 v61, s12, v63
    s_sub_u32 s60, s3, 3
    s_and_b32 s60, s60, 3
    s_lshl_b32 s12, s60, 8
    v_add_u32 v59, s12, v30
    s_mul_i32 s12, s60, 36864
    s_add_u32 s12, s12, 24576
    v_add_u32 v62, s12, v63
    s_waitcnt lgkmcnt(0)
    s_barrier
    ds_read_b64 v[32:33], v56
    ds_read_b64 v[34:35], v57
    ds_read_b64 v[36:37], v58
    ds_read_b64 v[38:39], v59
    ds_read_b128 v[80:83], v60 offset:0
    ds_read_b128 v[84:87], v60 offset:1024
    ds_read_b128 v[88:91], v60 offset:2048
    ds_read_b128 v[92:95], v60 offset:3072
    ds_read_b128 v[144:147], v60 offset:4096
    ds_read_b128 v[148:151], v60 offset:5120
    ds_read_b128 v[152:155], v60 offset:6144
    ds_read_b128 v[156:159], v60 offset:7168
    ds_read_b128 v[208:211], v60 offset:8192
    ds_read_b128 v[212:215], v60 offset:9216
    ds_read_b128 v[216:219], v60 offset:10240
    ds_read_b128 v[220:223], v60 offset:11264
    ds_read_b128 v[96:99], v61 offset:0
    ds_read_b128 v[100:103], v61 offset:1024
    ds_read_b128 v[104:107], v61 offset:2048
    ds_read_b128 v[108:111], v61 offset:3072
    ds_read_b128 v[160:163], v61 offset:4096
    ds_read_b128 v[164:167], v61 offset:5120
    ds_read_b128 v[168:171], v61 offset:6144
    ds_read_b128 v[172:175], v61 offset:7168
    ds_read_b128 v[224:227], v61 offset:8192
    ds_read_b128 v[228:231], v61 offset:9216
    ds_read_b128 v[232:235], v61 offset:10240
    ds_read_b128 v[236:239], v61 offset:11264
    ds_read_b128 v[112:115], v62 offset:0
    ds_read_b128 v[116:119], v62 offset:1024
    ds_read_b128 v[120:123], v62 offset:2048
    ds_read_b128 v[124:127], v62 offset:3072
    ds_read_b128 v[176:179], v62 offset:4096
    ds_read_b128 v[180:183], v62 offset:5120
    ds_read_b128 v[184:187], v62 offset:6144
    ds_read_b128 v[188:191], v62 offset:7168
    ds_read_b128 v[240:243], v62 offset:8192
    ds_read_b128 v[244:247], v62 offset:9216
    ds_read_b128 v[248:251], v62 offset:10240
    ds_read_b128 v[252:255], v62 offset:11264
    s_waitcnt lgkmcnt(15)
    v_max3_f32 v40, v32, v34, v36
    v_max_f32 v40, v40, v38
    v_sub_f32 v32, v32, v40
    v_sub_f32 v34, v34, v40
    v_sub_f32 v36, v36, v40
    v_sub_f32 v38, v38, v40
    v_exp_f32 v32, v32
    v_exp_f32 v34, v34
    v_exp_f32 v36, v36
    v_exp_f32 v38, v38
    s_nop 0
    v_mul_f32 v42, v32, v33
    v_fmac_f32 v42, v34, v35
    v_fmac_f32 v42, v36, v37
    v_fmac_f32 v42, v38, v39
    v_rcp_f32 v42, v42
    s_nop 0
    v_mul_f32 v44, v32, v42
    v_mul_f32 v45, v34, v42
    v_mul_f32 v46, v36, v42
    v_mul_f32 v47, v38, v42
    v_mul_f32 v64, v64, v44
    v_mul_f32 v65, v65, v44
    v_mul_f32 v66, v66, v44
    v_mul_f32 v67, v67, v44
    v_mul_f32 v68, v68, v44
    v_mul_f32 v69, v69, v44
    v_mul_f32 v70, v70, v44
    v_mul_f32 v71, v71, v44
    v_mul_f32 v72, v72, v44
    v_mul_f32 v73, v73, v44
    v_mul_f32 v74, v74, v44
    v_mul_f32 v75, v75, v44
    v_mul_f32 v76, v76, v44
    v_mul_f32 v77, v77, v44
    v_mul_f32 v78, v78, v44
    v_mul_f32 v79, v79, v44
    v_mul_f32 v128, v128, v44
    v_mul_f32 v129, v129, v44
    v_mul_f32 v130, v130, v44
    v_mul_f32 v131, v131, v44
    v_mul_f32 v132, v132, v44
    v_mul_f32 v133, v133, v44
    v_mul_f32 v134, v134, v44
    v_mul_f32 v135, v135, v44
    v_mul_f32 v136, v136, v44
    v_mul_f32 v137, v137, v44
    v_mul_f32 v138, v138, v44
    v_mul_f32 v139, v139, v44
    v_mul_f32 v140, v140, v44
    v_mul_f32 v141, v141, v44
    v_mul_f32 v142, v142, v44
    v_mul_f32 v143, v143, v44
    v_mul_f32 v192, v192, v44
    v_mul_f32 v193, v193, v44
    v_mul_f32 v194, v194, v44
    v_mul_f32 v195, v195, v44
    v_mul_f32 v196, v196, v44
    v_mul_f32 v197, v197, v44
    v_mul_f32 v198, v198, v44
    v_mul_f32 v199, v199, v44
    v_mul_f32 v200, v200, v44
    v_mul_f32 v201, v201, v44
    v_mul_f32 v202, v202, v44
    v_mul_f32 v203, v203, v44
    v_mul_f32 v204, v204, v44
    v_mul_f32 v205, v205, v44
    v_mul_f32 v206, v206, v44
    v_mul_f32 v207, v207, v44
    s_add_u32 s59, s58, 61440
    buffer_load_dwordx4 a[132:135], v63, s[48:51], s59 offen offset:1024 sc1
    s_add_u32 s59, s58, 12288
    buffer_load_dwordx4 a[136:139], v63, s[48:51], s59 offen offset:2048 sc1
    s_add_u32 s59, s58, 36864
    buffer_load_dwordx4 a[140:143], v63, s[48:51], s59 offen offset:2048 sc1
    s_add_u32 s59, s58, 61440
    buffer_load_dwordx4 a[144:147], v63, s[48:51], s59 offen offset:2048 sc1
    s_waitcnt lgkmcnt(15)
    v_fmac_f32 v64, v80, v45
    v_fmac_f32 v65, v81, v45
    v_fmac_f32 v66, v82, v45
    v_fmac_f32 v67, v83, v45
    v_fmac_f32 v68, v84, v45
    v_fmac_f32 v69, v85, v45
    v_fmac_f32 v70, v86, v45
    v_fmac_f32 v71, v87, v45
    v_fmac_f32 v72, v88, v45
    v_fmac_f32 v73, v89, v45
    v_fmac_f32 v74, v90, v45
    v_fmac_f32 v75, v91, v45
    v_fmac_f32 v76, v92, v45
    v_fmac_f32 v77, v93, v45
    v_fmac_f32 v78, v94, v45
    v_fmac_f32 v79, v95, v45
    v_fmac_f32 v128, v144, v45
    v_fmac_f32 v129, v145, v45
    v_fmac_f32 v130, v146, v45
    v_fmac_f32 v131, v147, v45
    v_fmac_f32 v132, v148, v45
    v_fmac_f32 v133, v149, v45
    v_fmac_f32 v134, v150, v45
    v_fmac_f32 v135, v151, v45
    v_fmac_f32 v136, v152, v45
    v_fmac_f32 v137, v153, v45
    v_fmac_f32 v138, v154, v45
    v_fmac_f32 v139, v155, v45
    v_fmac_f32 v140, v156, v45
    v_fmac_f32 v141, v157, v45
    v_fmac_f32 v142, v158, v45
    v_fmac_f32 v143, v159, v45
    v_fmac_f32 v192, v208, v45
    v_fmac_f32 v193, v209, v45
    v_fmac_f32 v194, v210, v45
    v_fmac_f32 v195, v211, v45
    v_fmac_f32 v196, v212, v45
    v_fmac_f32 v197, v213, v45
    v_fmac_f32 v198, v214, v45
    v_fmac_f32 v199, v215, v45
    v_fmac_f32 v200, v216, v45
    v_fmac_f32 v201, v217, v45
    v_fmac_f32 v202, v218, v45
    v_fmac_f32 v203, v219, v45
    v_fmac_f32 v204, v220, v45
    v_fmac_f32 v205, v221, v45
    v_fmac_f32 v206, v222, v45
    v_fmac_f32 v207, v223, v45
    s_add_u32 s59, s58, 12288
    buffer_load_dwordx4 a[148:151], v63, s[48:51], s59 offen offset:3072 sc1
    s_add_u32 s59, s58, 36864
    buffer_load_dwordx4 a[152:155], v63, s[48:51], s59 offen offset:3072 sc1
    s_add_u32 s59, s58, 61440
    buffer_load_dwordx4 a[156:159], v63, s[48:51], s59 offen offset:3072 sc1
    s_add_u32 s59, s58, 16384
    buffer_load_dwordx4 a[160:163], v63, s[48:51], s59 offen offset:0 sc1
    s_waitcnt lgkmcnt(12)
    v_fmac_f32 v64, v96, v46
    v_fmac_f32 v65, v97, v46
    v_fmac_f32 v66, v98, v46
    v_fmac_f32 v67, v99, v46
    v_fmac_f32 v68, v100, v46
    v_fmac_f32 v69, v101, v46
    v_fmac_f32 v70, v102, v46
    v_fmac_f32 v71, v103, v46
    v_fmac_f32 v72, v104, v46
    v_fmac_f32 v73, v105, v46
    v_fmac_f32 v74, v106, v46
    v_fmac_f32 v75, v107, v46
    v_fmac_f32 v76, v108, v46
    v_fmac_f32 v77, v109, v46
    v_fmac_f32 v78, v110, v46
    v_fmac_f32 v79, v111, v46
    v_fmac_f32 v128, v160, v46
    v_fmac_f32 v129, v161, v46
    v_fmac_f32 v130, v162, v46
    v_fmac_f32 v131, v163, v46
    v_fmac_f32 v132, v164, v46
    v_fmac_f32 v133, v165, v46
    v_fmac_f32 v134, v166, v46
    v_fmac_f32 v135, v167, v46
    v_fmac_f32 v136, v168, v46
    v_fmac_f32 v137, v169, v46
    v_fmac_f32 v138, v170, v46
    v_fmac_f32 v139, v171, v46
    v_fmac_f32 v140, v172, v46
    v_fmac_f32 v141, v173, v46
    v_fmac_f32 v142, v174, v46
    v_fmac_f32 v143, v175, v46
    v_fmac_f32 v192, v224, v46
    v_fmac_f32 v193, v225, v46
    v_fmac_f32 v194, v226, v46
    v_fmac_f32 v195, v227, v46
    v_fmac_f32 v196, v228, v46
    v_fmac_f32 v197, v229, v46
    v_fmac_f32 v198, v230, v46
    v_fmac_f32 v199, v231, v46
    v_fmac_f32 v200, v232, v46
    v_fmac_f32 v201, v233, v46
    v_fmac_f32 v202, v234, v46
    v_fmac_f32 v203, v235, v46
    v_fmac_f32 v204, v236, v46
    v_fmac_f32 v205, v237, v46
    v_fmac_f32 v206, v238, v46
    v_fmac_f32 v207, v239, v46
    s_add_u32 s59, s58, 40960
    buffer_load_dwordx4 a[164:167], v63, s[48:51], s59 offen offset:0 sc1
    s_add_u32 s59, s58, 65536
    buffer_load_dwordx4 a[168:171], v63, s[48:51], s59 offen offset:0 sc1
    s_add_u32 s59, s58, 16384
    buffer_load_dwordx4 a[172:175], v63, s[48:51], s59 offen offset:1024 sc1
    s_add_u32 s59, s58, 40960
    buffer_load_dwordx4 a[176:179], v63, s[48:51], s59 offen offset:1024 sc1
    s_waitcnt lgkmcnt(0)
    v_fmac_f32 v64, v112, v47
    v_fmac_f32 v65, v113, v47
    v_fmac_f32 v66, v114, v47
    v_fmac_f32 v67, v115, v47
    v_fmac_f32 v68, v116, v47
    v_fmac_f32 v69, v117, v47
    v_fmac_f32 v70, v118, v47
    v_fmac_f32 v71, v119, v47
    v_fmac_f32 v72, v120, v47
    v_fmac_f32 v73, v121, v47
    v_fmac_f32 v74, v122, v47
    v_fmac_f32 v75, v123, v47
    v_fmac_f32 v76, v124, v47
    v_fmac_f32 v77, v125, v47
    v_fmac_f32 v78, v126, v47
    v_fmac_f32 v79, v127, v47
    v_fmac_f32 v128, v176, v47
    v_fmac_f32 v129, v177, v47
    v_fmac_f32 v130, v178, v47
    v_fmac_f32 v131, v179, v47
    v_fmac_f32 v132, v180, v47
    v_fmac_f32 v133, v181, v47
    v_fmac_f32 v134, v182, v47
    v_fmac_f32 v135, v183, v47
    v_fmac_f32 v136, v184, v47
    v_fmac_f32 v137, v185, v47
    v_fmac_f32 v138, v186, v47
    v_fmac_f32 v139, v187, v47
    v_fmac_f32 v140, v188, v47
    v_fmac_f32 v141, v189, v47
    v_fmac_f32 v142, v190, v47
    v_fmac_f32 v143, v191, v47
    v_fmac_f32 v192, v240, v47
    v_fmac_f32 v193, v241, v47
    v_fmac_f32 v194, v242, v47
    v_fmac_f32 v195, v243, v47
    v_fmac_f32 v196, v244, v47
    v_fmac_f32 v197, v245, v47
    v_fmac_f32 v198, v246, v47
    v_fmac_f32 v199, v247, v47
    v_fmac_f32 v200, v248, v47
    v_fmac_f32 v201, v249, v47
    v_fmac_f32 v202, v250, v47
    v_fmac_f32 v203, v251, v47
    v_fmac_f32 v204, v252, v47
    v_fmac_f32 v205, v253, v47
    v_fmac_f32 v206, v254, v47
    v_fmac_f32 v207, v255, v47
    s_add_u32 s59, s58, 65536
    buffer_load_dwordx4 a[180:183], v63, s[48:51], s59 offen offset:1024 sc1
    s_add_u32 s59, s58, 16384
    buffer_load_dwordx4 a[184:187], v63, s[48:51], s59 offen offset:2048 sc1
    s_add_u32 s59, s58, 40960
    buffer_load_dwordx4 a[188:191], v63, s[48:51], s59 offen offset:2048 sc1
    v_cvt_pk_bf16_f32 v32, v64, v65
    v_cvt_pk_bf16_f32 v33, v66, v67
    v_cvt_pk_bf16_f32 v34, v68, v69
    v_cvt_pk_bf16_f32 v35, v70, v71
    v_cvt_pk_bf16_f32 v36, v72, v73
    v_cvt_pk_bf16_f32 v37, v74, v75
    v_cvt_pk_bf16_f32 v38, v76, v77
    v_cvt_pk_bf16_f32 v39, v78, v79
    v_cvt_pk_bf16_f32 v40, v128, v129
    v_cvt_pk_bf16_f32 v41, v130, v131
    v_cvt_pk_bf16_f32 v42, v132, v133
    v_cvt_pk_bf16_f32 v43, v134, v135
    v_cvt_pk_bf16_f32 v44, v136, v137
    v_cvt_pk_bf16_f32 v45, v138, v139
    v_cvt_pk_bf16_f32 v46, v140, v141
    v_cvt_pk_bf16_f32 v47, v142, v143
    v_cvt_pk_bf16_f32 v48, v192, v193
    v_cvt_pk_bf16_f32 v49, v194, v195
    v_cvt_pk_bf16_f32 v50, v196, v197
    v_cvt_pk_bf16_f32 v51, v198, v199
    v_cvt_pk_bf16_f32 v52, v200, v201
    v_cvt_pk_bf16_f32 v53, v202, v203
    v_cvt_pk_bf16_f32 v54, v204, v205
    v_cvt_pk_bf16_f32 v55, v206, v207
    ds_write_b128 v60, v[32:35] offset:0
    ds_write_b128 v60, v[36:39] offset:1024
    ds_write_b128 v60, v[40:43] offset:2048
    ds_write_b128 v60, v[44:47] offset:3072
    ds_write_b128 v60, v[48:51] offset:4096
    ds_write_b128 v60, v[52:55] offset:5120
    v_add_u32 v56, 110592, v63
    v_add_u32 v57, 0, v63
    v_add_u32 v58, 36864, v63
    v_add_u32 v59, 73728, v63
    v_lshrrev_b32 v4, 3, v1
    s_lshl_b32 s60, s3, 3
    v_add_u32 v4, s60, v4
    v_and_b32 v5, 7, v1
    s_lshl_b32 s60, s5, 5
    v_add_u32 v6, s60, v4
    v_mul_u32_u24 v6, 768, v6
    v_lshl_add_u32 v6, v5, 4, v6
    buffer_load_dwordx4 v[160:163], v6, s[40:43], 0 offen offset:0 sc1
    buffer_load_dwordx4 v[164:167], v6, s[40:43], 0 offen offset:128 sc1
    buffer_load_dwordx4 v[168:171], v6, s[40:43], 0 offen offset:256 sc1
    buffer_load_dwordx4 v[172:175], v6, s[40:43], 0 offen offset:384 sc1
    buffer_load_dwordx4 v[176:179], v6, s[40:43], 0 offen offset:512 sc1
    buffer_load_dwordx4 v[180:183], v6, s[40:43], 0 offen offset:640 sc1
    s_waitcnt lgkmcnt(0)
    s_barrier
    ds_read_b128 v[64:67], v56 offset:0
    ds_read_b128 v[68:71], v56 offset:1024
    ds_read_b128 v[72:75], v57 offset:0
    ds_read_b128 v[76:79], v57 offset:1024
    ds_read_b128 v[80:83], v58 offset:0
    ds_read_b128 v[84:87], v58 offset:1024
    ds_read_b128 v[88:91], v59 offset:0
    ds_read_b128 v[92:95], v59 offset:1024
    s_waitcnt lgkmcnt(7)
    s_waitcnt vmcnt(61)
    v_mfma_f32_32x32x16_bf16 v[96:111], a[224:227], v[64:67], 0
    s_add_u32 s59, s58, 65536
    buffer_load_dwordx4 a[224:227], v63, s[48:51], s59 offen offset:2048 sc1
    s_waitcnt vmcnt(61)
    v_mfma_f32_32x32x16_bf16 v[112:127], a[228:231], v[64:67], 0
    s_add_u32 s59, s58, 16384
    buffer_load_dwordx4 a[228:231], v63, s[48:51], s59 offen offset:3072 sc1
    s_waitcnt vmcnt(61)
    v_mfma_f32_32x32x16_bf16 v[128:143], a[232:235], v[64:67], 0
    s_add_u32 s59, s58, 40960
    buffer_load_dwordx4 a[232:235], v63, s[48:51], s59 offen offset:3072 sc1
    ds_read_b128 v[64:67], v56 offset:2048
    s_waitcnt lgkmcnt(7)
    s_waitcnt vmcnt(61)
    v_mfma_f32_32x32x16_bf16 v[96:111], a[236:239], v[68:71], v[96:111]
    s_add_u32 s59, s58, 65536
    buffer_load_dwordx4 a[236:239], v63, s[48:51], s59 offen offset:3072 sc1
    s_waitcnt vmcnt(61)
    v_mfma_f32_32x32x16_bf16 v[112:127], a[240:243], v[68:71], v[112:127]
    s_add_u32 s59, s58, 20480
    buffer_load_dwordx4 a[240:243], v63, s[48:51], s59 offen offset:0 sc1
    s_waitcnt vmcnt(61)
    v_mfma_f32_32x32x16_bf16 v[128:143], a[244:247], v[68:71], v[128:143]
    s_add_u32 s59, s58, 45056
    buffer_load_dwordx4 a[244:247], v63, s[48:51], s59 offen offset:0 sc1
    ds_read_b128 v[68:71], v56 offset:3072
    s_waitcnt lgkmcnt(7)
    s_waitcnt vmcnt(61)
    v_mfma_f32_32x32x16_bf16 v[96:111], a[248:251], v[72:75], v[96:111]
    s_add_u32 s59, s58, 69632
    buffer_load_dwordx4 a[248:251], v63, s[48:51], s59 offen offset:0 sc1
    s_waitcnt vmcnt(61)
    v_mfma_f32_32x32x16_bf16 v[112:127], a[252:255], v[72:75], v[112:127]
    s_add_u32 s59, s58, 20480
    buffer_load_dwordx4 a[252:255], v63, s[48:51], s59 offen offset:1024 sc1
    s_waitcnt vmcnt(61)
    v_mfma_f32_32x32x16_bf16 v[128:143], a[0:3], v[72:75], v[128:143]
    s_add_u32 s59, s58, 45056
    buffer_load_dwordx4 a[0:3], v63, s[48:51], s59 offen offset:1024 sc1
    ds_read_b128 v[72:75], v57 offset:2048
    s_waitcnt lgkmcnt(7)
    s_waitcnt vmcnt(61)
    v_mfma_f32_32x32x16_bf16 v[96:111], a[4:7], v[76:79], v[96:111]
    s_add_u32 s59, s58, 69632
    buffer_load_dwordx4 a[4:7], v63, s[48:51], s59 offen offset:1024 sc1
    s_waitcnt vmcnt(61)
    v_mfma_f32_32x32x16_bf16 v[112:127], a[8:11], v[76:79], v[112:127]
    s_add_u32 s59, s58, 20480
    buffer_load_dwordx4 a[8:11], v63, s[48:51], s59 offen offset:2048 sc1
    s_waitcnt vmcnt(61)
    v_mfma_f32_32x32x16_bf16 v[128:143], a[12:15], v[76:79], v[128:143]
    s_add_u32 s59, s58, 45056
    buffer_load_dwordx4 a[12:15], v63, s[48:51], s59 offen offset:2048 sc1
    ds_read_b128 v[76:79], v57 offset:3072
    s_waitcnt lgkmcnt(7)
    s_waitcnt vmcnt(61)
    v_mfma_f32_32x32x16_bf16 v[96:111], a[16:19], v[80:83], v[96:111]
    s_add_u32 s59, s58, 69632
    buffer_load_dwordx4 a[16:19], v63, s[48:51], s59 offen offset:2048 sc1
    s_waitcnt vmcnt(61)
    v_mfma_f32_32x32x16_bf16 v[112:127], a[20:23], v[80:83], v[112:127]
    s_add_u32 s59, s58, 20480
    buffer_load_dwordx4 a[20:23], v63, s[48:51], s59 offen offset:3072 sc1
    s_waitcnt vmcnt(61)
    v_mfma_f32_32x32x16_bf16 v[128:143], a[24:27], v[80:83], v[128:143]
    s_add_u32 s59, s58, 45056
    buffer_load_dwordx4 a[24:27], v63, s[48:51], s59 offen offset:3072 sc1
    ds_read_b128 v[80:83], v58 offset:2048
    s_waitcnt lgkmcnt(7)
    s_waitcnt vmcnt(61)
    v_mfma_f32_32x32x16_bf16 v[96:111], a[28:31], v[84:87], v[96:111]
    s_add_u32 s59, s58, 69632
    buffer_load_dwordx4 a[28:31], v63, s[48:51], s59 offen offset:3072 sc1
    s_waitcnt vmcnt(61)
    v_mfma_f32_32x32x16_bf16 v[112:127], a[32:35], v[84:87], v[112:127]
    s_waitcnt vmcnt(60)
    v_mfma_f32_32x32x16_bf16 v[128:143], a[36:39], v[84:87], v[128:143]
    ds_read_b128 v[84:87], v58 offset:3072
    s_waitcnt lgkmcnt(7)
    s_waitcnt vmcnt(59)
    v_mfma_f32_32x32x16_bf16 v[96:111], a[40:43], v[88:91], v[96:111]
    s_waitcnt vmcnt(58)
    v_mfma_f32_32x32x16_bf16 v[112:127], a[44:47], v[88:91], v[112:127]
    s_waitcnt vmcnt(57)
    v_mfma_f32_32x32x16_bf16 v[128:143], a[48:51], v[88:91], v[128:143]
    ds_read_b128 v[88:91], v59 offset:2048
    s_waitcnt lgkmcnt(7)
    s_waitcnt vmcnt(56)
    v_mfma_f32_32x32x16_bf16 v[96:111], a[52:55], v[92:95], v[96:111]
    s_waitcnt vmcnt(55)
    v_mfma_f32_32x32x16_bf16 v[112:127], a[56:59], v[92:95], v[112:127]
    s_waitcnt vmcnt(54)
    v_mfma_f32_32x32x16_bf16 v[128:143], a[60:63], v[92:95], v[128:143]
    ds_read_b128 v[92:95], v59 offset:3072
    s_waitcnt lgkmcnt(7)
    s_waitcnt vmcnt(53)
    v_mfma_f32_32x32x16_bf16 v[96:111], a[64:67], v[64:67], v[96:111]
    s_waitcnt vmcnt(52)
    v_mfma_f32_32x32x16_bf16 v[112:127], a[68:71], v[64:67], v[112:127]
    s_waitcnt vmcnt(51)
    v_mfma_f32_32x32x16_bf16 v[128:143], a[72:75], v[64:67], v[128:143]
    ds_read_b128 v[64:67], v56 offset:4096
    s_waitcnt lgkmcnt(7)
    s_waitcnt vmcnt(50)
    v_mfma_f32_32x32x16_bf16 v[96:111], a[76:79], v[68:71], v[96:111]
    s_waitcnt vmcnt(49)
    v_mfma_f32_32x32x16_bf16 v[112:127], a[80:83], v[68:71], v[112:127]
    s_waitcnt vmcnt(48)
    v_mfma_f32_32x32x16_bf16 v[128:143], a[84:87], v[68:71], v[128:143]
    ds_read_b128 v[68:71], v56 offset:5120
    s_waitcnt lgkmcnt(7)
    s_waitcnt vmcnt(47)
    v_mfma_f32_32x32x16_bf16 v[96:111], a[88:91], v[72:75], v[96:111]
    s_waitcnt vmcnt(46)
    v_mfma_f32_32x32x16_bf16 v[112:127], a[92:95], v[72:75], v[112:127]
    s_waitcnt vmcnt(45)
    v_mfma_f32_32x32x16_bf16 v[128:143], a[96:99], v[72:75], v[128:143]
    ds_read_b128 v[72:75], v57 offset:4096
    s_waitcnt lgkmcnt(7)
    s_waitcnt vmcnt(44)
    v_mfma_f32_32x32x16_bf16 v[96:111], a[100:103], v[76:79], v[96:111]
    s_waitcnt vmcnt(43)
    v_mfma_f32_32x32x16_bf16 v[112:127], a[104:107], v[76:79], v[112:127]
    s_waitcnt vmcnt(42)
    v_mfma_f32_32x32x16_bf16 v[128:143], a[108:111], v[76:79], v[128:143]
    ds_read_b128 v[76:79], v57 offset:5120
    s_waitcnt lgkmcnt(7)
    s_waitcnt vmcnt(41)
    v_mfma_f32_32x32x16_bf16 v[96:111], a[112:115], v[80:83], v[96:111]
    s_waitcnt vmcnt(40)
    v_mfma_f32_32x32x16_bf16 v[112:127], a[116:119], v[80:83], v[112:127]
    s_waitcnt vmcnt(39)
    v_mfma_f32_32x32x16_bf16 v[128:143], a[120:123], v[80:83], v[128:143]
    ds_read_b128 v[80:83], v58 offset:4096
    s_waitcnt lgkmcnt(7)
    s_waitcnt vmcnt(38)
    v_mfma_f32_32x32x16_bf16 v[96:111], a[124:127], v[84:87], v[96:111]
    s_waitcnt vmcnt(37)
    v_mfma_f32_32x32x16_bf16 v[112:127], a[128:131], v[84:87], v[112:127]
    s_waitcnt vmcnt(36)
    v_mfma_f32_32x32x16_bf16 v[128:143], a[132:135], v[84:87], v[128:143]
    ds_read_b128 v[84:87], v58 offset:5120
    s_waitcnt lgkmcnt(7)
    s_waitcnt vmcnt(35)
    v_mfma_f32_32x32x16_bf16 v[96:111], a[136:139], v[88:91], v[96:111]
    s_waitcnt vmcnt(34)
    v_mfma_f32_32x32x16_bf16 v[112:127], a[140:143], v[88:91], v[112:127]
    s_waitcnt vmcnt(33)
    v_mfma_f32_32x32x16_bf16 v[128:143], a[144:147], v[88:91], v[128:143]
    ds_read_b128 v[88:91], v59 offset:4096
    s_waitcnt lgkmcnt(7)
    s_waitcnt vmcnt(32)
    v_mfma_f32_32x32x16_bf16 v[96:111], a[148:151], v[92:95], v[96:111]
    s_waitcnt vmcnt(31)
    v_mfma_f32_32x32x16_bf16 v[112:127], a[152:155], v[92:95], v[112:127]
    s_waitcnt vmcnt(30)
    v_mfma_f32_32x32x16_bf16 v[128:143], a[156:159], v[92:95], v[128:143]
    ds_read_b128 v[92:95], v59 offset:5120
    s_waitcnt lgkmcnt(7)
    s_waitcnt vmcnt(29)
    v_mfma_f32_32x32x16_bf16 v[96:111], a[160:163], v[64:67], v[96:111]
    s_waitcnt vmcnt(28)
    v_mfma_f32_32x32x16_bf16 v[112:127], a[164:167], v[64:67], v[112:127]
    s_waitcnt vmcnt(27)
    v_mfma_f32_32x32x16_bf16 v[128:143], a[168:171], v[64:67], v[128:143]
    s_waitcnt lgkmcnt(6)
    s_waitcnt vmcnt(26)
    v_mfma_f32_32x32x16_bf16 v[96:111], a[172:175], v[68:71], v[96:111]
    s_waitcnt vmcnt(25)
    v_mfma_f32_32x32x16_bf16 v[112:127], a[176:179], v[68:71], v[112:127]
    s_waitcnt vmcnt(24)
    v_mfma_f32_32x32x16_bf16 v[128:143], a[180:183], v[68:71], v[128:143]
    s_waitcnt lgkmcnt(5)
    s_waitcnt vmcnt(23)
    v_mfma_f32_32x32x16_bf16 v[96:111], a[184:187], v[72:75], v[96:111]
    s_waitcnt vmcnt(22)
    v_mfma_f32_32x32x16_bf16 v[112:127], a[188:191], v[72:75], v[112:127]
    s_waitcnt vmcnt(15)
    v_mfma_f32_32x32x16_bf16 v[128:143], a[224:227], v[72:75], v[128:143]
    s_waitcnt lgkmcnt(4)
    s_waitcnt vmcnt(14)
    v_mfma_f32_32x32x16_bf16 v[96:111], a[228:231], v[76:79], v[96:111]
    s_waitcnt vmcnt(13)
    v_mfma_f32_32x32x16_bf16 v[112:127], a[232:235], v[76:79], v[112:127]
    s_waitcnt vmcnt(12)
    v_mfma_f32_32x32x16_bf16 v[128:143], a[236:239], v[76:79], v[128:143]
    s_waitcnt lgkmcnt(3)
    s_waitcnt vmcnt(11)
    v_mfma_f32_32x32x16_bf16 v[96:111], a[240:243], v[80:83], v[96:111]
    s_waitcnt vmcnt(10)
    v_mfma_f32_32x32x16_bf16 v[112:127], a[244:247], v[80:83], v[112:127]
    s_waitcnt vmcnt(9)
    v_mfma_f32_32x32x16_bf16 v[128:143], a[248:251], v[80:83], v[128:143]
    s_waitcnt lgkmcnt(2)
    s_waitcnt vmcnt(8)
    v_mfma_f32_32x32x16_bf16 v[96:111], a[252:255], v[84:87], v[96:111]
    s_waitcnt vmcnt(7)
    v_mfma_f32_32x32x16_bf16 v[112:127], a[0:3], v[84:87], v[112:127]
    s_waitcnt vmcnt(6)
    v_mfma_f32_32x32x16_bf16 v[128:143], a[4:7], v[84:87], v[128:143]
    s_waitcnt lgkmcnt(1)
    s_waitcnt vmcnt(5)
    v_mfma_f32_32x32x16_bf16 v[96:111], a[8:11], v[88:91], v[96:111]
    s_waitcnt vmcnt(4)
    v_mfma_f32_32x32x16_bf16 v[112:127], a[12:15], v[88:91], v[112:127]
    s_waitcnt vmcnt(3)
    v_mfma_f32_32x32x16_bf16 v[128:143], a[16:19], v[88:91], v[128:143]
    s_waitcnt lgkmcnt(0)
    s_waitcnt vmcnt(2)
    v_mfma_f32_32x32x16_bf16 v[96:111], a[20:23], v[92:95], v[96:111]
    s_waitcnt vmcnt(1)
    v_mfma_f32_32x32x16_bf16 v[112:127], a[24:27], v[92:95], v[112:127]
    s_waitcnt vmcnt(0)
    v_mfma_f32_32x32x16_bf16 v[128:143], a[28:31], v[92:95], v[128:143]
    s_nop 15
    v_mul_u32_u24 v7, 784, v2
    s_mul_i32 s60, s3, 192
    s_add_u32 s60, s60, 8192
    v_lshl_add_u32 v7, v3, 3, v7
    v_add_u32 v7, s60, v7
    v_cvt_pk_bf16_f32 v64, v96, v97
    v_cvt_pk_bf16_f32 v65, v98, v99
    v_cvt_pk_bf16_f32 v66, v100, v101
    v_cvt_pk_bf16_f32 v67, v102, v103
    v_cvt_pk_bf16_f32 v68, v104, v105
    v_cvt_pk_bf16_f32 v69, v106, v107
    v_cvt_pk_bf16_f32 v70, v108, v109
    v_cvt_pk_bf16_f32 v71, v110, v111
    v_cvt_pk_bf16_f32 v72, v112, v113
    v_cvt_pk_bf16_f32 v73, v114, v115
    v_cvt_pk_bf16_f32 v74, v116, v117
    v_cvt_pk_bf16_f32 v75, v118, v119
    v_cvt_pk_bf16_f32 v76, v120, v121
    v_cvt_pk_bf16_f32 v77, v122, v123
    v_cvt_pk_bf16_f32 v78, v124, v125
    v_cvt_pk_bf16_f32 v79, v126, v127
    v_cvt_pk_bf16_f32 v80, v128, v129
    v_cvt_pk_bf16_f32 v81, v130, v131
    v_cvt_pk_bf16_f32 v82, v132, v133
    v_cvt_pk_bf16_f32 v83, v134, v135
    v_cvt_pk_bf16_f32 v84, v136, v137
    v_cvt_pk_bf16_f32 v85, v138, v139
    v_cvt_pk_bf16_f32 v86, v140, v141
    v_cvt_pk_bf16_f32 v87, v142, v143
    ds_write_b64 v7, v[64:65] offset:0
    ds_write_b64 v7, v[66:67] offset:16
    ds_write_b64 v7, v[68:69] offset:32
    ds_write_b64 v7, v[70:71] offset:48
    ds_write_b64 v7, v[72:73] offset:64
    ds_write_b64 v7, v[74:75] offset:80
    ds_write_b64 v7, v[76:77] offset:96
    ds_write_b64 v7, v[78:79] offset:112
    ds_write_b64 v7, v[80:81] offset:128
    ds_write_b64 v7, v[82:83] offset:144
    ds_write_b64 v7, v[84:85] offset:160
    ds_write_b64 v7, v[86:87] offset:176
    v_mul_u32_u24 v8, 784, v4
    v_lshl_add_u32 v8, v5, 4, v8
    s_waitcnt lgkmcnt(0)
    s_barrier
    ds_read_b128 v[96:99], v8 offset:8192
    ds_read_b128 v[100:103], v8 offset:8320
    ds_read_b128 v[104:107], v8 offset:8448
    ds_read_b128 v[108:111], v8 offset:8576
    ds_read_b128 v[112:115], v8 offset:8704
    ds_read_b128 v[116:119], v8 offset:8832
    s_mov_b32 s60, 0xffff0000
    s_waitcnt vmcnt(16)
    s_waitcnt lgkmcnt(0)
    v_lshlrev_b32 v64, 16, v96
    v_and_b32 v65, s60, v96
    v_lshlrev_b32 v66, 16, v160
    v_and_b32 v67, s60, v160
    v_add_f32 v64, v64, v66
    v_add_f32 v65, v65, v67
    v_cvt_pk_bf16_f32 v128, v64, v65
    v_lshlrev_b32 v64, 16, v97
    v_and_b32 v65, s60, v97
    v_lshlrev_b32 v66, 16, v161
    v_and_b32 v67, s60, v161
    v_add_f32 v64, v64, v66
    v_add_f32 v65, v65, v67
    v_cvt_pk_bf16_f32 v129, v64, v65
    v_lshlrev_b32 v64, 16, v98
    v_and_b32 v65, s60, v98
    v_lshlrev_b32 v66, 16, v162
    v_and_b32 v67, s60, v162
    v_add_f32 v64, v64, v66
    v_add_f32 v65, v65, v67
    v_cvt_pk_bf16_f32 v130, v64, v65
    v_lshlrev_b32 v64, 16, v99
    v_and_b32 v65, s60, v99
    v_lshlrev_b32 v66, 16, v163
    v_and_b32 v67, s60, v163
    v_add_f32 v64, v64, v66
    v_add_f32 v65, v65, v67
    v_cvt_pk_bf16_f32 v131, v64, v65
    v_lshlrev_b32 v64, 16, v100
    v_and_b32 v65, s60, v100
    v_lshlrev_b32 v66, 16, v164
    v_and_b32 v67, s60, v164
    v_add_f32 v64, v64, v66
    v_add_f32 v65, v65, v67
    v_cvt_pk_bf16_f32 v132, v64, v65
    v_lshlrev_b32 v64, 16, v101
    v_and_b32 v65, s60, v101
    v_lshlrev_b32 v66, 16, v165
    v_and_b32 v67, s60, v165
    v_add_f32 v64, v64, v66
    v_add_f32 v65, v65, v67
    v_cvt_pk_bf16_f32 v133, v64, v65
    v_lshlrev_b32 v64, 16, v102
    v_and_b32 v65, s60, v102
    v_lshlrev_b32 v66, 16, v166
    v_and_b32 v67, s60, v166
    v_add_f32 v64, v64, v66
    v_add_f32 v65, v65, v67
    v_cvt_pk_bf16_f32 v134, v64, v65
    v_lshlrev_b32 v64, 16, v103
    v_and_b32 v65, s60, v103
    v_lshlrev_b32 v66, 16, v167
    v_and_b32 v67, s60, v167
    v_add_f32 v64, v64, v66
    v_add_f32 v65, v65, v67
    v_cvt_pk_bf16_f32 v135, v64, v65
    v_lshlrev_b32 v64, 16, v104
    v_and_b32 v65, s60, v104
    v_lshlrev_b32 v66, 16, v168
    v_and_b32 v67, s60, v168
    v_add_f32 v64, v64, v66
    v_add_f32 v65, v65, v67
    v_cvt_pk_bf16_f32 v136, v64, v65
    v_lshlrev_b32 v64, 16, v105
    v_and_b32 v65, s60, v105
    v_lshlrev_b32 v66, 16, v169
    v_and_b32 v67, s60, v169
    v_add_f32 v64, v64, v66
    v_add_f32 v65, v65, v67
    v_cvt_pk_bf16_f32 v137, v64, v65
    v_lshlrev_b32 v64, 16, v106
    v_and_b32 v65, s60, v106
    v_lshlrev_b32 v66, 16, v170
    v_and_b32 v67, s60, v170
    v_add_f32 v64, v64, v66
    v_add_f32 v65, v65, v67
    v_cvt_pk_bf16_f32 v138, v64, v65
    v_lshlrev_b32 v64, 16, v107
    v_and_b32 v65, s60, v107
    v_lshlrev_b32 v66, 16, v171
    v_and_b32 v67, s60, v171
    v_add_f32 v64, v64, v66
    v_add_f32 v65, v65, v67
    v_cvt_pk_bf16_f32 v139, v64, v65
    v_lshlrev_b32 v64, 16, v108
    v_and_b32 v65, s60, v108
    v_lshlrev_b32 v66, 16, v172
    v_and_b32 v67, s60, v172
    v_add_f32 v64, v64, v66
    v_add_f32 v65, v65, v67
    v_cvt_pk_bf16_f32 v140, v64, v65
    v_lshlrev_b32 v64, 16, v109
    v_and_b32 v65, s60, v109
    v_lshlrev_b32 v66, 16, v173
    v_and_b32 v67, s60, v173
    v_add_f32 v64, v64, v66
    v_add_f32 v65, v65, v67
    v_cvt_pk_bf16_f32 v141, v64, v65
    v_lshlrev_b32 v64, 16, v110
    v_and_b32 v65, s60, v110
    v_lshlrev_b32 v66, 16, v174
    v_and_b32 v67, s60, v174
    v_add_f32 v64, v64, v66
    v_add_f32 v65, v65, v67
    v_cvt_pk_bf16_f32 v142, v64, v65
    v_lshlrev_b32 v64, 16, v111
    v_and_b32 v65, s60, v111
    v_lshlrev_b32 v66, 16, v175
    v_and_b32 v67, s60, v175
    v_add_f32 v64, v64, v66
    v_add_f32 v65, v65, v67
    v_cvt_pk_bf16_f32 v143, v64, v65
    v_lshlrev_b32 v64, 16, v112
    v_and_b32 v65, s60, v112
    v_lshlrev_b32 v66, 16, v176
    v_and_b32 v67, s60, v176
    v_add_f32 v64, v64, v66
    v_add_f32 v65, v65, v67
    v_cvt_pk_bf16_f32 v144, v64, v65
    v_lshlrev_b32 v64, 16, v113
    v_and_b32 v65, s60, v113
    v_lshlrev_b32 v66, 16, v177
    v_and_b32 v67, s60, v177
    v_add_f32 v64, v64, v66
    v_add_f32 v65, v65, v67
    v_cvt_pk_bf16_f32 v145, v64, v65
    v_lshlrev_b32 v64, 16, v114
    v_and_b32 v65, s60, v114
    v_lshlrev_b32 v66, 16, v178
    v_and_b32 v67, s60, v178
    v_add_f32 v64, v64, v66
    v_add_f32 v65, v65, v67
    v_cvt_pk_bf16_f32 v146, v64, v65
    v_lshlrev_b32 v64, 16, v115
    v_and_b32 v65, s60, v115
    v_lshlrev_b32 v66, 16, v179
    v_and_b32 v67, s60, v179
    v_add_f32 v64, v64, v66
    v_add_f32 v65, v65, v67
    v_cvt_pk_bf16_f32 v147, v64, v65
    v_lshlrev_b32 v64, 16, v116
    v_and_b32 v65, s60, v116
    v_lshlrev_b32 v66, 16, v180
    v_and_b32 v67, s60, v180
    v_add_f32 v64, v64, v66
    v_add_f32 v65, v65, v67
    v_cvt_pk_bf16_f32 v148, v64, v65
    v_lshlrev_b32 v64, 16, v117
    v_and_b32 v65, s60, v117
    v_lshlrev_b32 v66, 16, v181
    v_and_b32 v67, s60, v181
    v_add_f32 v64, v64, v66
    v_add_f32 v65, v65, v67
    v_cvt_pk_bf16_f32 v149, v64, v65
    v_lshlrev_b32 v64, 16, v118
    v_and_b32 v65, s60, v118
    v_lshlrev_b32 v66, 16, v182
    v_and_b32 v67, s60, v182
    v_add_f32 v64, v64, v66
    v_add_f32 v65, v65, v67
    v_cvt_pk_bf16_f32 v150, v64, v65
    v_lshlrev_b32 v64, 16, v119
    v_and_b32 v65, s60, v119
    v_lshlrev_b32 v66, 16, v183
    v_and_b32 v67, s60, v183
    v_add_f32 v64, v64, v66
    v_add_f32 v65, v65, v67
    v_cvt_pk_bf16_f32 v151, v64, v65
    buffer_store_dwordx4 v[128:131], v6, s[44:47], 0 offen offset:0 sc1
    buffer_store_dwordx4 v[132:135], v6, s[44:47], 0 offen offset:128 sc1
    buffer_store_dwordx4 v[136:139], v6, s[44:47], 0 offen offset:256 sc1
    buffer_store_dwordx4 v[140:143], v6, s[44:47], 0 offen offset:384 sc1
    buffer_store_dwordx4 v[144:147], v6, s[44:47], 0 offen offset:512 sc1
    buffer_store_dwordx4 v[148:151], v6, s[44:47], 0 offen offset:640 sc1
L_fin:
standalone__video_timesformer__vision_kernel_end:
    s_endpgm
L2_mask0:
    s_lshl_b32 s60, s3, 5
    s_sub_u32 s60, 89, s60
    v_lshlrev_b32 v30, 2, v3
    v_mov_b32 v31, 0xff800000
    v_add_u32 v56, 0, v30
    v_cmp_gt_i32 vcc, s60, v56
    s_nop 1
    v_cndmask_b32 v32, v31, v32, vcc
    v_add_u32 v56, 1, v30
    v_cmp_gt_i32 vcc, s60, v56
    s_nop 1
    v_cndmask_b32 v33, v31, v33, vcc
    v_add_u32 v56, 2, v30
    v_cmp_gt_i32 vcc, s60, v56
    s_nop 1
    v_cndmask_b32 v34, v31, v34, vcc
    v_add_u32 v56, 3, v30
    v_cmp_gt_i32 vcc, s60, v56
    s_nop 1
    v_cndmask_b32 v35, v31, v35, vcc
    v_add_u32 v56, 8, v30
    v_cmp_gt_i32 vcc, s60, v56
    s_nop 1
    v_cndmask_b32 v36, v31, v36, vcc
    v_add_u32 v56, 9, v30
    v_cmp_gt_i32 vcc, s60, v56
    s_nop 1
    v_cndmask_b32 v37, v31, v37, vcc
    v_add_u32 v56, 10, v30
    v_cmp_gt_i32 vcc, s60, v56
    s_nop 1
    v_cndmask_b32 v38, v31, v38, vcc
    v_add_u32 v56, 11, v30
    v_cmp_gt_i32 vcc, s60, v56
    s_nop 1
    v_cndmask_b32 v39, v31, v39, vcc
    v_add_u32 v56, 16, v30
    v_cmp_gt_i32 vcc, s60, v56
    s_nop 1
    v_cndmask_b32 v40, v31, v40, vcc
    v_add_u32 v56, 17, v30
    v_cmp_gt_i32 vcc, s60, v56
    s_nop 1
    v_cndmask_b32 v41, v31, v41, vcc
    v_add_u32 v56, 18, v30
    v_cmp_gt_i32 vcc, s60, v56
    s_nop 1
    v_cndmask_b32 v42, v31, v42, vcc
    v_add_u32 v56, 19, v30
    v_cmp_gt_i32 vcc, s60, v56
    s_nop 1
    v_cndmask_b32 v43, v31, v43, vcc
    v_add_u32 v56, 24, v30
    v_cmp_gt_i32 vcc, s60, v56
    s_nop 1
    v_cndmask_b32 v44, v31, v44, vcc
    v_add_u32 v56, 25, v30
    v_cmp_gt_i32 vcc, s60, v56
    s_nop 1
    v_cndmask_b32 v45, v31, v45, vcc
    v_add_u32 v56, 26, v30
    v_cmp_gt_i32 vcc, s60, v56
    s_nop 1
    v_cndmask_b32 v46, v31, v46, vcc
    v_add_u32 v56, 27, v30
    v_cmp_gt_i32 vcc, s60, v56
    s_nop 1
    v_cndmask_b32 v47, v31, v47, vcc
    s_branch L2_nomask0
L2_mask1:
    s_lshl_b32 s60, s3, 5
    s_sub_u32 s60, 89, s60
    v_lshlrev_b32 v30, 2, v3
    v_mov_b32 v31, 0xff800000
    v_add_u32 v56, 0, v30
    v_cmp_gt_i32 vcc, s60, v56
    s_nop 1
    v_cndmask_b32 v32, v31, v32, vcc
    v_add_u32 v56, 1, v30
    v_cmp_gt_i32 vcc, s60, v56
    s_nop 1
    v_cndmask_b32 v33, v31, v33, vcc
    v_add_u32 v56, 2, v30
    v_cmp_gt_i32 vcc, s60, v56
    s_nop 1
    v_cndmask_b32 v34, v31, v34, vcc
    v_add_u32 v56, 3, v30
    v_cmp_gt_i32 vcc, s60, v56
    s_nop 1
    v_cndmask_b32 v35, v31, v35, vcc
    v_add_u32 v56, 8, v30
    v_cmp_gt_i32 vcc, s60, v56
    s_nop 1
    v_cndmask_b32 v36, v31, v36, vcc
    v_add_u32 v56, 9, v30
    v_cmp_gt_i32 vcc, s60, v56
    s_nop 1
    v_cndmask_b32 v37, v31, v37, vcc
    v_add_u32 v56, 10, v30
    v_cmp_gt_i32 vcc, s60, v56
    s_nop 1
    v_cndmask_b32 v38, v31, v38, vcc
    v_add_u32 v56, 11, v30
    v_cmp_gt_i32 vcc, s60, v56
    s_nop 1
    v_cndmask_b32 v39, v31, v39, vcc
    v_add_u32 v56, 16, v30
    v_cmp_gt_i32 vcc, s60, v56
    s_nop 1
    v_cndmask_b32 v40, v31, v40, vcc
    v_add_u32 v56, 17, v30
    v_cmp_gt_i32 vcc, s60, v56
    s_nop 1
    v_cndmask_b32 v41, v31, v41, vcc
    v_add_u32 v56, 18, v30
    v_cmp_gt_i32 vcc, s60, v56
    s_nop 1
    v_cndmask_b32 v42, v31, v42, vcc
    v_add_u32 v56, 19, v30
    v_cmp_gt_i32 vcc, s60, v56
    s_nop 1
    v_cndmask_b32 v43, v31, v43, vcc
    v_add_u32 v56, 24, v30
    v_cmp_gt_i32 vcc, s60, v56
    s_nop 1
    v_cndmask_b32 v44, v31, v44, vcc
    v_add_u32 v56, 25, v30
    v_cmp_gt_i32 vcc, s60, v56
    s_nop 1
    v_cndmask_b32 v45, v31, v45, vcc
    v_add_u32 v56, 26, v30
    v_cmp_gt_i32 vcc, s60, v56
    s_nop 1
    v_cndmask_b32 v46, v31, v46, vcc
    v_add_u32 v56, 27, v30
    v_cmp_gt_i32 vcc, s60, v56
    s_nop 1
    v_cndmask_b32 v47, v31, v47, vcc
    s_branch L2_nomask1
L2_rs1:
    v_max_f32 v30, v30, v28
    v_sub_f32 v31, v28, v30
    v_exp_f32 v31, v31
    v_mov_b32 v28, v30
    s_nop 7
    v_mul_f32 v29, v29, v31
    v_mul_f32 v64, v64, v31
    v_mul_f32 v65, v65, v31
    v_mul_f32 v66, v66, v31
    v_mul_f32 v67, v67, v31
    v_mul_f32 v68, v68, v31
    v_mul_f32 v69, v69, v31
    v_mul_f32 v70, v70, v31
    v_mul_f32 v71, v71, v31
    v_mul_f32 v72, v72, v31
    v_mul_f32 v73, v73, v31
    v_mul_f32 v74, v74, v31
    v_mul_f32 v75, v75, v31
    v_mul_f32 v76, v76, v31
    v_mul_f32 v77, v77, v31
    v_mul_f32 v78, v78, v31
    v_mul_f32 v79, v79, v31
    v_mul_f32 v80, v80, v31
    v_mul_f32 v81, v81, v31
    v_mul_f32 v82, v82, v31
    v_mul_f32 v83, v83, v31
    v_mul_f32 v84, v84, v31
    v_mul_f32 v85, v85, v31
    v_mul_f32 v86, v86, v31
    v_mul_f32 v87, v87, v31
    v_mul_f32 v88, v88, v31
    v_mul_f32 v89, v89, v31
    v_mul_f32 v90, v90, v31
    v_mul_f32 v91, v91, v31
    v_mul_f32 v92, v92, v31
    v_mul_f32 v93, v93, v31
    v_mul_f32 v94, v94, v31
    v_mul_f32 v95, v95, v31
    v_mul_f32 v96, v96, v31
    v_mul_f32 v97, v97, v31
    v_mul_f32 v98, v98, v31
    v_mul_f32 v99, v99, v31
    v_mul_f32 v100, v100, v31
    v_mul_f32 v101, v101, v31
    v_mul_f32 v102, v102, v31
    v_mul_f32 v103, v103, v31
    v_mul_f32 v104, v104, v31
    v_mul_f32 v105, v105, v31
    v_mul_f32 v106, v106, v31
    v_mul_f32 v107, v107, v31
    v_mul_f32 v108, v108, v31
    v_mul_f32 v109, v109, v31
    v_mul_f32 v110, v110, v31
    v_mul_f32 v111, v111, v31
    v_mul_f32 v112, v112, v31
    v_mul_f32 v113, v113, v31
    v_mul_f32 v114, v114, v31
    v_mul_f32 v115, v115, v31
    v_mul_f32 v116, v116, v31
    v_mul_f32 v117, v117, v31
    v_mul_f32 v118, v118, v31
    v_mul_f32 v119, v119, v31
    v_mul_f32 v120, v120, v31
    v_mul_f32 v121, v121, v31
    v_mul_f32 v122, v122, v31
    v_mul_f32 v123, v123, v31
    v_mul_f32 v124, v124, v31
    v_mul_f32 v125, v125, v31
    v_mul_f32 v126, v126, v31
    v_mul_f32 v127, v127, v31
    v_mul_f32 v128, v128, v31
    v_mul_f32 v129, v129, v31
    v_mul_f32 v130, v130, v31
    v_mul_f32 v131, v131, v31
    v_mul_f32 v132, v132, v31
    v_mul_f32 v133, v133, v31
    v_mul_f32 v134, v134, v31
    v_mul_f32 v135, v135, v31
    v_mul_f32 v136, v136, v31
    v_mul_f32 v137, v137, v31
    v_mul_f32 v138, v138, v31
    v_mul_f32 v139, v139, v31
    v_mul_f32 v140, v140, v31
    v_mul_f32 v141, v141, v31
    v_mul_f32 v142, v142, v31
    v_mul_f32 v143, v143, v31
    v_mul_f32 v144, v144, v31
    v_mul_f32 v145, v145, v31
    v_mul_f32 v146, v146, v31
    v_mul_f32 v147, v147, v31
    v_mul_f32 v148, v148, v31
    v_mul_f32 v149, v149, v31
    v_mul_f32 v150, v150, v31
    v_mul_f32 v151, v151, v31
    v_mul_f32 v152, v152, v31
    v_mul_f32 v153, v153, v31
    v_mul_f32 v154, v154, v31
    v_mul_f32 v155, v155, v31
    v_mul_f32 v156, v156, v31
    v_mul_f32 v157, v157, v31
    v_mul_f32 v158, v158, v31
    v_mul_f32 v159, v159, v31
    v_mul_f32 v160, v160, v31
    v_mul_f32 v161, v161, v31
    v_mul_f32 v162, v162, v31
    v_mul_f32 v163, v163, v31
    v_mul_f32 v164, v164, v31
    v_mul_f32 v165, v165, v31
    v_mul_f32 v166, v166, v31
    v_mul_f32 v167, v167, v31
    v_mul_f32 v168, v168, v31
    v_mul_f32 v169, v169, v31
    v_mul_f32 v170, v170, v31
    v_mul_f32 v171, v171, v31
    v_mul_f32 v172, v172, v31
    v_mul_f32 v173, v173, v31
    v_mul_f32 v174, v174, v31
    v_mul_f32 v175, v175, v31
    v_mul_f32 v176, v176, v31
    v_mul_f32 v177, v177, v31
    v_mul_f32 v178, v178, v31
    v_mul_f32 v179, v179, v31
    v_mul_f32 v180, v180, v31
    v_mul_f32 v181, v181, v31
    v_mul_f32 v182, v182, v31
    v_mul_f32 v183, v183, v31
    v_mul_f32 v184, v184, v31
    v_mul_f32 v185, v185, v31
    v_mul_f32 v186, v186, v31
    v_mul_f32 v187, v187, v31
    v_mul_f32 v188, v188, v31
    v_mul_f32 v189, v189, v31
    v_mul_f32 v190, v190, v31
    v_mul_f32 v191, v191, v31
    v_mul_f32 v192, v192, v31
    v_mul_f32 v193, v193, v31
    v_mul_f32 v194, v194, v31
    v_mul_f32 v195, v195, v31
    v_mul_f32 v196, v196, v31
    v_mul_f32 v197, v197, v31
    v_mul_f32 v198, v198, v31
    v_mul_f32 v199, v199, v31
    v_mul_f32 v200, v200, v31
    v_mul_f32 v201, v201, v31
    v_mul_f32 v202, v202, v31
    v_mul_f32 v203, v203, v31
    v_mul_f32 v204, v204, v31
    v_mul_f32 v205, v205, v31
    v_mul_f32 v206, v206, v31
    v_mul_f32 v207, v207, v31
    v_mul_f32 v208, v208, v31
    v_mul_f32 v209, v209, v31
    v_mul_f32 v210, v210, v31
    v_mul_f32 v211, v211, v31
    v_mul_f32 v212, v212, v31
    v_mul_f32 v213, v213, v31
    v_mul_f32 v214, v214, v31
    v_mul_f32 v215, v215, v31
    v_mul_f32 v216, v216, v31
    v_mul_f32 v217, v217, v31
    v_mul_f32 v218, v218, v31
    v_mul_f32 v219, v219, v31
    v_mul_f32 v220, v220, v31
    v_mul_f32 v221, v221, v31
    v_mul_f32 v222, v222, v31
    v_mul_f32 v223, v223, v31
    v_mul_f32 v224, v224, v31
    v_mul_f32 v225, v225, v31
    v_mul_f32 v226, v226, v31
    v_mul_f32 v227, v227, v31
    v_mul_f32 v228, v228, v31
    v_mul_f32 v229, v229, v31
    v_mul_f32 v230, v230, v31
    v_mul_f32 v231, v231, v31
    v_mul_f32 v232, v232, v31
    v_mul_f32 v233, v233, v31
    v_mul_f32 v234, v234, v31
    v_mul_f32 v235, v235, v31
    v_mul_f32 v236, v236, v31
    v_mul_f32 v237, v237, v31
    v_mul_f32 v238, v238, v31
    v_mul_f32 v239, v239, v31
    v_mul_f32 v240, v240, v31
    v_mul_f32 v241, v241, v31
    v_mul_f32 v242, v242, v31
    v_mul_f32 v243, v243, v31
    v_mul_f32 v244, v244, v31
    v_mul_f32 v245, v245, v31
    v_mul_f32 v246, v246, v31
    v_mul_f32 v247, v247, v31
    v_mul_f32 v248, v248, v31
    v_mul_f32 v249, v249, v31
    v_mul_f32 v250, v250, v31
    v_mul_f32 v251, v251, v31
    v_mul_f32 v252, v252, v31
    v_mul_f32 v253, v253, v31
    v_mul_f32 v254, v254, v31
    v_mul_f32 v255, v255, v31
    s_nop 1
    s_branch L2_nors1
L2_mask2:
    s_lshl_b32 s60, s3, 5
    s_sub_u32 s60, 89, s60
    v_lshlrev_b32 v30, 2, v3
    v_mov_b32 v31, 0xff800000
    v_add_u32 v56, 0, v30
    v_cmp_gt_i32 vcc, s60, v56
    s_nop 1
    v_cndmask_b32 v32, v31, v32, vcc
    v_add_u32 v56, 1, v30
    v_cmp_gt_i32 vcc, s60, v56
    s_nop 1
    v_cndmask_b32 v33, v31, v33, vcc
    v_add_u32 v56, 2, v30
    v_cmp_gt_i32 vcc, s60, v56
    s_nop 1
    v_cndmask_b32 v34, v31, v34, vcc
    v_add_u32 v56, 3, v30
    v_cmp_gt_i32 vcc, s60, v56
    s_nop 1
    v_cndmask_b32 v35, v31, v35, vcc
    v_add_u32 v56, 8, v30
    v_cmp_gt_i32 vcc, s60, v56
    s_nop 1
    v_cndmask_b32 v36, v31, v36, vcc
    v_add_u32 v56, 9, v30
    v_cmp_gt_i32 vcc, s60, v56
    s_nop 1
    v_cndmask_b32 v37, v31, v37, vcc
    v_add_u32 v56, 10, v30
    v_cmp_gt_i32 vcc, s60, v56
    s_nop 1
    v_cndmask_b32 v38, v31, v38, vcc
    v_add_u32 v56, 11, v30
    v_cmp_gt_i32 vcc, s60, v56
    s_nop 1
    v_cndmask_b32 v39, v31, v39, vcc
    v_add_u32 v56, 16, v30
    v_cmp_gt_i32 vcc, s60, v56
    s_nop 1
    v_cndmask_b32 v40, v31, v40, vcc
    v_add_u32 v56, 17, v30
    v_cmp_gt_i32 vcc, s60, v56
    s_nop 1
    v_cndmask_b32 v41, v31, v41, vcc
    v_add_u32 v56, 18, v30
    v_cmp_gt_i32 vcc, s60, v56
    s_nop 1
    v_cndmask_b32 v42, v31, v42, vcc
    v_add_u32 v56, 19, v30
    v_cmp_gt_i32 vcc, s60, v56
    s_nop 1
    v_cndmask_b32 v43, v31, v43, vcc
    v_add_u32 v56, 24, v30
    v_cmp_gt_i32 vcc, s60, v56
    s_nop 1
    v_cndmask_b32 v44, v31, v44, vcc
    v_add_u32 v56, 25, v30
    v_cmp_gt_i32 vcc, s60, v56
    s_nop 1
    v_cndmask_b32 v45, v31, v45, vcc
    v_add_u32 v56, 26, v30
    v_cmp_gt_i32 vcc, s60, v56
    s_nop 1
    v_cndmask_b32 v46, v31, v46, vcc
    v_add_u32 v56, 27, v30
    v_cmp_gt_i32 vcc, s60, v56
    s_nop 1
    v_cndmask_b32 v47, v31, v47, vcc
    s_branch L2_nomask2
L2_rs2:
    v_max_f32 v30, v30, v28
    v_sub_f32 v31, v28, v30
    v_exp_f32 v31, v31
    v_mov_b32 v28, v30
    s_nop 7
    v_mul_f32 v29, v29, v31
    v_mul_f32 v64, v64, v31
    v_mul_f32 v65, v65, v31
    v_mul_f32 v66, v66, v31
    v_mul_f32 v67, v67, v31
    v_mul_f32 v68, v68, v31
    v_mul_f32 v69, v69, v31
    v_mul_f32 v70, v70, v31
    v_mul_f32 v71, v71, v31
    v_mul_f32 v72, v72, v31
    v_mul_f32 v73, v73, v31
    v_mul_f32 v74, v74, v31
    v_mul_f32 v75, v75, v31
    v_mul_f32 v76, v76, v31
    v_mul_f32 v77, v77, v31
    v_mul_f32 v78, v78, v31
    v_mul_f32 v79, v79, v31
    v_mul_f32 v80, v80, v31
    v_mul_f32 v81, v81, v31
    v_mul_f32 v82, v82, v31
    v_mul_f32 v83, v83, v31
    v_mul_f32 v84, v84, v31
    v_mul_f32 v85, v85, v31
    v_mul_f32 v86, v86, v31
    v_mul_f32 v87, v87, v31
    v_mul_f32 v88, v88, v31
    v_mul_f32 v89, v89, v31
    v_mul_f32 v90, v90, v31
    v_mul_f32 v91, v91, v31
    v_mul_f32 v92, v92, v31
    v_mul_f32 v93, v93, v31
    v_mul_f32 v94, v94, v31
    v_mul_f32 v95, v95, v31
    v_mul_f32 v96, v96, v31
    v_mul_f32 v97, v97, v31
    v_mul_f32 v98, v98, v31
    v_mul_f32 v99, v99, v31
    v_mul_f32 v100, v100, v31
    v_mul_f32 v101, v101, v31
    v_mul_f32 v102, v102, v31
    v_mul_f32 v103, v103, v31
    v_mul_f32 v104, v104, v31
    v_mul_f32 v105, v105, v31
    v_mul_f32 v106, v106, v31
    v_mul_f32 v107, v107, v31
    v_mul_f32 v108, v108, v31
    v_mul_f32 v109, v109, v31
    v_mul_f32 v110, v110, v31
    v_mul_f32 v111, v111, v31
    v_mul_f32 v112, v112, v31
    v_mul_f32 v113, v113, v31
    v_mul_f32 v114, v114, v31
    v_mul_f32 v115, v115, v31
    v_mul_f32 v116, v116, v31
    v_mul_f32 v117, v117, v31
    v_mul_f32 v118, v118, v31
    v_mul_f32 v119, v119, v31
    v_mul_f32 v120, v120, v31
    v_mul_f32 v121, v121, v31
    v_mul_f32 v122, v122, v31
    v_mul_f32 v123, v123, v31
    v_mul_f32 v124, v124, v31
    v_mul_f32 v125, v125, v31
    v_mul_f32 v126, v126, v31
    v_mul_f32 v127, v127, v31
    v_mul_f32 v128, v128, v31
    v_mul_f32 v129, v129, v31
    v_mul_f32 v130, v130, v31
    v_mul_f32 v131, v131, v31
    v_mul_f32 v132, v132, v31
    v_mul_f32 v133, v133, v31
    v_mul_f32 v134, v134, v31
    v_mul_f32 v135, v135, v31
    v_mul_f32 v136, v136, v31
    v_mul_f32 v137, v137, v31
    v_mul_f32 v138, v138, v31
    v_mul_f32 v139, v139, v31
    v_mul_f32 v140, v140, v31
    v_mul_f32 v141, v141, v31
    v_mul_f32 v142, v142, v31
    v_mul_f32 v143, v143, v31
    v_mul_f32 v144, v144, v31
    v_mul_f32 v145, v145, v31
    v_mul_f32 v146, v146, v31
    v_mul_f32 v147, v147, v31
    v_mul_f32 v148, v148, v31
    v_mul_f32 v149, v149, v31
    v_mul_f32 v150, v150, v31
    v_mul_f32 v151, v151, v31
    v_mul_f32 v152, v152, v31
    v_mul_f32 v153, v153, v31
    v_mul_f32 v154, v154, v31
    v_mul_f32 v155, v155, v31
    v_mul_f32 v156, v156, v31
    v_mul_f32 v157, v157, v31
    v_mul_f32 v158, v158, v31
    v_mul_f32 v159, v159, v31
    v_mul_f32 v160, v160, v31
    v_mul_f32 v161, v161, v31
    v_mul_f32 v162, v162, v31
    v_mul_f32 v163, v163, v31
    v_mul_f32 v164, v164, v31
    v_mul_f32 v165, v165, v31
    v_mul_f32 v166, v166, v31
    v_mul_f32 v167, v167, v31
    v_mul_f32 v168, v168, v31
    v_mul_f32 v169, v169, v31
    v_mul_f32 v170, v170, v31
    v_mul_f32 v171, v171, v31
    v_mul_f32 v172, v172, v31
    v_mul_f32 v173, v173, v31
    v_mul_f32 v174, v174, v31
    v_mul_f32 v175, v175, v31
    v_mul_f32 v176, v176, v31
    v_mul_f32 v177, v177, v31
    v_mul_f32 v178, v178, v31
    v_mul_f32 v179, v179, v31
    v_mul_f32 v180, v180, v31
    v_mul_f32 v181, v181, v31
    v_mul_f32 v182, v182, v31
    v_mul_f32 v183, v183, v31
    v_mul_f32 v184, v184, v31
    v_mul_f32 v185, v185, v31
    v_mul_f32 v186, v186, v31
    v_mul_f32 v187, v187, v31
    v_mul_f32 v188, v188, v31
    v_mul_f32 v189, v189, v31
    v_mul_f32 v190, v190, v31
    v_mul_f32 v191, v191, v31
    v_mul_f32 v192, v192, v31
    v_mul_f32 v193, v193, v31
    v_mul_f32 v194, v194, v31
    v_mul_f32 v195, v195, v31
    v_mul_f32 v196, v196, v31
    v_mul_f32 v197, v197, v31
    v_mul_f32 v198, v198, v31
    v_mul_f32 v199, v199, v31
    v_mul_f32 v200, v200, v31
    v_mul_f32 v201, v201, v31
    v_mul_f32 v202, v202, v31
    v_mul_f32 v203, v203, v31
    v_mul_f32 v204, v204, v31
    v_mul_f32 v205, v205, v31
    v_mul_f32 v206, v206, v31
    v_mul_f32 v207, v207, v31
    v_mul_f32 v208, v208, v31
    v_mul_f32 v209, v209, v31
    v_mul_f32 v210, v210, v31
    v_mul_f32 v211, v211, v31
    v_mul_f32 v212, v212, v31
    v_mul_f32 v213, v213, v31
    v_mul_f32 v214, v214, v31
    v_mul_f32 v215, v215, v31
    v_mul_f32 v216, v216, v31
    v_mul_f32 v217, v217, v31
    v_mul_f32 v218, v218, v31
    v_mul_f32 v219, v219, v31
    v_mul_f32 v220, v220, v31
    v_mul_f32 v221, v221, v31
    v_mul_f32 v222, v222, v31
    v_mul_f32 v223, v223, v31
    v_mul_f32 v224, v224, v31
    v_mul_f32 v225, v225, v31
    v_mul_f32 v226, v226, v31
    v_mul_f32 v227, v227, v31
    v_mul_f32 v228, v228, v31
    v_mul_f32 v229, v229, v31
    v_mul_f32 v230, v230, v31
    v_mul_f32 v231, v231, v31
    v_mul_f32 v232, v232, v31
    v_mul_f32 v233, v233, v31
    v_mul_f32 v234, v234, v31
    v_mul_f32 v235, v235, v31
    v_mul_f32 v236, v236, v31
    v_mul_f32 v237, v237, v31
    v_mul_f32 v238, v238, v31
    v_mul_f32 v239, v239, v31
    v_mul_f32 v240, v240, v31
    v_mul_f32 v241, v241, v31
    v_mul_f32 v242, v242, v31
    v_mul_f32 v243, v243, v31
    v_mul_f32 v244, v244, v31
    v_mul_f32 v245, v245, v31
    v_mul_f32 v246, v246, v31
    v_mul_f32 v247, v247, v31
    v_mul_f32 v248, v248, v31
    v_mul_f32 v249, v249, v31
    v_mul_f32 v250, v250, v31
    v_mul_f32 v251, v251, v31
    v_mul_f32 v252, v252, v31
    v_mul_f32 v253, v253, v31
    v_mul_f32 v254, v254, v31
    v_mul_f32 v255, v255, v31
    s_nop 1
    s_branch L2_nors2
L2_mask3:
    s_lshl_b32 s60, s3, 5
    s_sub_u32 s60, 89, s60
    v_lshlrev_b32 v30, 2, v3
    v_mov_b32 v31, 0xff800000
    v_add_u32 v56, 0, v30
    v_cmp_gt_i32 vcc, s60, v56
    s_nop 1
    v_cndmask_b32 v32, v31, v32, vcc
    v_add_u32 v56, 1, v30
    v_cmp_gt_i32 vcc, s60, v56
    s_nop 1
    v_cndmask_b32 v33, v31, v33, vcc
    v_add_u32 v56, 2, v30
    v_cmp_gt_i32 vcc, s60, v56
    s_nop 1
    v_cndmask_b32 v34, v31, v34, vcc
    v_add_u32 v56, 3, v30
    v_cmp_gt_i32 vcc, s60, v56
    s_nop 1
    v_cndmask_b32 v35, v31, v35, vcc
    v_add_u32 v56, 8, v30
    v_cmp_gt_i32 vcc, s60, v56
    s_nop 1
    v_cndmask_b32 v36, v31, v36, vcc
    v_add_u32 v56, 9, v30
    v_cmp_gt_i32 vcc, s60, v56
    s_nop 1
    v_cndmask_b32 v37, v31, v37, vcc
    v_add_u32 v56, 10, v30
    v_cmp_gt_i32 vcc, s60, v56
    s_nop 1
    v_cndmask_b32 v38, v31, v38, vcc
    v_add_u32 v56, 11, v30
    v_cmp_gt_i32 vcc, s60, v56
    s_nop 1
    v_cndmask_b32 v39, v31, v39, vcc
    v_add_u32 v56, 16, v30
    v_cmp_gt_i32 vcc, s60, v56
    s_nop 1
    v_cndmask_b32 v40, v31, v40, vcc
    v_add_u32 v56, 17, v30
    v_cmp_gt_i32 vcc, s60, v56
    s_nop 1
    v_cndmask_b32 v41, v31, v41, vcc
    v_add_u32 v56, 18, v30
    v_cmp_gt_i32 vcc, s60, v56
    s_nop 1
    v_cndmask_b32 v42, v31, v42, vcc
    v_add_u32 v56, 19, v30
    v_cmp_gt_i32 vcc, s60, v56
    s_nop 1
    v_cndmask_b32 v43, v31, v43, vcc
    v_add_u32 v56, 24, v30
    v_cmp_gt_i32 vcc, s60, v56
    s_nop 1
    v_cndmask_b32 v44, v31, v44, vcc
    v_add_u32 v56, 25, v30
    v_cmp_gt_i32 vcc, s60, v56
    s_nop 1
    v_cndmask_b32 v45, v31, v45, vcc
    v_add_u32 v56, 26, v30
    v_cmp_gt_i32 vcc, s60, v56
    s_nop 1
    v_cndmask_b32 v46, v31, v46, vcc
    v_add_u32 v56, 27, v30
    v_cmp_gt_i32 vcc, s60, v56
    s_nop 1
    v_cndmask_b32 v47, v31, v47, vcc
    s_branch L2_nomask3
L2_rs3:
    v_max_f32 v30, v30, v28
    v_sub_f32 v31, v28, v30
    v_exp_f32 v31, v31
    v_mov_b32 v28, v30
    s_nop 7
    v_mul_f32 v29, v29, v31
    v_mul_f32 v64, v64, v31
    v_mul_f32 v65, v65, v31
    v_mul_f32 v66, v66, v31
    v_mul_f32 v67, v67, v31
    v_mul_f32 v68, v68, v31
    v_mul_f32 v69, v69, v31
    v_mul_f32 v70, v70, v31
    v_mul_f32 v71, v71, v31
    v_mul_f32 v72, v72, v31
    v_mul_f32 v73, v73, v31
    v_mul_f32 v74, v74, v31
    v_mul_f32 v75, v75, v31
    v_mul_f32 v76, v76, v31
    v_mul_f32 v77, v77, v31
    v_mul_f32 v78, v78, v31
    v_mul_f32 v79, v79, v31
    v_mul_f32 v80, v80, v31
    v_mul_f32 v81, v81, v31
    v_mul_f32 v82, v82, v31
    v_mul_f32 v83, v83, v31
    v_mul_f32 v84, v84, v31
    v_mul_f32 v85, v85, v31
    v_mul_f32 v86, v86, v31
    v_mul_f32 v87, v87, v31
    v_mul_f32 v88, v88, v31
    v_mul_f32 v89, v89, v31
    v_mul_f32 v90, v90, v31
    v_mul_f32 v91, v91, v31
    v_mul_f32 v92, v92, v31
    v_mul_f32 v93, v93, v31
    v_mul_f32 v94, v94, v31
    v_mul_f32 v95, v95, v31
    v_mul_f32 v96, v96, v31
    v_mul_f32 v97, v97, v31
    v_mul_f32 v98, v98, v31
    v_mul_f32 v99, v99, v31
    v_mul_f32 v100, v100, v31
    v_mul_f32 v101, v101, v31
    v_mul_f32 v102, v102, v31
    v_mul_f32 v103, v103, v31
    v_mul_f32 v104, v104, v31
    v_mul_f32 v105, v105, v31
    v_mul_f32 v106, v106, v31
    v_mul_f32 v107, v107, v31
    v_mul_f32 v108, v108, v31
    v_mul_f32 v109, v109, v31
    v_mul_f32 v110, v110, v31
    v_mul_f32 v111, v111, v31
    v_mul_f32 v112, v112, v31
    v_mul_f32 v113, v113, v31
    v_mul_f32 v114, v114, v31
    v_mul_f32 v115, v115, v31
    v_mul_f32 v116, v116, v31
    v_mul_f32 v117, v117, v31
    v_mul_f32 v118, v118, v31
    v_mul_f32 v119, v119, v31
    v_mul_f32 v120, v120, v31
    v_mul_f32 v121, v121, v31
    v_mul_f32 v122, v122, v31
    v_mul_f32 v123, v123, v31
    v_mul_f32 v124, v124, v31
    v_mul_f32 v125, v125, v31
    v_mul_f32 v126, v126, v31
    v_mul_f32 v127, v127, v31
    v_mul_f32 v128, v128, v31
    v_mul_f32 v129, v129, v31
    v_mul_f32 v130, v130, v31
    v_mul_f32 v131, v131, v31
    v_mul_f32 v132, v132, v31
    v_mul_f32 v133, v133, v31
    v_mul_f32 v134, v134, v31
    v_mul_f32 v135, v135, v31
    v_mul_f32 v136, v136, v31
    v_mul_f32 v137, v137, v31
    v_mul_f32 v138, v138, v31
    v_mul_f32 v139, v139, v31
    v_mul_f32 v140, v140, v31
    v_mul_f32 v141, v141, v31
    v_mul_f32 v142, v142, v31
    v_mul_f32 v143, v143, v31
    v_mul_f32 v144, v144, v31
    v_mul_f32 v145, v145, v31
    v_mul_f32 v146, v146, v31
    v_mul_f32 v147, v147, v31
    v_mul_f32 v148, v148, v31
    v_mul_f32 v149, v149, v31
    v_mul_f32 v150, v150, v31
    v_mul_f32 v151, v151, v31
    v_mul_f32 v152, v152, v31
    v_mul_f32 v153, v153, v31
    v_mul_f32 v154, v154, v31
    v_mul_f32 v155, v155, v31
    v_mul_f32 v156, v156, v31
    v_mul_f32 v157, v157, v31
    v_mul_f32 v158, v158, v31
    v_mul_f32 v159, v159, v31
    v_mul_f32 v160, v160, v31
    v_mul_f32 v161, v161, v31
    v_mul_f32 v162, v162, v31
    v_mul_f32 v163, v163, v31
    v_mul_f32 v164, v164, v31
    v_mul_f32 v165, v165, v31
    v_mul_f32 v166, v166, v31
    v_mul_f32 v167, v167, v31
    v_mul_f32 v168, v168, v31
    v_mul_f32 v169, v169, v31
    v_mul_f32 v170, v170, v31
    v_mul_f32 v171, v171, v31
    v_mul_f32 v172, v172, v31
    v_mul_f32 v173, v173, v31
    v_mul_f32 v174, v174, v31
    v_mul_f32 v175, v175, v31
    v_mul_f32 v176, v176, v31
    v_mul_f32 v177, v177, v31
    v_mul_f32 v178, v178, v31
    v_mul_f32 v179, v179, v31
    v_mul_f32 v180, v180, v31
    v_mul_f32 v181, v181, v31
    v_mul_f32 v182, v182, v31
    v_mul_f32 v183, v183, v31
    v_mul_f32 v184, v184, v31
    v_mul_f32 v185, v185, v31
    v_mul_f32 v186, v186, v31
    v_mul_f32 v187, v187, v31
    v_mul_f32 v188, v188, v31
    v_mul_f32 v189, v189, v31
    v_mul_f32 v190, v190, v31
    v_mul_f32 v191, v191, v31
    v_mul_f32 v192, v192, v31
    v_mul_f32 v193, v193, v31
    v_mul_f32 v194, v194, v31
    v_mul_f32 v195, v195, v31
    v_mul_f32 v196, v196, v31
    v_mul_f32 v197, v197, v31
    v_mul_f32 v198, v198, v31
    v_mul_f32 v199, v199, v31
    v_mul_f32 v200, v200, v31
    v_mul_f32 v201, v201, v31
    v_mul_f32 v202, v202, v31
    v_mul_f32 v203, v203, v31
    v_mul_f32 v204, v204, v31
    v_mul_f32 v205, v205, v31
    v_mul_f32 v206, v206, v31
    v_mul_f32 v207, v207, v31
    v_mul_f32 v208, v208, v31
    v_mul_f32 v209, v209, v31
    v_mul_f32 v210, v210, v31
    v_mul_f32 v211, v211, v31
    v_mul_f32 v212, v212, v31
    v_mul_f32 v213, v213, v31
    v_mul_f32 v214, v214, v31
    v_mul_f32 v215, v215, v31
    v_mul_f32 v216, v216, v31
    v_mul_f32 v217, v217, v31
    v_mul_f32 v218, v218, v31
    v_mul_f32 v219, v219, v31
    v_mul_f32 v220, v220, v31
    v_mul_f32 v221, v221, v31
    v_mul_f32 v222, v222, v31
    v_mul_f32 v223, v223, v31
    v_mul_f32 v224, v224, v31
    v_mul_f32 v225, v225, v31
    v_mul_f32 v226, v226, v31
    v_mul_f32 v227, v227, v31
    v_mul_f32 v228, v228, v31
    v_mul_f32 v229, v229, v31
    v_mul_f32 v230, v230, v31
    v_mul_f32 v231, v231, v31
    v_mul_f32 v232, v232, v31
    v_mul_f32 v233, v233, v31
    v_mul_f32 v234, v234, v31
    v_mul_f32 v235, v235, v31
    v_mul_f32 v236, v236, v31
    v_mul_f32 v237, v237, v31
    v_mul_f32 v238, v238, v31
    v_mul_f32 v239, v239, v31
    v_mul_f32 v240, v240, v31
    v_mul_f32 v241, v241, v31
    v_mul_f32 v242, v242, v31
    v_mul_f32 v243, v243, v31
    v_mul_f32 v244, v244, v31
    v_mul_f32 v245, v245, v31
    v_mul_f32 v246, v246, v31
    v_mul_f32 v247, v247, v31
    v_mul_f32 v248, v248, v31
    v_mul_f32 v249, v249, v31
    v_mul_f32 v250, v250, v31
    v_mul_f32 v251, v251, v31
    v_mul_f32 v252, v252, v31
    v_mul_f32 v253, v253, v31
    v_mul_f32 v254, v254, v31
    v_mul_f32 v255, v255, v31
    s_nop 1
    s_branch L2_nors3
L2_mask4:
    s_lshl_b32 s60, s3, 5
    s_sub_u32 s60, 89, s60
    v_lshlrev_b32 v30, 2, v3
    v_mov_b32 v31, 0xff800000
    v_add_u32 v56, 0, v30
    v_cmp_gt_i32 vcc, s60, v56
    s_nop 1
    v_cndmask_b32 v32, v31, v32, vcc
    v_add_u32 v56, 1, v30
    v_cmp_gt_i32 vcc, s60, v56
    s_nop 1
    v_cndmask_b32 v33, v31, v33, vcc
    v_add_u32 v56, 2, v30
    v_cmp_gt_i32 vcc, s60, v56
    s_nop 1
    v_cndmask_b32 v34, v31, v34, vcc
    v_add_u32 v56, 3, v30
    v_cmp_gt_i32 vcc, s60, v56
    s_nop 1
    v_cndmask_b32 v35, v31, v35, vcc
    v_add_u32 v56, 8, v30
    v_cmp_gt_i32 vcc, s60, v56
    s_nop 1
    v_cndmask_b32 v36, v31, v36, vcc
    v_add_u32 v56, 9, v30
    v_cmp_gt_i32 vcc, s60, v56
    s_nop 1
    v_cndmask_b32 v37, v31, v37, vcc
    v_add_u32 v56, 10, v30
    v_cmp_gt_i32 vcc, s60, v56
    s_nop 1
    v_cndmask_b32 v38, v31, v38, vcc
    v_add_u32 v56, 11, v30
    v_cmp_gt_i32 vcc, s60, v56
    s_nop 1
    v_cndmask_b32 v39, v31, v39, vcc
    v_add_u32 v56, 16, v30
    v_cmp_gt_i32 vcc, s60, v56
    s_nop 1
    v_cndmask_b32 v40, v31, v40, vcc
    v_add_u32 v56, 17, v30
    v_cmp_gt_i32 vcc, s60, v56
    s_nop 1
    v_cndmask_b32 v41, v31, v41, vcc
    v_add_u32 v56, 18, v30
    v_cmp_gt_i32 vcc, s60, v56
    s_nop 1
    v_cndmask_b32 v42, v31, v42, vcc
    v_add_u32 v56, 19, v30
    v_cmp_gt_i32 vcc, s60, v56
    s_nop 1
    v_cndmask_b32 v43, v31, v43, vcc
    v_add_u32 v56, 24, v30
    v_cmp_gt_i32 vcc, s60, v56
    s_nop 1
    v_cndmask_b32 v44, v31, v44, vcc
    v_add_u32 v56, 25, v30
    v_cmp_gt_i32 vcc, s60, v56
    s_nop 1
    v_cndmask_b32 v45, v31, v45, vcc
    v_add_u32 v56, 26, v30
    v_cmp_gt_i32 vcc, s60, v56
    s_nop 1
    v_cndmask_b32 v46, v31, v46, vcc
    v_add_u32 v56, 27, v30
    v_cmp_gt_i32 vcc, s60, v56
    s_nop 1
    v_cndmask_b32 v47, v31, v47, vcc
    s_branch L2_nomask4
L2_rs4:
    v_max_f32 v30, v30, v28
    v_sub_f32 v31, v28, v30
    v_exp_f32 v31, v31
    v_mov_b32 v28, v30
    s_nop 7
    v_mul_f32 v29, v29, v31
    v_mul_f32 v64, v64, v31
    v_mul_f32 v65, v65, v31
    v_mul_f32 v66, v66, v31
    v_mul_f32 v67, v67, v31
    v_mul_f32 v68, v68, v31
    v_mul_f32 v69, v69, v31
    v_mul_f32 v70, v70, v31
    v_mul_f32 v71, v71, v31
    v_mul_f32 v72, v72, v31
    v_mul_f32 v73, v73, v31
    v_mul_f32 v74, v74, v31
    v_mul_f32 v75, v75, v31
    v_mul_f32 v76, v76, v31
    v_mul_f32 v77, v77, v31
    v_mul_f32 v78, v78, v31
    v_mul_f32 v79, v79, v31
    v_mul_f32 v80, v80, v31
    v_mul_f32 v81, v81, v31
    v_mul_f32 v82, v82, v31
    v_mul_f32 v83, v83, v31
    v_mul_f32 v84, v84, v31
    v_mul_f32 v85, v85, v31
    v_mul_f32 v86, v86, v31
    v_mul_f32 v87, v87, v31
    v_mul_f32 v88, v88, v31
    v_mul_f32 v89, v89, v31
    v_mul_f32 v90, v90, v31
    v_mul_f32 v91, v91, v31
    v_mul_f32 v92, v92, v31
    v_mul_f32 v93, v93, v31
    v_mul_f32 v94, v94, v31
    v_mul_f32 v95, v95, v31
    v_mul_f32 v96, v96, v31
    v_mul_f32 v97, v97, v31
    v_mul_f32 v98, v98, v31
    v_mul_f32 v99, v99, v31
    v_mul_f32 v100, v100, v31
    v_mul_f32 v101, v101, v31
    v_mul_f32 v102, v102, v31
    v_mul_f32 v103, v103, v31
    v_mul_f32 v104, v104, v31
    v_mul_f32 v105, v105, v31
    v_mul_f32 v106, v106, v31
    v_mul_f32 v107, v107, v31
    v_mul_f32 v108, v108, v31
    v_mul_f32 v109, v109, v31
    v_mul_f32 v110, v110, v31
    v_mul_f32 v111, v111, v31
    v_mul_f32 v112, v112, v31
    v_mul_f32 v113, v113, v31
    v_mul_f32 v114, v114, v31
    v_mul_f32 v115, v115, v31
    v_mul_f32 v116, v116, v31
    v_mul_f32 v117, v117, v31
    v_mul_f32 v118, v118, v31
    v_mul_f32 v119, v119, v31
    v_mul_f32 v120, v120, v31
    v_mul_f32 v121, v121, v31
    v_mul_f32 v122, v122, v31
    v_mul_f32 v123, v123, v31
    v_mul_f32 v124, v124, v31
    v_mul_f32 v125, v125, v31
    v_mul_f32 v126, v126, v31
    v_mul_f32 v127, v127, v31
    v_mul_f32 v128, v128, v31
    v_mul_f32 v129, v129, v31
    v_mul_f32 v130, v130, v31
    v_mul_f32 v131, v131, v31
    v_mul_f32 v132, v132, v31
    v_mul_f32 v133, v133, v31
    v_mul_f32 v134, v134, v31
    v_mul_f32 v135, v135, v31
    v_mul_f32 v136, v136, v31
    v_mul_f32 v137, v137, v31
    v_mul_f32 v138, v138, v31
    v_mul_f32 v139, v139, v31
    v_mul_f32 v140, v140, v31
    v_mul_f32 v141, v141, v31
    v_mul_f32 v142, v142, v31
    v_mul_f32 v143, v143, v31
    v_mul_f32 v144, v144, v31
    v_mul_f32 v145, v145, v31
    v_mul_f32 v146, v146, v31
    v_mul_f32 v147, v147, v31
    v_mul_f32 v148, v148, v31
    v_mul_f32 v149, v149, v31
    v_mul_f32 v150, v150, v31
    v_mul_f32 v151, v151, v31
    v_mul_f32 v152, v152, v31
    v_mul_f32 v153, v153, v31
    v_mul_f32 v154, v154, v31
    v_mul_f32 v155, v155, v31
    v_mul_f32 v156, v156, v31
    v_mul_f32 v157, v157, v31
    v_mul_f32 v158, v158, v31
    v_mul_f32 v159, v159, v31
    v_mul_f32 v160, v160, v31
    v_mul_f32 v161, v161, v31
    v_mul_f32 v162, v162, v31
    v_mul_f32 v163, v163, v31
    v_mul_f32 v164, v164, v31
    v_mul_f32 v165, v165, v31
    v_mul_f32 v166, v166, v31
    v_mul_f32 v167, v167, v31
    v_mul_f32 v168, v168, v31
    v_mul_f32 v169, v169, v31
    v_mul_f32 v170, v170, v31
    v_mul_f32 v171, v171, v31
    v_mul_f32 v172, v172, v31
    v_mul_f32 v173, v173, v31
    v_mul_f32 v174, v174, v31
    v_mul_f32 v175, v175, v31
    v_mul_f32 v176, v176, v31
    v_mul_f32 v177, v177, v31
    v_mul_f32 v178, v178, v31
    v_mul_f32 v179, v179, v31
    v_mul_f32 v180, v180, v31
    v_mul_f32 v181, v181, v31
    v_mul_f32 v182, v182, v31
    v_mul_f32 v183, v183, v31
    v_mul_f32 v184, v184, v31
    v_mul_f32 v185, v185, v31
    v_mul_f32 v186, v186, v31
    v_mul_f32 v187, v187, v31
    v_mul_f32 v188, v188, v31
    v_mul_f32 v189, v189, v31
    v_mul_f32 v190, v190, v31
    v_mul_f32 v191, v191, v31
    v_mul_f32 v192, v192, v31
    v_mul_f32 v193, v193, v31
    v_mul_f32 v194, v194, v31
    v_mul_f32 v195, v195, v31
    v_mul_f32 v196, v196, v31
    v_mul_f32 v197, v197, v31
    v_mul_f32 v198, v198, v31
    v_mul_f32 v199, v199, v31
    v_mul_f32 v200, v200, v31
    v_mul_f32 v201, v201, v31
    v_mul_f32 v202, v202, v31
    v_mul_f32 v203, v203, v31
    v_mul_f32 v204, v204, v31
    v_mul_f32 v205, v205, v31
    v_mul_f32 v206, v206, v31
    v_mul_f32 v207, v207, v31
    v_mul_f32 v208, v208, v31
    v_mul_f32 v209, v209, v31
    v_mul_f32 v210, v210, v31
    v_mul_f32 v211, v211, v31
    v_mul_f32 v212, v212, v31
    v_mul_f32 v213, v213, v31
    v_mul_f32 v214, v214, v31
    v_mul_f32 v215, v215, v31
    v_mul_f32 v216, v216, v31
    v_mul_f32 v217, v217, v31
    v_mul_f32 v218, v218, v31
    v_mul_f32 v219, v219, v31
    v_mul_f32 v220, v220, v31
    v_mul_f32 v221, v221, v31
    v_mul_f32 v222, v222, v31
    v_mul_f32 v223, v223, v31
    v_mul_f32 v224, v224, v31
    v_mul_f32 v225, v225, v31
    v_mul_f32 v226, v226, v31
    v_mul_f32 v227, v227, v31
    v_mul_f32 v228, v228, v31
    v_mul_f32 v229, v229, v31
    v_mul_f32 v230, v230, v31
    v_mul_f32 v231, v231, v31
    v_mul_f32 v232, v232, v31
    v_mul_f32 v233, v233, v31
    v_mul_f32 v234, v234, v31
    v_mul_f32 v235, v235, v31
    v_mul_f32 v236, v236, v31
    v_mul_f32 v237, v237, v31
    v_mul_f32 v238, v238, v31
    v_mul_f32 v239, v239, v31
    v_mul_f32 v240, v240, v31
    v_mul_f32 v241, v241, v31
    v_mul_f32 v242, v242, v31
    v_mul_f32 v243, v243, v31
    v_mul_f32 v244, v244, v31
    v_mul_f32 v245, v245, v31
    v_mul_f32 v246, v246, v31
    v_mul_f32 v247, v247, v31
    v_mul_f32 v248, v248, v31
    v_mul_f32 v249, v249, v31
    v_mul_f32 v250, v250, v31
    v_mul_f32 v251, v251, v31
    v_mul_f32 v252, v252, v31
    v_mul_f32 v253, v253, v31
    v_mul_f32 v254, v254, v31
    v_mul_f32 v255, v255, v31
    s_nop 1
    s_branch L2_nors4
L2_mask5:
    s_lshl_b32 s60, s3, 5
    s_sub_u32 s60, 89, s60
    v_lshlrev_b32 v30, 2, v3
    v_mov_b32 v31, 0xff800000
    v_add_u32 v56, 0, v30
    v_cmp_gt_i32 vcc, s60, v56
    s_nop 1
    v_cndmask_b32 v32, v31, v32, vcc
    v_add_u32 v56, 1, v30
    v_cmp_gt_i32 vcc, s60, v56
    s_nop 1
    v_cndmask_b32 v33, v31, v33, vcc
    v_add_u32 v56, 2, v30
    v_cmp_gt_i32 vcc, s60, v56
    s_nop 1
    v_cndmask_b32 v34, v31, v34, vcc
    v_add_u32 v56, 3, v30
    v_cmp_gt_i32 vcc, s60, v56
    s_nop 1
    v_cndmask_b32 v35, v31, v35, vcc
    v_add_u32 v56, 8, v30
    v_cmp_gt_i32 vcc, s60, v56
    s_nop 1
    v_cndmask_b32 v36, v31, v36, vcc
    v_add_u32 v56, 9, v30
    v_cmp_gt_i32 vcc, s60, v56
    s_nop 1
    v_cndmask_b32 v37, v31, v37, vcc
    v_add_u32 v56, 10, v30
    v_cmp_gt_i32 vcc, s60, v56
    s_nop 1
    v_cndmask_b32 v38, v31, v38, vcc
    v_add_u32 v56, 11, v30
    v_cmp_gt_i32 vcc, s60, v56
    s_nop 1
    v_cndmask_b32 v39, v31, v39, vcc
    v_add_u32 v56, 16, v30
    v_cmp_gt_i32 vcc, s60, v56
    s_nop 1
    v_cndmask_b32 v40, v31, v40, vcc
    v_add_u32 v56, 17, v30
    v_cmp_gt_i32 vcc, s60, v56
    s_nop 1
    v_cndmask_b32 v41, v31, v41, vcc
    v_add_u32 v56, 18, v30
    v_cmp_gt_i32 vcc, s60, v56
    s_nop 1
    v_cndmask_b32 v42, v31, v42, vcc
    v_add_u32 v56, 19, v30
    v_cmp_gt_i32 vcc, s60, v56
    s_nop 1
    v_cndmask_b32 v43, v31, v43, vcc
    v_add_u32 v56, 24, v30
    v_cmp_gt_i32 vcc, s60, v56
    s_nop 1
    v_cndmask_b32 v44, v31, v44, vcc
    v_add_u32 v56, 25, v30
    v_cmp_gt_i32 vcc, s60, v56
    s_nop 1
    v_cndmask_b32 v45, v31, v45, vcc
    v_add_u32 v56, 26, v30
    v_cmp_gt_i32 vcc, s60, v56
    s_nop 1
    v_cndmask_b32 v46, v31, v46, vcc
    v_add_u32 v56, 27, v30
    v_cmp_gt_i32 vcc, s60, v56
    s_nop 1
    v_cndmask_b32 v47, v31, v47, vcc
    s_branch L2_nomask5
L2_rs5:
    v_max_f32 v30, v30, v28
    v_sub_f32 v31, v28, v30
    v_exp_f32 v31, v31
    v_mov_b32 v28, v30
    s_nop 7
    v_mul_f32 v29, v29, v31
    v_mul_f32 v64, v64, v31
    v_mul_f32 v65, v65, v31
    v_mul_f32 v66, v66, v31
    v_mul_f32 v67, v67, v31
    v_mul_f32 v68, v68, v31
    v_mul_f32 v69, v69, v31
    v_mul_f32 v70, v70, v31
    v_mul_f32 v71, v71, v31
    v_mul_f32 v72, v72, v31
    v_mul_f32 v73, v73, v31
    v_mul_f32 v74, v74, v31
    v_mul_f32 v75, v75, v31
    v_mul_f32 v76, v76, v31
    v_mul_f32 v77, v77, v31
    v_mul_f32 v78, v78, v31
    v_mul_f32 v79, v79, v31
    v_mul_f32 v80, v80, v31
    v_mul_f32 v81, v81, v31
    v_mul_f32 v82, v82, v31
    v_mul_f32 v83, v83, v31
    v_mul_f32 v84, v84, v31
    v_mul_f32 v85, v85, v31
    v_mul_f32 v86, v86, v31
    v_mul_f32 v87, v87, v31
    v_mul_f32 v88, v88, v31
    v_mul_f32 v89, v89, v31
    v_mul_f32 v90, v90, v31
    v_mul_f32 v91, v91, v31
    v_mul_f32 v92, v92, v31
    v_mul_f32 v93, v93, v31
    v_mul_f32 v94, v94, v31
    v_mul_f32 v95, v95, v31
    v_mul_f32 v96, v96, v31
    v_mul_f32 v97, v97, v31
    v_mul_f32 v98, v98, v31
    v_mul_f32 v99, v99, v31
    v_mul_f32 v100, v100, v31
    v_mul_f32 v101, v101, v31
    v_mul_f32 v102, v102, v31
    v_mul_f32 v103, v103, v31
    v_mul_f32 v104, v104, v31
    v_mul_f32 v105, v105, v31
    v_mul_f32 v106, v106, v31
    v_mul_f32 v107, v107, v31
    v_mul_f32 v108, v108, v31
    v_mul_f32 v109, v109, v31
    v_mul_f32 v110, v110, v31
    v_mul_f32 v111, v111, v31
    v_mul_f32 v112, v112, v31
    v_mul_f32 v113, v113, v31
    v_mul_f32 v114, v114, v31
    v_mul_f32 v115, v115, v31
    v_mul_f32 v116, v116, v31
    v_mul_f32 v117, v117, v31
    v_mul_f32 v118, v118, v31
    v_mul_f32 v119, v119, v31
    v_mul_f32 v120, v120, v31
    v_mul_f32 v121, v121, v31
    v_mul_f32 v122, v122, v31
    v_mul_f32 v123, v123, v31
    v_mul_f32 v124, v124, v31
    v_mul_f32 v125, v125, v31
    v_mul_f32 v126, v126, v31
    v_mul_f32 v127, v127, v31
    v_mul_f32 v128, v128, v31
    v_mul_f32 v129, v129, v31
    v_mul_f32 v130, v130, v31
    v_mul_f32 v131, v131, v31
    v_mul_f32 v132, v132, v31
    v_mul_f32 v133, v133, v31
    v_mul_f32 v134, v134, v31
    v_mul_f32 v135, v135, v31
    v_mul_f32 v136, v136, v31
    v_mul_f32 v137, v137, v31
    v_mul_f32 v138, v138, v31
    v_mul_f32 v139, v139, v31
    v_mul_f32 v140, v140, v31
    v_mul_f32 v141, v141, v31
    v_mul_f32 v142, v142, v31
    v_mul_f32 v143, v143, v31
    v_mul_f32 v144, v144, v31
    v_mul_f32 v145, v145, v31
    v_mul_f32 v146, v146, v31
    v_mul_f32 v147, v147, v31
    v_mul_f32 v148, v148, v31
    v_mul_f32 v149, v149, v31
    v_mul_f32 v150, v150, v31
    v_mul_f32 v151, v151, v31
    v_mul_f32 v152, v152, v31
    v_mul_f32 v153, v153, v31
    v_mul_f32 v154, v154, v31
    v_mul_f32 v155, v155, v31
    v_mul_f32 v156, v156, v31
    v_mul_f32 v157, v157, v31
    v_mul_f32 v158, v158, v31
    v_mul_f32 v159, v159, v31
    v_mul_f32 v160, v160, v31
    v_mul_f32 v161, v161, v31
    v_mul_f32 v162, v162, v31
    v_mul_f32 v163, v163, v31
    v_mul_f32 v164, v164, v31
    v_mul_f32 v165, v165, v31
    v_mul_f32 v166, v166, v31
    v_mul_f32 v167, v167, v31
    v_mul_f32 v168, v168, v31
    v_mul_f32 v169, v169, v31
    v_mul_f32 v170, v170, v31
    v_mul_f32 v171, v171, v31
    v_mul_f32 v172, v172, v31
    v_mul_f32 v173, v173, v31
    v_mul_f32 v174, v174, v31
    v_mul_f32 v175, v175, v31
    v_mul_f32 v176, v176, v31
    v_mul_f32 v177, v177, v31
    v_mul_f32 v178, v178, v31
    v_mul_f32 v179, v179, v31
    v_mul_f32 v180, v180, v31
    v_mul_f32 v181, v181, v31
    v_mul_f32 v182, v182, v31
    v_mul_f32 v183, v183, v31
    v_mul_f32 v184, v184, v31
    v_mul_f32 v185, v185, v31
    v_mul_f32 v186, v186, v31
    v_mul_f32 v187, v187, v31
    v_mul_f32 v188, v188, v31
    v_mul_f32 v189, v189, v31
    v_mul_f32 v190, v190, v31
    v_mul_f32 v191, v191, v31
    v_mul_f32 v192, v192, v31
    v_mul_f32 v193, v193, v31
    v_mul_f32 v194, v194, v31
    v_mul_f32 v195, v195, v31
    v_mul_f32 v196, v196, v31
    v_mul_f32 v197, v197, v31
    v_mul_f32 v198, v198, v31
    v_mul_f32 v199, v199, v31
    v_mul_f32 v200, v200, v31
    v_mul_f32 v201, v201, v31
    v_mul_f32 v202, v202, v31
    v_mul_f32 v203, v203, v31
    v_mul_f32 v204, v204, v31
    v_mul_f32 v205, v205, v31
    v_mul_f32 v206, v206, v31
    v_mul_f32 v207, v207, v31
    v_mul_f32 v208, v208, v31
    v_mul_f32 v209, v209, v31
    v_mul_f32 v210, v210, v31
    v_mul_f32 v211, v211, v31
    v_mul_f32 v212, v212, v31
    v_mul_f32 v213, v213, v31
    v_mul_f32 v214, v214, v31
    v_mul_f32 v215, v215, v31
    v_mul_f32 v216, v216, v31
    v_mul_f32 v217, v217, v31
    v_mul_f32 v218, v218, v31
    v_mul_f32 v219, v219, v31
    v_mul_f32 v220, v220, v31
    v_mul_f32 v221, v221, v31
    v_mul_f32 v222, v222, v31
    v_mul_f32 v223, v223, v31
    v_mul_f32 v224, v224, v31
    v_mul_f32 v225, v225, v31
    v_mul_f32 v226, v226, v31
    v_mul_f32 v227, v227, v31
    v_mul_f32 v228, v228, v31
    v_mul_f32 v229, v229, v31
    v_mul_f32 v230, v230, v31
    v_mul_f32 v231, v231, v31
    v_mul_f32 v232, v232, v31
    v_mul_f32 v233, v233, v31
    v_mul_f32 v234, v234, v31
    v_mul_f32 v235, v235, v31
    v_mul_f32 v236, v236, v31
    v_mul_f32 v237, v237, v31
    v_mul_f32 v238, v238, v31
    v_mul_f32 v239, v239, v31
    v_mul_f32 v240, v240, v31
    v_mul_f32 v241, v241, v31
    v_mul_f32 v242, v242, v31
    v_mul_f32 v243, v243, v31
    v_mul_f32 v244, v244, v31
    v_mul_f32 v245, v245, v31
    v_mul_f32 v246, v246, v31
    v_mul_f32 v247, v247, v31
    v_mul_f32 v248, v248, v31
    v_mul_f32 v249, v249, v31
    v_mul_f32 v250, v250, v31
    v_mul_f32 v251, v251, v31
    v_mul_f32 v252, v252, v31
    v_mul_f32 v253, v253, v31
    v_mul_f32 v254, v254, v31
    v_mul_f32 v255, v255, v31
    s_nop 1
    s_branch L2_nors5
.section .rodata,"a"
.p2align 6
.amdhsa_kernel standalone__video_timesformer__vision_kernel
  .amdhsa_next_free_vgpr 512
  .amdhsa_next_free_sgpr 102
  .amdhsa_accum_offset 256
  .amdhsa_group_segment_fixed_size 0
  .amdhsa_kernarg_size 64
  .amdhsa_user_sgpr_count 2
  .amdhsa_user_sgpr_kernarg_segment_ptr 1
  .amdhsa_system_sgpr_workgroup_id_x 1
  .amdhsa_float_denorm_mode_32 3
.end_amdhsa_kernel
```
